```python
import torch

def _softmax(x, axis=-1):
    return torch.softmax(x, dim=axis)
def _gelu(x):
    return torch.nn.functional.gelu(x, approximate="tanh")
def _silu(x):
    return torch.nn.functional.silu(x)
def _sigmoid(x):
    return torch.sigmoid(x)
def _layernorm(x, axis=-1, eps=1e-5):
    m = x.mean(dim=axis, keepdim=True)
    v = x.var(dim=axis, keepdim=True, unbiased=False)
    return (x - m) / torch.sqrt(v + eps)
def _scatter_add(tgt, idx, src, axis=0):
    return tgt.clone().index_add_(axis, idx, src)
def _segment_sum(src, seg, n):
    out = torch.zeros((n,) + src.shape[1:], dtype=src.dtype)
    return out.index_add_(0, seg, src)
def _pad(x, pw):
    flat = tuple(v for pair in reversed(pw) for v in pair)
    return torch.nn.functional.pad(x, flat)

kernel_name = 'interleave_layers__linear_kernel_hedgehog__spectral_fnet__prompt'

def setup_inputs():

    _w = (lambda a: (lambda t: t.to(torch.bfloat16) if t.is_floating_point() else t)(torch.as_tensor(a)))
    def _A_setup():
        B, S, D, H = 1, 2048, 576, 32
        Dh = D // H
        return {
            "x": _w((lambda *s: torch.randn(*s, dtype=torch.bfloat16) * 0.4)(B, S, D)),
            "wqkv": _w((lambda *s: torch.randn(*s, dtype=torch.bfloat16) * 1.6)(D, 3 * D)),
            "w_phi": _w((lambda *s: torch.randn(*s, dtype=torch.bfloat16) * 1.6)(H, Dh, Dh) * (Dh ** -0.5)),
            "wo": _w((lambda *s: torch.randn(*s, dtype=torch.bfloat16) * 1.6)(D, D)),
        }
    _A_in = _A_setup()

    def _B_setup():
        B, S, D = 1, 2048, 576
        ns = torch.arange(S)[:, None] * torch.arange(S)[None, :]
        nd = torch.arange(D)[:, None] * torch.arange(D)[None, :]
        Ws_re = torch.cos(-2.0 * torch.pi * ns / S).to(float)
        Ws_im = torch.sin(-2.0 * torch.pi * ns / S).to(float)
        Wd_re = torch.cos(-2.0 * torch.pi * nd / D).to(float)
        Wd_im = torch.sin(-2.0 * torch.pi * nd / D).to(float)
        return {
            "x": _w((lambda *s: torch.randn(*s, dtype=torch.bfloat16) * 0.4)(B, S, D)),
            "dft_seq_re": _w(Ws_re),
            "dft_seq_im": _w(Ws_im),
            "dft_hid_re": _w(Wd_re),
            "dft_hid_im": _w(Wd_im),
        }
    _B_in = _B_setup()

    return {
        "A_x": _A_in["x"],
        "A_wqkv": _A_in["wqkv"],
        "A_w_phi": _A_in["w_phi"],
        "A_wo": _A_in["wo"],
        "B_x": _B_in["x"],
        "B_dft_seq_re": _B_in["dft_seq_re"],
        "B_dft_seq_im": _B_in["dft_seq_im"],
        "B_dft_hid_re": _B_in["dft_hid_re"],
        "B_dft_hid_im": _B_in["dft_hid_im"],
    }

def reference(A_x, A_wqkv, A_w_phi, A_wo, B_x, B_dft_seq_re, B_dft_seq_im, B_dft_hid_re, B_dft_hid_im):
    def _A_ref(x, wqkv, w_phi, wo):
        B, S, D = x.shape
        H = 32; Dh = D // H
        qkv = (lambda x, *d: x.permute(*d))((x @ wqkv).reshape(B, S, 3, H, Dh), 2, 0, 3, 1, 4)
        q, k, v = qkv[0], qkv[1], qkv[2]
        pq = torch.einsum("bhsd,hdf->bhsf", q, w_phi)
        pk = torch.einsum("bhsd,hdf->bhsf", k, w_phi)
        phi_q = torch.concatenate([_softmax(pq, axis=-1), _softmax(-pq, axis=-1)], axis=-1)
        phi_k = torch.concatenate([_softmax(pk, axis=-1), _softmax(-pk, axis=-1)], axis=-1)
        kv = torch.einsum("bhsf,bhsd->bhfd", phi_k, v)
        z  = torch.einsum("bhsf->bhf", phi_k)
        num = torch.einsum("bhqf,bhfd->bhqd", phi_q, kv)
        den = torch.einsum("bhqf,bhf->bhq", phi_q, z)[..., None] + 1e-6
        o = num / den
        return (lambda x, *d: x.permute(*d))(o, 0, 2, 1, 3).reshape(B, S, D) @ wo

    def _B_ref(x, dft_seq_re, dft_seq_im, dft_hid_re, dft_hid_im):
        a = torch.einsum("bsd,ed->bse", x, dft_hid_re)
        b = torch.einsum("bsd,ed->bse", x, dft_hid_im)
        y = torch.einsum("ts,bse->bte", dft_seq_re, a) - torch.einsum("ts,bse->bte", dft_seq_im, b)
        return y

    x = A_x
    x = x + _A_ref(_layernorm(x, axis=-1), A_wqkv, A_w_phi, A_wo)
    x = x + _B_ref(_layernorm(x, axis=-1), B_dft_seq_re, B_dft_seq_im, B_dft_hid_re, B_dft_hid_im)
    x = x + _A_ref(_layernorm(x, axis=-1), A_wqkv, A_w_phi, A_wo)
    x = x + _B_ref(_layernorm(x, axis=-1), B_dft_seq_re, B_dft_seq_im, B_dft_hid_re, B_dft_hid_im)
    return x
```

```asm
; @launch kernel=prep_kernel grid=(256,1,1) block=(256,1,1) lds=0
; @launch kernel=ln0_kernel grid=(256,1,1) block=(64,1,1) lds=0
; @launch kernel=qkv_kernel grid=(256,1,1) block=(256,1,1) lds=122880
; @launch kernel=kv_kernel grid=(256,1,1) block=(256,1,1) lds=32768
; @launch kernel=o_kernel grid=(256,1,1) block=(256,1,1) lds=0
; @launch kernel=op1_kernel grid=(192,1,1) block=(256,1,1) lds=61440
; @launch kernel=ln1_kernel grid=(256,1,1) block=(64,1,1) lds=0
; @launch kernel=hid_kernel grid=(192,1,1) block=(256,1,1) lds=86016
; @launch kernel=seq_kernel grid=(256,1,1) block=(512,1,1) lds=110592
; @launch kernel=post1_kernel grid=(256,1,1) block=(64,1,1) lds=0
; @launch kernel=qkv_kernel grid=(256,1,1) block=(256,1,1) lds=122880
; @launch kernel=kv_kernel grid=(256,1,1) block=(256,1,1) lds=32768
; @launch kernel=o_kernel grid=(256,1,1) block=(256,1,1) lds=0
; @launch kernel=op2_kernel grid=(192,1,1) block=(256,1,1) lds=61440
; @launch kernel=ln3_kernel grid=(256,1,1) block=(64,1,1) lds=0
; @launch kernel=hid_kernel grid=(192,1,1) block=(256,1,1) lds=86016
; @launch kernel=seq_kernel grid=(256,1,1) block=(512,1,1) lds=110592
; @launch kernel=post2_kernel grid=(256,1,1) block=(64,1,1) lds=0
.amdgcn_target "amdgcn-amd-amdhsa--gfx950"
.text
.globl prep_kernel
.p2align 8
.type prep_kernel,@function
prep_kernel:
    s_cmp_ge_u32 s2, 256
    s_cbranch_scc1 L_prep_end
    s_load_dwordx16 s[4:19], s[0:1], 0
    s_load_dwordx8 s[20:27], s[0:1], 64
    v_lshrrev_b32 v1, 6, v0
    v_and_b32 v2, 63, v0
    s_nop 0
    v_readfirstlane_b32 s28, v1
    s_lshl_b32 s29, s2, 2
    s_add_u32 s28, s28, s29
    s_waitcnt lgkmcnt(0)
    s_mov_b32 s32, s6
    s_mov_b32 s33, s7
    s_and_b32 s33, s33, 0xffff
    s_mov_b32 s34, 0x1e6000
    s_mov_b32 s35, 0x00020000
    s_mov_b32 s36, s10
    s_mov_b32 s37, s11
    s_and_b32 s37, s37, 0xffff
    s_mov_b32 s38, 0xa2000
    s_mov_b32 s39, 0x00020000
    s_mov_b32 s40, s26
    s_mov_b32 s41, s27
    s_and_b32 s41, s41, 0xffff
    s_mov_b32 s42, 0x10000000
    s_mov_b32 s43, 0x00020000
    s_mov_b32 s44, s8
    s_mov_b32 s45, s9
    s_and_b32 s45, s45, 0xffff
    s_mov_b32 s46, 0x5100
    s_mov_b32 s47, 0x00020000
    s_mov_b32 s30, s28
L_wq_loop:
    s_cmp_ge_u32 s30, 1944
    s_cbranch_scc1 L_wq_done
    s_mov_b32 s31, 0x97b425f
    s_mul_hi_u32 s48, s30, s31
    s_mul_i32 s49, s48, 27
    s_sub_u32 s49, s30, s49
    s_lshl_b32 s50, s49, 7
    v_lshlrev_b32 v3, 1, v2
    v_add_u32 v3, s50, v3
    s_mul_i32 s51, s48, 27648
    buffer_load_ushort v8, v3, s[32:35], s51 offen
    s_add_u32 s51, s51, 3456
    buffer_load_ushort v9, v3, s[32:35], s51 offen
    s_add_u32 s51, s51, 3456
    buffer_load_ushort v10, v3, s[32:35], s51 offen
    s_add_u32 s51, s51, 3456
    buffer_load_ushort v11, v3, s[32:35], s51 offen
    s_add_u32 s51, s51, 3456
    buffer_load_ushort v12, v3, s[32:35], s51 offen
    s_add_u32 s51, s51, 3456
    buffer_load_ushort v13, v3, s[32:35], s51 offen
    s_add_u32 s51, s51, 3456
    buffer_load_ushort v14, v3, s[32:35], s51 offen
    s_add_u32 s51, s51, 3456
    buffer_load_ushort v15, v3, s[32:35], s51 offen
    s_add_u32 s51, s51, 3456
    v_lshrrev_b32 v4, 1, v3
    s_movk_i32 s52, 1152
    v_mul_lo_u32 v4, v4, s52
    s_lshl_b32 s53, s48, 4
    s_add_u32 s53, s53, 0x0
    s_waitcnt vmcnt(0)
    v_lshl_or_b32 v16, v9, 16, v8
    v_lshl_or_b32 v17, v11, 16, v10
    v_lshl_or_b32 v18, v13, 16, v12
    v_lshl_or_b32 v19, v15, 16, v14
    buffer_store_dwordx4 v[16:19], v4, s[40:43], s53 offen
    s_add_u32 s30, s30, 1024
    s_branch L_wq_loop
L_wq_done:
    s_mov_b32 s30, s28
L_wo_loop:
    s_cmp_ge_u32 s30, 648
    s_cbranch_scc1 L_wo_done
    s_mov_b32 s31, 0x1c71c71d
    s_mul_hi_u32 s48, s30, s31
    s_mul_i32 s49, s48, 9
    s_sub_u32 s49, s30, s49
    s_lshl_b32 s50, s49, 7
    v_lshlrev_b32 v3, 1, v2
    v_add_u32 v3, s50, v3
    s_mul_i32 s51, s48, 9216
    buffer_load_ushort v8, v3, s[36:39], s51 offen
    s_add_u32 s51, s51, 1152
    buffer_load_ushort v9, v3, s[36:39], s51 offen
    s_add_u32 s51, s51, 1152
    buffer_load_ushort v10, v3, s[36:39], s51 offen
    s_add_u32 s51, s51, 1152
    buffer_load_ushort v11, v3, s[36:39], s51 offen
    s_add_u32 s51, s51, 1152
    buffer_load_ushort v12, v3, s[36:39], s51 offen
    s_add_u32 s51, s51, 1152
    buffer_load_ushort v13, v3, s[36:39], s51 offen
    s_add_u32 s51, s51, 1152
    buffer_load_ushort v14, v3, s[36:39], s51 offen
    s_add_u32 s51, s51, 1152
    buffer_load_ushort v15, v3, s[36:39], s51 offen
    s_add_u32 s51, s51, 1152
    v_lshrrev_b32 v4, 1, v3
    s_movk_i32 s52, 1152
    v_mul_lo_u32 v4, v4, s52
    s_lshl_b32 s53, s48, 4
    s_add_u32 s53, s53, 0x1e6000
    s_waitcnt vmcnt(0)
    v_lshl_or_b32 v16, v9, 16, v8
    v_lshl_or_b32 v17, v11, 16, v10
    v_lshl_or_b32 v18, v13, 16, v12
    v_lshl_or_b32 v19, v15, 16, v14
    buffer_store_dwordx4 v[16:19], v4, s[40:43], s53 offen
    s_add_u32 s30, s30, 1024
    s_branch L_wo_loop
L_wo_done:
    s_cmp_ge_u32 s2, 4
    s_cbranch_scc1 L_phi_done
    s_lshl_b32 s30, s2, 8
    v_add_u32 v3, s30, v0
    v_lshrrev_b32 v4, 5, v3
    v_and_b32 v5, 31, v3
    s_movk_i32 s31, 648
    v_mul_lo_u32 v6, v4, s31
    v_lshl_add_u32 v6, v5, 1, v6
    v_mov_b32 v8, 0
    v_mov_b32 v9, 0
    v_mov_b32 v10, 0
    v_mov_b32 v11, 0
    v_mov_b32 v12, 0
    v_mov_b32 v13, 0
    v_mov_b32 v14, 0
    v_mov_b32 v15, 0
    v_mov_b32 v16, 0
    v_mov_b32 v17, 0
    v_mov_b32 v18, 0
    v_mov_b32 v19, 0
    v_mov_b32 v20, 0
    v_mov_b32 v21, 0
    v_mov_b32 v22, 0
    v_mov_b32 v23, 0
    v_mov_b32 v24, 0
    v_mov_b32 v25, 0
    v_cmp_gt_u32 vcc, 18, v5
    s_and_saveexec_b64 s[48:49], vcc
    s_cbranch_execz L_phi_skip
    buffer_load_ushort v8, v6, s[44:47], 0 offen offset:0
    buffer_load_ushort v9, v6, s[44:47], 0 offen offset:36
    buffer_load_ushort v10, v6, s[44:47], 0 offen offset:72
    buffer_load_ushort v11, v6, s[44:47], 0 offen offset:108
    buffer_load_ushort v12, v6, s[44:47], 0 offen offset:144
    buffer_load_ushort v13, v6, s[44:47], 0 offen offset:180
    buffer_load_ushort v14, v6, s[44:47], 0 offen offset:216
    buffer_load_ushort v15, v6, s[44:47], 0 offen offset:252
    buffer_load_ushort v16, v6, s[44:47], 0 offen offset:288
    buffer_load_ushort v17, v6, s[44:47], 0 offen offset:324
    buffer_load_ushort v18, v6, s[44:47], 0 offen offset:360
    buffer_load_ushort v19, v6, s[44:47], 0 offen offset:396
    buffer_load_ushort v20, v6, s[44:47], 0 offen offset:432
    buffer_load_ushort v21, v6, s[44:47], 0 offen offset:468
    buffer_load_ushort v22, v6, s[44:47], 0 offen offset:504
    buffer_load_ushort v23, v6, s[44:47], 0 offen offset:540
    buffer_load_ushort v24, v6, s[44:47], 0 offen offset:576
    buffer_load_ushort v25, v6, s[44:47], 0 offen offset:612
L_phi_skip:
    s_mov_b64 exec, s[48:49]
    s_waitcnt vmcnt(0)
    v_lshl_or_b32 v32, v9, 16, v8
    v_lshl_or_b32 v33, v11, 16, v10
    v_lshl_or_b32 v34, v13, 16, v12
    v_lshl_or_b32 v35, v15, 16, v14
    v_lshl_or_b32 v36, v17, 16, v16
    v_lshl_or_b32 v37, v19, 16, v18
    v_lshl_or_b32 v38, v21, 16, v20
    v_lshl_or_b32 v39, v23, 16, v22
    v_lshl_or_b32 v40, v25, 16, v24
    v_mov_b32 v41, 0
    v_mov_b32 v42, 0
    v_mov_b32 v43, 0
    v_mov_b32 v44, 0
    v_mov_b32 v45, 0
    v_mov_b32 v46, 0
    v_mov_b32 v47, 0
    v_lshlrev_b32 v7, 6, v3
    s_mov_b32 s31, 0x288000
    buffer_store_dwordx4 v[32:35], v7, s[40:43], s31 offen offset:0
    buffer_store_dwordx4 v[36:39], v7, s[40:43], s31 offen offset:16
    buffer_store_dwordx4 v[40:43], v7, s[40:43], s31 offen offset:32
    buffer_store_dwordx4 v[44:47], v7, s[40:43], s31 offen offset:48
L_phi_done:
    s_cmp_ge_u32 s28, 448
    s_cbranch_scc1 L_prep_end
    s_mov_b32 s31, 0x12492493
    s_mul_hi_u32 s48, s28, s31
    s_mul_i32 s49, s48, 14
    s_sub_u32 s49, s28, s49
    s_lshl_b32 s50, s48, 5
    s_add_u32 s50, s50, s49
    s_add_u32 s50, s50, 18
    s_lshl_b32 s50, s50, 12
    s_add_u32 s50, s50, 0xcd8000
    s_cmp_eq_u32 s49, 0
    s_cselect_b32 s51, 0x3f803f80, 0
    v_mov_b32 v16, s51
    v_mov_b32 v17, s51
    v_mov_b32 v18, s51
    v_mov_b32 v19, s51
    v_lshlrev_b32 v3, 4, v2
    buffer_store_dwordx4 v[16:19], v3, s[40:43], s50 offen offset:0
    buffer_store_dwordx4 v[16:19], v3, s[40:43], s50 offen offset:1024
    buffer_store_dwordx4 v[16:19], v3, s[40:43], s50 offen offset:2048
    buffer_store_dwordx4 v[16:19], v3, s[40:43], s50 offen offset:3072
L_prep_end:
    s_endpgm
.globl ln0_kernel
.p2align 8
.type ln0_kernel,@function
ln0_kernel:
    s_cmp_ge_u32 s2, 256
    s_cbranch_scc1 L_ln0_kernel_end
    s_load_dwordx16 s[4:19], s[0:1], 0
    s_load_dwordx8 s[20:27], s[0:1], 64
    v_lshrrev_b32 v1, 6, v0
    v_and_b32 v2, 63, v0
    s_lshl_b32 s28, s2, 3
    v_lshrrev_b32 v3, 3, v0
    v_add_u32 v3, s28, v3
    s_movk_i32 s29, 1152
    v_mul_lo_u32 v3, v3, s29
    v_and_b32 v4, 7, v0
    v_lshl_add_u32 v3, v4, 4, v3
    s_waitcnt lgkmcnt(0)
    s_mov_b32 s32, s4
    s_mov_b32 s33, s5
    s_and_b32 s33, s33, 0xffff
    s_mov_b32 s34, 0x240000
    s_mov_b32 s35, 0x00020000
    s_add_u32 s36, s26, 0x298000
    s_addc_u32 s37, s27, 0
    s_and_b32 s37, s37, 0xffff
    s_mov_b32 s38, 0x240000
    s_mov_b32 s39, 0x00020000
    buffer_load_dwordx4 v[8:11], v3, s[32:35], 0 offen offset:0
    buffer_load_dwordx4 v[12:15], v3, s[32:35], 0 offen offset:128
    buffer_load_dwordx4 v[16:19], v3, s[32:35], 0 offen offset:256
    buffer_load_dwordx4 v[20:23], v3, s[32:35], 0 offen offset:384
    buffer_load_dwordx4 v[24:27], v3, s[32:35], 0 offen offset:512
    buffer_load_dwordx4 v[28:31], v3, s[32:35], 0 offen offset:640
    buffer_load_dwordx4 v[32:35], v3, s[32:35], 0 offen offset:768
    buffer_load_dwordx4 v[36:39], v3, s[32:35], 0 offen offset:896
    buffer_load_dwordx4 v[40:43], v3, s[32:35], 0 offen offset:1024
    s_waitcnt vmcnt(0)
    v_lshlrev_b32 v44, 16, v8
    v_and_b32 v45, 0xffff0000, v8
    v_lshlrev_b32 v46, 16, v9
    v_and_b32 v47, 0xffff0000, v9
    v_lshlrev_b32 v48, 16, v10
    v_and_b32 v49, 0xffff0000, v10
    v_lshlrev_b32 v50, 16, v11
    v_and_b32 v51, 0xffff0000, v11
    v_lshlrev_b32 v52, 16, v12
    v_and_b32 v53, 0xffff0000, v12
    v_lshlrev_b32 v54, 16, v13
    v_and_b32 v55, 0xffff0000, v13
    v_lshlrev_b32 v56, 16, v14
    v_and_b32 v57, 0xffff0000, v14
    v_lshlrev_b32 v58, 16, v15
    v_and_b32 v59, 0xffff0000, v15
    v_lshlrev_b32 v60, 16, v16
    v_and_b32 v61, 0xffff0000, v16
    v_lshlrev_b32 v62, 16, v17
    v_and_b32 v63, 0xffff0000, v17
    v_lshlrev_b32 v64, 16, v18
    v_and_b32 v65, 0xffff0000, v18
    v_lshlrev_b32 v66, 16, v19
    v_and_b32 v67, 0xffff0000, v19
    v_lshlrev_b32 v68, 16, v20
    v_and_b32 v69, 0xffff0000, v20
    v_lshlrev_b32 v70, 16, v21
    v_and_b32 v71, 0xffff0000, v21
    v_lshlrev_b32 v72, 16, v22
    v_and_b32 v73, 0xffff0000, v22
    v_lshlrev_b32 v74, 16, v23
    v_and_b32 v75, 0xffff0000, v23
    v_lshlrev_b32 v76, 16, v24
    v_and_b32 v77, 0xffff0000, v24
    v_lshlrev_b32 v78, 16, v25
    v_and_b32 v79, 0xffff0000, v25
    v_lshlrev_b32 v80, 16, v26
    v_and_b32 v81, 0xffff0000, v26
    v_lshlrev_b32 v82, 16, v27
    v_and_b32 v83, 0xffff0000, v27
    v_lshlrev_b32 v84, 16, v28
    v_and_b32 v85, 0xffff0000, v28
    v_lshlrev_b32 v86, 16, v29
    v_and_b32 v87, 0xffff0000, v29
    v_lshlrev_b32 v88, 16, v30
    v_and_b32 v89, 0xffff0000, v30
    v_lshlrev_b32 v90, 16, v31
    v_and_b32 v91, 0xffff0000, v31
    v_lshlrev_b32 v92, 16, v32
    v_and_b32 v93, 0xffff0000, v32
    v_lshlrev_b32 v94, 16, v33
    v_and_b32 v95, 0xffff0000, v33
    v_lshlrev_b32 v96, 16, v34
    v_and_b32 v97, 0xffff0000, v34
    v_lshlrev_b32 v98, 16, v35
    v_and_b32 v99, 0xffff0000, v35
    v_lshlrev_b32 v100, 16, v36
    v_and_b32 v101, 0xffff0000, v36
    v_lshlrev_b32 v102, 16, v37
    v_and_b32 v103, 0xffff0000, v37
    v_lshlrev_b32 v104, 16, v38
    v_and_b32 v105, 0xffff0000, v38
    v_lshlrev_b32 v106, 16, v39
    v_and_b32 v107, 0xffff0000, v39
    v_lshlrev_b32 v108, 16, v40
    v_and_b32 v109, 0xffff0000, v40
    v_lshlrev_b32 v110, 16, v41
    v_and_b32 v111, 0xffff0000, v41
    v_lshlrev_b32 v112, 16, v42
    v_and_b32 v113, 0xffff0000, v42
    v_lshlrev_b32 v114, 16, v43
    v_and_b32 v115, 0xffff0000, v43
    v_add_f32 v116, v44, v45
    v_add_f32 v116, v116, v46
    v_add_f32 v116, v116, v47
    v_add_f32 v116, v116, v48
    v_add_f32 v116, v116, v49
    v_add_f32 v116, v116, v50
    v_add_f32 v116, v116, v51
    v_add_f32 v116, v116, v52
    v_add_f32 v116, v116, v53
    v_add_f32 v116, v116, v54
    v_add_f32 v116, v116, v55
    v_add_f32 v116, v116, v56
    v_add_f32 v116, v116, v57
    v_add_f32 v116, v116, v58
    v_add_f32 v116, v116, v59
    v_add_f32 v116, v116, v60
    v_add_f32 v116, v116, v61
    v_add_f32 v116, v116, v62
    v_add_f32 v116, v116, v63
    v_add_f32 v116, v116, v64
    v_add_f32 v116, v116, v65
    v_add_f32 v116, v116, v66
    v_add_f32 v116, v116, v67
    v_add_f32 v116, v116, v68
    v_add_f32 v116, v116, v69
    v_add_f32 v116, v116, v70
    v_add_f32 v116, v116, v71
    v_add_f32 v116, v116, v72
    v_add_f32 v116, v116, v73
    v_add_f32 v116, v116, v74
    v_add_f32 v116, v116, v75
    v_add_f32 v116, v116, v76
    v_add_f32 v116, v116, v77
    v_add_f32 v116, v116, v78
    v_add_f32 v116, v116, v79
    v_add_f32 v116, v116, v80
    v_add_f32 v116, v116, v81
    v_add_f32 v116, v116, v82
    v_add_f32 v116, v116, v83
    v_add_f32 v116, v116, v84
    v_add_f32 v116, v116, v85
    v_add_f32 v116, v116, v86
    v_add_f32 v116, v116, v87
    v_add_f32 v116, v116, v88
    v_add_f32 v116, v116, v89
    v_add_f32 v116, v116, v90
    v_add_f32 v116, v116, v91
    v_add_f32 v116, v116, v92
    v_add_f32 v116, v116, v93
    v_add_f32 v116, v116, v94
    v_add_f32 v116, v116, v95
    v_add_f32 v116, v116, v96
    v_add_f32 v116, v116, v97
    v_add_f32 v116, v116, v98
    v_add_f32 v116, v116, v99
    v_add_f32 v116, v116, v100
    v_add_f32 v116, v116, v101
    v_add_f32 v116, v116, v102
    v_add_f32 v116, v116, v103
    v_add_f32 v116, v116, v104
    v_add_f32 v116, v116, v105
    v_add_f32 v116, v116, v106
    v_add_f32 v116, v116, v107
    v_add_f32 v116, v116, v108
    v_add_f32 v116, v116, v109
    v_add_f32 v116, v116, v110
    v_add_f32 v116, v116, v111
    v_add_f32 v116, v116, v112
    v_add_f32 v116, v116, v113
    v_add_f32 v116, v116, v114
    v_add_f32 v116, v116, v115
    s_nop 1
    v_add_f32_dpp v116, v116, v116 quad_perm:[1,0,3,2] row_mask:0xf bank_mask:0xf
    s_nop 1
    v_add_f32_dpp v116, v116, v116 quad_perm:[2,3,0,1] row_mask:0xf bank_mask:0xf
    s_nop 1
    v_add_f32_dpp v116, v116, v116 row_half_mirror row_mask:0xf bank_mask:0xf
    v_mul_f32 v118, 0x3ae38e39, v116
    v_sub_f32 v119, v44, v118
    v_mul_f32 v117, v119, v119
    v_sub_f32 v119, v45, v118
    v_fmac_f32 v117, v119, v119
    v_sub_f32 v119, v46, v118
    v_fmac_f32 v117, v119, v119
    v_sub_f32 v119, v47, v118
    v_fmac_f32 v117, v119, v119
    v_sub_f32 v119, v48, v118
    v_fmac_f32 v117, v119, v119
    v_sub_f32 v119, v49, v118
    v_fmac_f32 v117, v119, v119
    v_sub_f32 v119, v50, v118
    v_fmac_f32 v117, v119, v119
    v_sub_f32 v119, v51, v118
    v_fmac_f32 v117, v119, v119
    v_sub_f32 v119, v52, v118
    v_fmac_f32 v117, v119, v119
    v_sub_f32 v119, v53, v118
    v_fmac_f32 v117, v119, v119
    v_sub_f32 v119, v54, v118
    v_fmac_f32 v117, v119, v119
    v_sub_f32 v119, v55, v118
    v_fmac_f32 v117, v119, v119
    v_sub_f32 v119, v56, v118
    v_fmac_f32 v117, v119, v119
    v_sub_f32 v119, v57, v118
    v_fmac_f32 v117, v119, v119
    v_sub_f32 v119, v58, v118
    v_fmac_f32 v117, v119, v119
    v_sub_f32 v119, v59, v118
    v_fmac_f32 v117, v119, v119
    v_sub_f32 v119, v60, v118
    v_fmac_f32 v117, v119, v119
    v_sub_f32 v119, v61, v118
    v_fmac_f32 v117, v119, v119
    v_sub_f32 v119, v62, v118
    v_fmac_f32 v117, v119, v119
    v_sub_f32 v119, v63, v118
    v_fmac_f32 v117, v119, v119
    v_sub_f32 v119, v64, v118
    v_fmac_f32 v117, v119, v119
    v_sub_f32 v119, v65, v118
    v_fmac_f32 v117, v119, v119
    v_sub_f32 v119, v66, v118
    v_fmac_f32 v117, v119, v119
    v_sub_f32 v119, v67, v118
    v_fmac_f32 v117, v119, v119
    v_sub_f32 v119, v68, v118
    v_fmac_f32 v117, v119, v119
    v_sub_f32 v119, v69, v118
    v_fmac_f32 v117, v119, v119
    v_sub_f32 v119, v70, v118
    v_fmac_f32 v117, v119, v119
    v_sub_f32 v119, v71, v118
    v_fmac_f32 v117, v119, v119
    v_sub_f32 v119, v72, v118
    v_fmac_f32 v117, v119, v119
    v_sub_f32 v119, v73, v118
    v_fmac_f32 v117, v119, v119
    v_sub_f32 v119, v74, v118
    v_fmac_f32 v117, v119, v119
    v_sub_f32 v119, v75, v118
    v_fmac_f32 v117, v119, v119
    v_sub_f32 v119, v76, v118
    v_fmac_f32 v117, v119, v119
    v_sub_f32 v119, v77, v118
    v_fmac_f32 v117, v119, v119
    v_sub_f32 v119, v78, v118
    v_fmac_f32 v117, v119, v119
    v_sub_f32 v119, v79, v118
    v_fmac_f32 v117, v119, v119
    v_sub_f32 v119, v80, v118
    v_fmac_f32 v117, v119, v119
    v_sub_f32 v119, v81, v118
    v_fmac_f32 v117, v119, v119
    v_sub_f32 v119, v82, v118
    v_fmac_f32 v117, v119, v119
    v_sub_f32 v119, v83, v118
    v_fmac_f32 v117, v119, v119
    v_sub_f32 v119, v84, v118
    v_fmac_f32 v117, v119, v119
    v_sub_f32 v119, v85, v118
    v_fmac_f32 v117, v119, v119
    v_sub_f32 v119, v86, v118
    v_fmac_f32 v117, v119, v119
    v_sub_f32 v119, v87, v118
    v_fmac_f32 v117, v119, v119
    v_sub_f32 v119, v88, v118
    v_fmac_f32 v117, v119, v119
    v_sub_f32 v119, v89, v118
    v_fmac_f32 v117, v119, v119
    v_sub_f32 v119, v90, v118
    v_fmac_f32 v117, v119, v119
    v_sub_f32 v119, v91, v118
    v_fmac_f32 v117, v119, v119
    v_sub_f32 v119, v92, v118
    v_fmac_f32 v117, v119, v119
    v_sub_f32 v119, v93, v118
    v_fmac_f32 v117, v119, v119
    v_sub_f32 v119, v94, v118
    v_fmac_f32 v117, v119, v119
    v_sub_f32 v119, v95, v118
    v_fmac_f32 v117, v119, v119
    v_sub_f32 v119, v96, v118
    v_fmac_f32 v117, v119, v119
    v_sub_f32 v119, v97, v118
    v_fmac_f32 v117, v119, v119
    v_sub_f32 v119, v98, v118
    v_fmac_f32 v117, v119, v119
    v_sub_f32 v119, v99, v118
    v_fmac_f32 v117, v119, v119
    v_sub_f32 v119, v100, v118
    v_fmac_f32 v117, v119, v119
    v_sub_f32 v119, v101, v118
    v_fmac_f32 v117, v119, v119
    v_sub_f32 v119, v102, v118
    v_fmac_f32 v117, v119, v119
    v_sub_f32 v119, v103, v118
    v_fmac_f32 v117, v119, v119
    v_sub_f32 v119, v104, v118
    v_fmac_f32 v117, v119, v119
    v_sub_f32 v119, v105, v118
    v_fmac_f32 v117, v119, v119
    v_sub_f32 v119, v106, v118
    v_fmac_f32 v117, v119, v119
    v_sub_f32 v119, v107, v118
    v_fmac_f32 v117, v119, v119
    v_sub_f32 v119, v108, v118
    v_fmac_f32 v117, v119, v119
    v_sub_f32 v119, v109, v118
    v_fmac_f32 v117, v119, v119
    v_sub_f32 v119, v110, v118
    v_fmac_f32 v117, v119, v119
    v_sub_f32 v119, v111, v118
    v_fmac_f32 v117, v119, v119
    v_sub_f32 v119, v112, v118
    v_fmac_f32 v117, v119, v119
    v_sub_f32 v119, v113, v118
    v_fmac_f32 v117, v119, v119
    v_sub_f32 v119, v114, v118
    v_fmac_f32 v117, v119, v119
    v_sub_f32 v119, v115, v118
    v_fmac_f32 v117, v119, v119
    s_nop 1
    v_add_f32_dpp v117, v117, v117 quad_perm:[1,0,3,2] row_mask:0xf bank_mask:0xf
    s_nop 1
    v_add_f32_dpp v117, v117, v117 quad_perm:[2,3,0,1] row_mask:0xf bank_mask:0xf
    s_nop 1
    v_add_f32_dpp v117, v117, v117 row_half_mirror row_mask:0xf bank_mask:0xf
    v_mul_f32 v120, 0x3ae38e39, v117
    v_cvt_pk_bf16_f32 v121, v118, v120
    v_and_b32 v122, 0xffff0000, v121
    v_lshlrev_b32 v121, 16, v121
    v_add_f32 v122, 0x3727c5ac, v122
    v_cvt_pk_bf16_f32 v122, v122, v122
    v_lshlrev_b32 v122, 16, v122
    v_sqrt_f32 v122, v122
    s_nop 0
    v_cvt_pk_bf16_f32 v122, v122, v122
    v_lshlrev_b32 v122, 16, v122
    v_rcp_f32 v123, v122
    v_sub_f32 v44, v44, v121
    v_sub_f32 v45, v45, v121
    v_cvt_pk_bf16_f32 v8, v44, v45
    v_lshlrev_b32 v44, 16, v8
    v_and_b32 v45, 0xffff0000, v8
    v_mul_f32 v125, v44, v123
    v_fma_f32 v127, -v125, v122, v44
    v_fma_f32 v44, v127, v123, v125
    v_mul_f32 v126, v45, v123
    v_fma_f32 v128, -v126, v122, v45
    v_fma_f32 v45, v128, v123, v126
    v_cvt_pk_bf16_f32 v8, v44, v45
    v_sub_f32 v46, v46, v121
    v_sub_f32 v47, v47, v121
    v_cvt_pk_bf16_f32 v9, v46, v47
    v_lshlrev_b32 v46, 16, v9
    v_and_b32 v47, 0xffff0000, v9
    v_mul_f32 v125, v46, v123
    v_fma_f32 v127, -v125, v122, v46
    v_fma_f32 v46, v127, v123, v125
    v_mul_f32 v126, v47, v123
    v_fma_f32 v128, -v126, v122, v47
    v_fma_f32 v47, v128, v123, v126
    v_cvt_pk_bf16_f32 v9, v46, v47
    v_sub_f32 v48, v48, v121
    v_sub_f32 v49, v49, v121
    v_cvt_pk_bf16_f32 v10, v48, v49
    v_lshlrev_b32 v48, 16, v10
    v_and_b32 v49, 0xffff0000, v10
    v_mul_f32 v125, v48, v123
    v_fma_f32 v127, -v125, v122, v48
    v_fma_f32 v48, v127, v123, v125
    v_mul_f32 v126, v49, v123
    v_fma_f32 v128, -v126, v122, v49
    v_fma_f32 v49, v128, v123, v126
    v_cvt_pk_bf16_f32 v10, v48, v49
    v_sub_f32 v50, v50, v121
    v_sub_f32 v51, v51, v121
    v_cvt_pk_bf16_f32 v11, v50, v51
    v_lshlrev_b32 v50, 16, v11
    v_and_b32 v51, 0xffff0000, v11
    v_mul_f32 v125, v50, v123
    v_fma_f32 v127, -v125, v122, v50
    v_fma_f32 v50, v127, v123, v125
    v_mul_f32 v126, v51, v123
    v_fma_f32 v128, -v126, v122, v51
    v_fma_f32 v51, v128, v123, v126
    v_cvt_pk_bf16_f32 v11, v50, v51
    v_sub_f32 v52, v52, v121
    v_sub_f32 v53, v53, v121
    v_cvt_pk_bf16_f32 v12, v52, v53
    v_lshlrev_b32 v52, 16, v12
    v_and_b32 v53, 0xffff0000, v12
    v_mul_f32 v125, v52, v123
    v_fma_f32 v127, -v125, v122, v52
    v_fma_f32 v52, v127, v123, v125
    v_mul_f32 v126, v53, v123
    v_fma_f32 v128, -v126, v122, v53
    v_fma_f32 v53, v128, v123, v126
    v_cvt_pk_bf16_f32 v12, v52, v53
    v_sub_f32 v54, v54, v121
    v_sub_f32 v55, v55, v121
    v_cvt_pk_bf16_f32 v13, v54, v55
    v_lshlrev_b32 v54, 16, v13
    v_and_b32 v55, 0xffff0000, v13
    v_mul_f32 v125, v54, v123
    v_fma_f32 v127, -v125, v122, v54
    v_fma_f32 v54, v127, v123, v125
    v_mul_f32 v126, v55, v123
    v_fma_f32 v128, -v126, v122, v55
    v_fma_f32 v55, v128, v123, v126
    v_cvt_pk_bf16_f32 v13, v54, v55
    v_sub_f32 v56, v56, v121
    v_sub_f32 v57, v57, v121
    v_cvt_pk_bf16_f32 v14, v56, v57
    v_lshlrev_b32 v56, 16, v14
    v_and_b32 v57, 0xffff0000, v14
    v_mul_f32 v125, v56, v123
    v_fma_f32 v127, -v125, v122, v56
    v_fma_f32 v56, v127, v123, v125
    v_mul_f32 v126, v57, v123
    v_fma_f32 v128, -v126, v122, v57
    v_fma_f32 v57, v128, v123, v126
    v_cvt_pk_bf16_f32 v14, v56, v57
    v_sub_f32 v58, v58, v121
    v_sub_f32 v59, v59, v121
    v_cvt_pk_bf16_f32 v15, v58, v59
    v_lshlrev_b32 v58, 16, v15
    v_and_b32 v59, 0xffff0000, v15
    v_mul_f32 v125, v58, v123
    v_fma_f32 v127, -v125, v122, v58
    v_fma_f32 v58, v127, v123, v125
    v_mul_f32 v126, v59, v123
    v_fma_f32 v128, -v126, v122, v59
    v_fma_f32 v59, v128, v123, v126
    v_cvt_pk_bf16_f32 v15, v58, v59
    v_sub_f32 v60, v60, v121
    v_sub_f32 v61, v61, v121
    v_cvt_pk_bf16_f32 v16, v60, v61
    v_lshlrev_b32 v60, 16, v16
    v_and_b32 v61, 0xffff0000, v16
    v_mul_f32 v125, v60, v123
    v_fma_f32 v127, -v125, v122, v60
    v_fma_f32 v60, v127, v123, v125
    v_mul_f32 v126, v61, v123
    v_fma_f32 v128, -v126, v122, v61
    v_fma_f32 v61, v128, v123, v126
    v_cvt_pk_bf16_f32 v16, v60, v61
    v_sub_f32 v62, v62, v121
    v_sub_f32 v63, v63, v121
    v_cvt_pk_bf16_f32 v17, v62, v63
    v_lshlrev_b32 v62, 16, v17
    v_and_b32 v63, 0xffff0000, v17
    v_mul_f32 v125, v62, v123
    v_fma_f32 v127, -v125, v122, v62
    v_fma_f32 v62, v127, v123, v125
    v_mul_f32 v126, v63, v123
    v_fma_f32 v128, -v126, v122, v63
    v_fma_f32 v63, v128, v123, v126
    v_cvt_pk_bf16_f32 v17, v62, v63
    v_sub_f32 v64, v64, v121
    v_sub_f32 v65, v65, v121
    v_cvt_pk_bf16_f32 v18, v64, v65
    v_lshlrev_b32 v64, 16, v18
    v_and_b32 v65, 0xffff0000, v18
    v_mul_f32 v125, v64, v123
    v_fma_f32 v127, -v125, v122, v64
    v_fma_f32 v64, v127, v123, v125
    v_mul_f32 v126, v65, v123
    v_fma_f32 v128, -v126, v122, v65
    v_fma_f32 v65, v128, v123, v126
    v_cvt_pk_bf16_f32 v18, v64, v65
    v_sub_f32 v66, v66, v121
    v_sub_f32 v67, v67, v121
    v_cvt_pk_bf16_f32 v19, v66, v67
    v_lshlrev_b32 v66, 16, v19
    v_and_b32 v67, 0xffff0000, v19
    v_mul_f32 v125, v66, v123
    v_fma_f32 v127, -v125, v122, v66
    v_fma_f32 v66, v127, v123, v125
    v_mul_f32 v126, v67, v123
    v_fma_f32 v128, -v126, v122, v67
    v_fma_f32 v67, v128, v123, v126
    v_cvt_pk_bf16_f32 v19, v66, v67
    v_sub_f32 v68, v68, v121
    v_sub_f32 v69, v69, v121
    v_cvt_pk_bf16_f32 v20, v68, v69
    v_lshlrev_b32 v68, 16, v20
    v_and_b32 v69, 0xffff0000, v20
    v_mul_f32 v125, v68, v123
    v_fma_f32 v127, -v125, v122, v68
    v_fma_f32 v68, v127, v123, v125
    v_mul_f32 v126, v69, v123
    v_fma_f32 v128, -v126, v122, v69
    v_fma_f32 v69, v128, v123, v126
    v_cvt_pk_bf16_f32 v20, v68, v69
    v_sub_f32 v70, v70, v121
    v_sub_f32 v71, v71, v121
    v_cvt_pk_bf16_f32 v21, v70, v71
    v_lshlrev_b32 v70, 16, v21
    v_and_b32 v71, 0xffff0000, v21
    v_mul_f32 v125, v70, v123
    v_fma_f32 v127, -v125, v122, v70
    v_fma_f32 v70, v127, v123, v125
    v_mul_f32 v126, v71, v123
    v_fma_f32 v128, -v126, v122, v71
    v_fma_f32 v71, v128, v123, v126
    v_cvt_pk_bf16_f32 v21, v70, v71
    v_sub_f32 v72, v72, v121
    v_sub_f32 v73, v73, v121
    v_cvt_pk_bf16_f32 v22, v72, v73
    v_lshlrev_b32 v72, 16, v22
    v_and_b32 v73, 0xffff0000, v22
    v_mul_f32 v125, v72, v123
    v_fma_f32 v127, -v125, v122, v72
    v_fma_f32 v72, v127, v123, v125
    v_mul_f32 v126, v73, v123
    v_fma_f32 v128, -v126, v122, v73
    v_fma_f32 v73, v128, v123, v126
    v_cvt_pk_bf16_f32 v22, v72, v73
    v_sub_f32 v74, v74, v121
    v_sub_f32 v75, v75, v121
    v_cvt_pk_bf16_f32 v23, v74, v75
    v_lshlrev_b32 v74, 16, v23
    v_and_b32 v75, 0xffff0000, v23
    v_mul_f32 v125, v74, v123
    v_fma_f32 v127, -v125, v122, v74
    v_fma_f32 v74, v127, v123, v125
    v_mul_f32 v126, v75, v123
    v_fma_f32 v128, -v126, v122, v75
    v_fma_f32 v75, v128, v123, v126
    v_cvt_pk_bf16_f32 v23, v74, v75
    v_sub_f32 v76, v76, v121
    v_sub_f32 v77, v77, v121
    v_cvt_pk_bf16_f32 v24, v76, v77
    v_lshlrev_b32 v76, 16, v24
    v_and_b32 v77, 0xffff0000, v24
    v_mul_f32 v125, v76, v123
    v_fma_f32 v127, -v125, v122, v76
    v_fma_f32 v76, v127, v123, v125
    v_mul_f32 v126, v77, v123
    v_fma_f32 v128, -v126, v122, v77
    v_fma_f32 v77, v128, v123, v126
    v_cvt_pk_bf16_f32 v24, v76, v77
    v_sub_f32 v78, v78, v121
    v_sub_f32 v79, v79, v121
    v_cvt_pk_bf16_f32 v25, v78, v79
    v_lshlrev_b32 v78, 16, v25
    v_and_b32 v79, 0xffff0000, v25
    v_mul_f32 v125, v78, v123
    v_fma_f32 v127, -v125, v122, v78
    v_fma_f32 v78, v127, v123, v125
    v_mul_f32 v126, v79, v123
    v_fma_f32 v128, -v126, v122, v79
    v_fma_f32 v79, v128, v123, v126
    v_cvt_pk_bf16_f32 v25, v78, v79
    v_sub_f32 v80, v80, v121
    v_sub_f32 v81, v81, v121
    v_cvt_pk_bf16_f32 v26, v80, v81
    v_lshlrev_b32 v80, 16, v26
    v_and_b32 v81, 0xffff0000, v26
    v_mul_f32 v125, v80, v123
    v_fma_f32 v127, -v125, v122, v80
    v_fma_f32 v80, v127, v123, v125
    v_mul_f32 v126, v81, v123
    v_fma_f32 v128, -v126, v122, v81
    v_fma_f32 v81, v128, v123, v126
    v_cvt_pk_bf16_f32 v26, v80, v81
    v_sub_f32 v82, v82, v121
    v_sub_f32 v83, v83, v121
    v_cvt_pk_bf16_f32 v27, v82, v83
    v_lshlrev_b32 v82, 16, v27
    v_and_b32 v83, 0xffff0000, v27
    v_mul_f32 v125, v82, v123
    v_fma_f32 v127, -v125, v122, v82
    v_fma_f32 v82, v127, v123, v125
    v_mul_f32 v126, v83, v123
    v_fma_f32 v128, -v126, v122, v83
    v_fma_f32 v83, v128, v123, v126
    v_cvt_pk_bf16_f32 v27, v82, v83
    v_sub_f32 v84, v84, v121
    v_sub_f32 v85, v85, v121
    v_cvt_pk_bf16_f32 v28, v84, v85
    v_lshlrev_b32 v84, 16, v28
    v_and_b32 v85, 0xffff0000, v28
    v_mul_f32 v125, v84, v123
    v_fma_f32 v127, -v125, v122, v84
    v_fma_f32 v84, v127, v123, v125
    v_mul_f32 v126, v85, v123
    v_fma_f32 v128, -v126, v122, v85
    v_fma_f32 v85, v128, v123, v126
    v_cvt_pk_bf16_f32 v28, v84, v85
    v_sub_f32 v86, v86, v121
    v_sub_f32 v87, v87, v121
    v_cvt_pk_bf16_f32 v29, v86, v87
    v_lshlrev_b32 v86, 16, v29
    v_and_b32 v87, 0xffff0000, v29
    v_mul_f32 v125, v86, v123
    v_fma_f32 v127, -v125, v122, v86
    v_fma_f32 v86, v127, v123, v125
    v_mul_f32 v126, v87, v123
    v_fma_f32 v128, -v126, v122, v87
    v_fma_f32 v87, v128, v123, v126
    v_cvt_pk_bf16_f32 v29, v86, v87
    v_sub_f32 v88, v88, v121
    v_sub_f32 v89, v89, v121
    v_cvt_pk_bf16_f32 v30, v88, v89
    v_lshlrev_b32 v88, 16, v30
    v_and_b32 v89, 0xffff0000, v30
    v_mul_f32 v125, v88, v123
    v_fma_f32 v127, -v125, v122, v88
    v_fma_f32 v88, v127, v123, v125
    v_mul_f32 v126, v89, v123
    v_fma_f32 v128, -v126, v122, v89
    v_fma_f32 v89, v128, v123, v126
    v_cvt_pk_bf16_f32 v30, v88, v89
    v_sub_f32 v90, v90, v121
    v_sub_f32 v91, v91, v121
    v_cvt_pk_bf16_f32 v31, v90, v91
    v_lshlrev_b32 v90, 16, v31
    v_and_b32 v91, 0xffff0000, v31
    v_mul_f32 v125, v90, v123
    v_fma_f32 v127, -v125, v122, v90
    v_fma_f32 v90, v127, v123, v125
    v_mul_f32 v126, v91, v123
    v_fma_f32 v128, -v126, v122, v91
    v_fma_f32 v91, v128, v123, v126
    v_cvt_pk_bf16_f32 v31, v90, v91
    v_sub_f32 v92, v92, v121
    v_sub_f32 v93, v93, v121
    v_cvt_pk_bf16_f32 v32, v92, v93
    v_lshlrev_b32 v92, 16, v32
    v_and_b32 v93, 0xffff0000, v32
    v_mul_f32 v125, v92, v123
    v_fma_f32 v127, -v125, v122, v92
    v_fma_f32 v92, v127, v123, v125
    v_mul_f32 v126, v93, v123
    v_fma_f32 v128, -v126, v122, v93
    v_fma_f32 v93, v128, v123, v126
    v_cvt_pk_bf16_f32 v32, v92, v93
    v_sub_f32 v94, v94, v121
    v_sub_f32 v95, v95, v121
    v_cvt_pk_bf16_f32 v33, v94, v95
    v_lshlrev_b32 v94, 16, v33
    v_and_b32 v95, 0xffff0000, v33
    v_mul_f32 v125, v94, v123
    v_fma_f32 v127, -v125, v122, v94
    v_fma_f32 v94, v127, v123, v125
    v_mul_f32 v126, v95, v123
    v_fma_f32 v128, -v126, v122, v95
    v_fma_f32 v95, v128, v123, v126
    v_cvt_pk_bf16_f32 v33, v94, v95
    v_sub_f32 v96, v96, v121
    v_sub_f32 v97, v97, v121
    v_cvt_pk_bf16_f32 v34, v96, v97
    v_lshlrev_b32 v96, 16, v34
    v_and_b32 v97, 0xffff0000, v34
    v_mul_f32 v125, v96, v123
    v_fma_f32 v127, -v125, v122, v96
    v_fma_f32 v96, v127, v123, v125
    v_mul_f32 v126, v97, v123
    v_fma_f32 v128, -v126, v122, v97
    v_fma_f32 v97, v128, v123, v126
    v_cvt_pk_bf16_f32 v34, v96, v97
    v_sub_f32 v98, v98, v121
    v_sub_f32 v99, v99, v121
    v_cvt_pk_bf16_f32 v35, v98, v99
    v_lshlrev_b32 v98, 16, v35
    v_and_b32 v99, 0xffff0000, v35
    v_mul_f32 v125, v98, v123
    v_fma_f32 v127, -v125, v122, v98
    v_fma_f32 v98, v127, v123, v125
    v_mul_f32 v126, v99, v123
    v_fma_f32 v128, -v126, v122, v99
    v_fma_f32 v99, v128, v123, v126
    v_cvt_pk_bf16_f32 v35, v98, v99
    v_sub_f32 v100, v100, v121
    v_sub_f32 v101, v101, v121
    v_cvt_pk_bf16_f32 v36, v100, v101
    v_lshlrev_b32 v100, 16, v36
    v_and_b32 v101, 0xffff0000, v36
    v_mul_f32 v125, v100, v123
    v_fma_f32 v127, -v125, v122, v100
    v_fma_f32 v100, v127, v123, v125
    v_mul_f32 v126, v101, v123
    v_fma_f32 v128, -v126, v122, v101
    v_fma_f32 v101, v128, v123, v126
    v_cvt_pk_bf16_f32 v36, v100, v101
    v_sub_f32 v102, v102, v121
    v_sub_f32 v103, v103, v121
    v_cvt_pk_bf16_f32 v37, v102, v103
    v_lshlrev_b32 v102, 16, v37
    v_and_b32 v103, 0xffff0000, v37
    v_mul_f32 v125, v102, v123
    v_fma_f32 v127, -v125, v122, v102
    v_fma_f32 v102, v127, v123, v125
    v_mul_f32 v126, v103, v123
    v_fma_f32 v128, -v126, v122, v103
    v_fma_f32 v103, v128, v123, v126
    v_cvt_pk_bf16_f32 v37, v102, v103
    v_sub_f32 v104, v104, v121
    v_sub_f32 v105, v105, v121
    v_cvt_pk_bf16_f32 v38, v104, v105
    v_lshlrev_b32 v104, 16, v38
    v_and_b32 v105, 0xffff0000, v38
    v_mul_f32 v125, v104, v123
    v_fma_f32 v127, -v125, v122, v104
    v_fma_f32 v104, v127, v123, v125
    v_mul_f32 v126, v105, v123
    v_fma_f32 v128, -v126, v122, v105
    v_fma_f32 v105, v128, v123, v126
    v_cvt_pk_bf16_f32 v38, v104, v105
    v_sub_f32 v106, v106, v121
    v_sub_f32 v107, v107, v121
    v_cvt_pk_bf16_f32 v39, v106, v107
    v_lshlrev_b32 v106, 16, v39
    v_and_b32 v107, 0xffff0000, v39
    v_mul_f32 v125, v106, v123
    v_fma_f32 v127, -v125, v122, v106
    v_fma_f32 v106, v127, v123, v125
    v_mul_f32 v126, v107, v123
    v_fma_f32 v128, -v126, v122, v107
    v_fma_f32 v107, v128, v123, v126
    v_cvt_pk_bf16_f32 v39, v106, v107
    v_sub_f32 v108, v108, v121
    v_sub_f32 v109, v109, v121
    v_cvt_pk_bf16_f32 v40, v108, v109
    v_lshlrev_b32 v108, 16, v40
    v_and_b32 v109, 0xffff0000, v40
    v_mul_f32 v125, v108, v123
    v_fma_f32 v127, -v125, v122, v108
    v_fma_f32 v108, v127, v123, v125
    v_mul_f32 v126, v109, v123
    v_fma_f32 v128, -v126, v122, v109
    v_fma_f32 v109, v128, v123, v126
    v_cvt_pk_bf16_f32 v40, v108, v109
    v_sub_f32 v110, v110, v121
    v_sub_f32 v111, v111, v121
    v_cvt_pk_bf16_f32 v41, v110, v111
    v_lshlrev_b32 v110, 16, v41
    v_and_b32 v111, 0xffff0000, v41
    v_mul_f32 v125, v110, v123
    v_fma_f32 v127, -v125, v122, v110
    v_fma_f32 v110, v127, v123, v125
    v_mul_f32 v126, v111, v123
    v_fma_f32 v128, -v126, v122, v111
    v_fma_f32 v111, v128, v123, v126
    v_cvt_pk_bf16_f32 v41, v110, v111
    v_sub_f32 v112, v112, v121
    v_sub_f32 v113, v113, v121
    v_cvt_pk_bf16_f32 v42, v112, v113
    v_lshlrev_b32 v112, 16, v42
    v_and_b32 v113, 0xffff0000, v42
    v_mul_f32 v125, v112, v123
    v_fma_f32 v127, -v125, v122, v112
    v_fma_f32 v112, v127, v123, v125
    v_mul_f32 v126, v113, v123
    v_fma_f32 v128, -v126, v122, v113
    v_fma_f32 v113, v128, v123, v126
    v_cvt_pk_bf16_f32 v42, v112, v113
    v_sub_f32 v114, v114, v121
    v_sub_f32 v115, v115, v121
    v_cvt_pk_bf16_f32 v43, v114, v115
    v_lshlrev_b32 v114, 16, v43
    v_and_b32 v115, 0xffff0000, v43
    v_mul_f32 v125, v114, v123
    v_fma_f32 v127, -v125, v122, v114
    v_fma_f32 v114, v127, v123, v125
    v_mul_f32 v126, v115, v123
    v_fma_f32 v128, -v126, v122, v115
    v_fma_f32 v115, v128, v123, v126
    v_cvt_pk_bf16_f32 v43, v114, v115
    buffer_store_dwordx4 v[8:11], v3, s[36:39], 0 offen offset:0
    buffer_store_dwordx4 v[12:15], v3, s[36:39], 0 offen offset:128
    buffer_store_dwordx4 v[16:19], v3, s[36:39], 0 offen offset:256
    buffer_store_dwordx4 v[20:23], v3, s[36:39], 0 offen offset:384
    buffer_store_dwordx4 v[24:27], v3, s[36:39], 0 offen offset:512
    buffer_store_dwordx4 v[28:31], v3, s[36:39], 0 offen offset:640
    buffer_store_dwordx4 v[32:35], v3, s[36:39], 0 offen offset:768
    buffer_store_dwordx4 v[36:39], v3, s[36:39], 0 offen offset:896
    buffer_store_dwordx4 v[40:43], v3, s[36:39], 0 offen offset:1024
L_ln0_kernel_end:
    s_endpgm
.globl qkv_kernel
.p2align 8
.type qkv_kernel,@function
qkv_kernel:
    s_cmp_ge_u32 s2, 256
    s_cbranch_scc1 L_qkv_kernel_end
    s_load_dwordx16 s[4:19], s[0:1], 0
    s_load_dwordx8 s[20:27], s[0:1], 64
    v_lshrrev_b32 v1, 6, v0
    s_nop 0
    v_readfirstlane_b32 s36, v1
    v_and_b32 v1, 63, v0
    s_lshl_b32 s37, s36, 10
    v_and_b32 v148, 15, v1
    v_lshlrev_b32 v148, 7, v148
    v_lshrrev_b32 v149, 4, v1
    v_and_b32 v150, 7, v1
    v_xor_b32 v149, v149, v150
    v_lshl_add_u32 v151, v149, 4, v148
    v_xor_b32 v152, 64, v151
    s_mov_b32 s38, s36
    s_mov_b32 s39, 0
    s_mul_i32 s40, s38, 8192
    s_mul_i32 s41, s39, 8192
    s_add_u32 s41, s41, 32768
    v_add_u32 v12, s40, v151
    v_add_u32 v13, s40, v152
    v_add_u32 v14, s41, v151
    v_add_u32 v15, s41, v152
    s_mov_b32 s42, s38
    s_mov_b32 s43, s39
    s_and_b32 s51, s2, 7
    s_lshr_b32 s52, s2, 3
    s_lshl_b32 s53, s51, 8
    s_mul_i32 s54, s52, 18
    s_waitcnt lgkmcnt(0)
    s_add_u32 s28, s26, 0x298000
    s_addc_u32 s29, s27, 0
    s_and_b32 s29, s29, 0xffff
    s_mov_b32 s30, 0x240000
    s_mov_b32 s31, 0x00020000
    s_mov_b32 s32, s26
    s_mov_b32 s33, s27
    s_and_b32 s33, s33, 0xffff
    s_mov_b32 s34, 0x1e6000
    s_mov_b32 s35, 0x00020000
    v_mov_b32 v155, 558
    v_lshrrev_b32 v148, 3, v1
    v_and_b32 v149, 7, v1
    v_xor_b32 v149, v149, v148
    v_lshlrev_b32 v149, 4, v149
    s_lshl_b32 s44, s36, 3
    v_add_u32 v148, s44, v148
    s_mov_b32 s45, 1152
    s_mov_b32 s46, 1152
    v_add_u32 v150, 0, v148
    v_add_u32 v150, s53, v150
    v_mul_lo_u32 v150, v150, s45
    v_add_u32 v2, v150, v149
    v_add_u32 v150, 32, v148
    v_add_u32 v150, s53, v150
    v_mul_lo_u32 v150, v150, s45
    v_add_u32 v3, v150, v149
    v_add_u32 v150, 64, v148
    v_add_u32 v150, s53, v150
    v_mul_lo_u32 v150, v150, s45
    v_add_u32 v4, v150, v149
    v_add_u32 v150, 96, v148
    v_add_u32 v150, s53, v150
    v_mul_lo_u32 v150, v150, s45
    v_add_u32 v5, v150, v149
    v_add_u32 v150, 128, v148
    v_add_u32 v150, s53, v150
    v_mul_lo_u32 v150, v150, s45
    v_add_u32 v6, v150, v149
    v_add_u32 v150, 160, v148
    v_add_u32 v150, s53, v150
    v_mul_lo_u32 v150, v150, s45
    v_add_u32 v7, v150, v149
    v_add_u32 v150, 192, v148
    v_add_u32 v150, s53, v150
    v_mul_lo_u32 v150, v150, s45
    v_add_u32 v8, v150, v149
    v_add_u32 v150, 224, v148
    v_add_u32 v150, s53, v150
    v_mul_lo_u32 v150, v150, s45
    v_add_u32 v9, v150, v149
    v_add_u32 v150, 0, v148
    v_cmp_le_u32 vcc, 18, v150
    s_nop 1
    v_cndmask_b32 v151, 0, v155, vcc
    v_add_u32 v151, v151, v150
    v_cmp_le_u32 vcc, 36, v150
    s_nop 1
    v_cndmask_b32 v152, 0, v155, vcc
    v_add_u32 v151, v151, v152
    v_add_u32 v151, s54, v151
    v_cmp_gt_u32 vcc, 54, v150
    s_nop 1
    v_cndmask_b32 v150, 0, v151, vcc
    v_mul_lo_u32 v150, v150, s46
    v_add_u32 v10, v150, v149
    v_add_u32 v150, 32, v148
    v_cmp_le_u32 vcc, 18, v150
    s_nop 1
    v_cndmask_b32 v151, 0, v155, vcc
    v_add_u32 v151, v151, v150
    v_cmp_le_u32 vcc, 36, v150
    s_nop 1
    v_cndmask_b32 v152, 0, v155, vcc
    v_add_u32 v151, v151, v152
    v_add_u32 v151, s54, v151
    v_cmp_gt_u32 vcc, 54, v150
    s_nop 1
    v_cndmask_b32 v150, 0, v151, vcc
    v_mul_lo_u32 v150, v150, s46
    v_add_u32 v11, v150, v149
    v_mov_b32 v84, 0
    v_mov_b32 v85, 0
    v_mov_b32 v86, 0
    v_mov_b32 v87, 0
    v_mov_b32 v88, 0
    v_mov_b32 v89, 0
    v_mov_b32 v90, 0
    v_mov_b32 v91, 0
    v_mov_b32 v92, 0
    v_mov_b32 v93, 0
    v_mov_b32 v94, 0
    v_mov_b32 v95, 0
    v_mov_b32 v96, 0
    v_mov_b32 v97, 0
    v_mov_b32 v98, 0
    v_mov_b32 v99, 0
    v_mov_b32 v100, 0
    v_mov_b32 v101, 0
    v_mov_b32 v102, 0
    v_mov_b32 v103, 0
    v_mov_b32 v104, 0
    v_mov_b32 v105, 0
    v_mov_b32 v106, 0
    v_mov_b32 v107, 0
    v_mov_b32 v108, 0
    v_mov_b32 v109, 0
    v_mov_b32 v110, 0
    v_mov_b32 v111, 0
    v_mov_b32 v112, 0
    v_mov_b32 v113, 0
    v_mov_b32 v114, 0
    v_mov_b32 v115, 0
    v_mov_b32 v116, 0
    v_mov_b32 v117, 0
    v_mov_b32 v118, 0
    v_mov_b32 v119, 0
    v_mov_b32 v120, 0
    v_mov_b32 v121, 0
    v_mov_b32 v122, 0
    v_mov_b32 v123, 0
    v_mov_b32 v124, 0
    v_mov_b32 v125, 0
    v_mov_b32 v126, 0
    v_mov_b32 v127, 0
    v_mov_b32 v128, 0
    v_mov_b32 v129, 0
    v_mov_b32 v130, 0
    v_mov_b32 v131, 0
    v_mov_b32 v132, 0
    v_mov_b32 v133, 0
    v_mov_b32 v134, 0
    v_mov_b32 v135, 0
    v_mov_b32 v136, 0
    v_mov_b32 v137, 0
    v_mov_b32 v138, 0
    v_mov_b32 v139, 0
    v_mov_b32 v140, 0
    v_mov_b32 v141, 0
    v_mov_b32 v142, 0
    v_mov_b32 v143, 0
    v_mov_b32 v144, 0
    v_mov_b32 v145, 0
    v_mov_b32 v146, 0
    v_mov_b32 v147, 0
    s_mov_b32 s47, 0
    s_mov_b32 s48, 0
    s_add_u32 m0, s37, 0
    s_nop 0
    buffer_load_dwordx4 v2, s[28:31], s47 offen lds
    s_add_u32 m0, s37, 4096
    s_nop 0
    buffer_load_dwordx4 v3, s[28:31], s47 offen lds
    s_add_u32 m0, s37, 8192
    s_nop 0
    buffer_load_dwordx4 v4, s[28:31], s47 offen lds
    s_add_u32 m0, s37, 12288
    s_nop 0
    buffer_load_dwordx4 v5, s[28:31], s47 offen lds
    s_add_u32 m0, s37, 16384
    s_nop 0
    buffer_load_dwordx4 v6, s[28:31], s47 offen lds
    s_add_u32 m0, s37, 20480
    s_nop 0
    buffer_load_dwordx4 v7, s[28:31], s47 offen lds
    s_add_u32 m0, s37, 24576
    s_nop 0
    buffer_load_dwordx4 v8, s[28:31], s47 offen lds
    s_add_u32 m0, s37, 28672
    s_nop 0
    buffer_load_dwordx4 v9, s[28:31], s47 offen lds
    s_add_u32 m0, s37, 32768
    s_nop 0
    buffer_load_dwordx4 v10, s[32:35], s48 offen lds
    s_add_u32 m0, s37, 36864
    s_nop 0
    buffer_load_dwordx4 v11, s[32:35], s48 offen lds
    s_add_u32 s47, s47, 128
    s_add_u32 s48, s48, 128
    s_add_u32 m0, s37, 40960
    s_nop 0
    buffer_load_dwordx4 v2, s[28:31], s47 offen lds
    s_add_u32 m0, s37, 45056
    s_nop 0
    buffer_load_dwordx4 v3, s[28:31], s47 offen lds
    s_add_u32 m0, s37, 49152
    s_nop 0
    buffer_load_dwordx4 v4, s[28:31], s47 offen lds
    s_add_u32 m0, s37, 53248
    s_nop 0
    buffer_load_dwordx4 v5, s[28:31], s47 offen lds
    s_add_u32 m0, s37, 57344
    s_nop 0
    buffer_load_dwordx4 v6, s[28:31], s47 offen lds
    s_add_u32 m0, s37, 61440
    s_nop 0
    buffer_load_dwordx4 v7, s[28:31], s47 offen lds
    s_add_u32 m0, s37, 65536
    s_nop 0
    buffer_load_dwordx4 v8, s[28:31], s47 offen lds
    s_add_u32 m0, s37, 69632
    s_nop 0
    buffer_load_dwordx4 v9, s[28:31], s47 offen lds
    s_add_u32 m0, s37, 73728
    s_nop 0
    buffer_load_dwordx4 v10, s[32:35], s48 offen lds
    s_add_u32 m0, s37, 77824
    s_nop 0
    buffer_load_dwordx4 v11, s[32:35], s48 offen lds
    s_add_u32 s47, s47, 128
    s_add_u32 s48, s48, 128
    s_mov_b32 s49, 2
L_qkv_kernel_loop:
    s_waitcnt vmcnt(10)
    s_barrier
    s_add_u32 m0, s37, 81920
    s_nop 0
    buffer_load_dwordx4 v2, s[28:31], s47 offen lds
    s_add_u32 m0, s37, 86016
    s_nop 0
    buffer_load_dwordx4 v3, s[28:31], s47 offen lds
    s_add_u32 m0, s37, 90112
    s_nop 0
    buffer_load_dwordx4 v4, s[28:31], s47 offen lds
    s_add_u32 m0, s37, 94208
    s_nop 0
    buffer_load_dwordx4 v5, s[28:31], s47 offen lds
    s_add_u32 m0, s37, 98304
    s_nop 0
    buffer_load_dwordx4 v6, s[28:31], s47 offen lds
    s_add_u32 m0, s37, 102400
    s_nop 0
    buffer_load_dwordx4 v7, s[28:31], s47 offen lds
    s_add_u32 m0, s37, 106496
    s_nop 0
    buffer_load_dwordx4 v8, s[28:31], s47 offen lds
    s_add_u32 m0, s37, 110592
    s_nop 0
    buffer_load_dwordx4 v9, s[28:31], s47 offen lds
    s_add_u32 m0, s37, 114688
    s_nop 0
    buffer_load_dwordx4 v10, s[32:35], s48 offen lds
    s_add_u32 m0, s37, 118784
    s_nop 0
    buffer_load_dwordx4 v11, s[32:35], s48 offen lds
    s_add_u32 s47, s47, 128
    s_add_u32 s48, s48, 128
    ds_read_b128 v[20:23], v12 offset:0
    ds_read_b128 v[28:31], v12 offset:2048
    ds_read_b128 v[36:39], v12 offset:4096
    ds_read_b128 v[44:47], v12 offset:6144
    ds_read_b128 v[52:55], v14 offset:0
    ds_read_b128 v[60:63], v14 offset:2048
    ds_read_b128 v[68:71], v14 offset:4096
    ds_read_b128 v[76:79], v14 offset:6144
    ds_read_b128 v[24:27], v13 offset:0
    ds_read_b128 v[32:35], v13 offset:2048
    ds_read_b128 v[40:43], v13 offset:4096
    ds_read_b128 v[48:51], v13 offset:6144
    ds_read_b128 v[56:59], v15 offset:0
    ds_read_b128 v[64:67], v15 offset:2048
    ds_read_b128 v[72:75], v15 offset:4096
    ds_read_b128 v[80:83], v15 offset:6144
    s_waitcnt lgkmcnt(8)
    v_mfma_f32_16x16x32_bf16 v[84:87], v[20:23], v[52:55], v[84:87]
    v_mfma_f32_16x16x32_bf16 v[88:91], v[20:23], v[60:63], v[88:91]
    v_mfma_f32_16x16x32_bf16 v[92:95], v[20:23], v[68:71], v[92:95]
    v_mfma_f32_16x16x32_bf16 v[96:99], v[20:23], v[76:79], v[96:99]
    v_mfma_f32_16x16x32_bf16 v[100:103], v[28:31], v[52:55], v[100:103]
    v_mfma_f32_16x16x32_bf16 v[104:107], v[28:31], v[60:63], v[104:107]
    v_mfma_f32_16x16x32_bf16 v[108:111], v[28:31], v[68:71], v[108:111]
    v_mfma_f32_16x16x32_bf16 v[112:115], v[28:31], v[76:79], v[112:115]
    v_mfma_f32_16x16x32_bf16 v[116:119], v[36:39], v[52:55], v[116:119]
    v_mfma_f32_16x16x32_bf16 v[120:123], v[36:39], v[60:63], v[120:123]
    v_mfma_f32_16x16x32_bf16 v[124:127], v[36:39], v[68:71], v[124:127]
    v_mfma_f32_16x16x32_bf16 v[128:131], v[36:39], v[76:79], v[128:131]
    v_mfma_f32_16x16x32_bf16 v[132:135], v[44:47], v[52:55], v[132:135]
    v_mfma_f32_16x16x32_bf16 v[136:139], v[44:47], v[60:63], v[136:139]
    v_mfma_f32_16x16x32_bf16 v[140:143], v[44:47], v[68:71], v[140:143]
    v_mfma_f32_16x16x32_bf16 v[144:147], v[44:47], v[76:79], v[144:147]
    s_waitcnt lgkmcnt(0)
    v_mfma_f32_16x16x32_bf16 v[84:87], v[24:27], v[56:59], v[84:87]
    v_mfma_f32_16x16x32_bf16 v[88:91], v[24:27], v[64:67], v[88:91]
    v_mfma_f32_16x16x32_bf16 v[92:95], v[24:27], v[72:75], v[92:95]
    v_mfma_f32_16x16x32_bf16 v[96:99], v[24:27], v[80:83], v[96:99]
    v_mfma_f32_16x16x32_bf16 v[100:103], v[32:35], v[56:59], v[100:103]
    v_mfma_f32_16x16x32_bf16 v[104:107], v[32:35], v[64:67], v[104:107]
    v_mfma_f32_16x16x32_bf16 v[108:111], v[32:35], v[72:75], v[108:111]
    v_mfma_f32_16x16x32_bf16 v[112:115], v[32:35], v[80:83], v[112:115]
    v_mfma_f32_16x16x32_bf16 v[116:119], v[40:43], v[56:59], v[116:119]
    v_mfma_f32_16x16x32_bf16 v[120:123], v[40:43], v[64:67], v[120:123]
    v_mfma_f32_16x16x32_bf16 v[124:127], v[40:43], v[72:75], v[124:127]
    v_mfma_f32_16x16x32_bf16 v[128:131], v[40:43], v[80:83], v[128:131]
    v_mfma_f32_16x16x32_bf16 v[132:135], v[48:51], v[56:59], v[132:135]
    v_mfma_f32_16x16x32_bf16 v[136:139], v[48:51], v[64:67], v[136:139]
    v_mfma_f32_16x16x32_bf16 v[140:143], v[48:51], v[72:75], v[140:143]
    v_mfma_f32_16x16x32_bf16 v[144:147], v[48:51], v[80:83], v[144:147]
    s_waitcnt vmcnt(10)
    s_barrier
    s_add_u32 m0, s37, 0
    s_nop 0
    buffer_load_dwordx4 v2, s[28:31], s47 offen lds
    s_add_u32 m0, s37, 4096
    s_nop 0
    buffer_load_dwordx4 v3, s[28:31], s47 offen lds
    s_add_u32 m0, s37, 8192
    s_nop 0
    buffer_load_dwordx4 v4, s[28:31], s47 offen lds
    s_add_u32 m0, s37, 12288
    s_nop 0
    buffer_load_dwordx4 v5, s[28:31], s47 offen lds
    s_add_u32 m0, s37, 16384
    s_nop 0
    buffer_load_dwordx4 v6, s[28:31], s47 offen lds
    s_add_u32 m0, s37, 20480
    s_nop 0
    buffer_load_dwordx4 v7, s[28:31], s47 offen lds
    s_add_u32 m0, s37, 24576
    s_nop 0
    buffer_load_dwordx4 v8, s[28:31], s47 offen lds
    s_add_u32 m0, s37, 28672
    s_nop 0
    buffer_load_dwordx4 v9, s[28:31], s47 offen lds
    s_add_u32 m0, s37, 32768
    s_nop 0
    buffer_load_dwordx4 v10, s[32:35], s48 offen lds
    s_add_u32 m0, s37, 36864
    s_nop 0
    buffer_load_dwordx4 v11, s[32:35], s48 offen lds
    s_add_u32 s47, s47, 128
    s_add_u32 s48, s48, 128
    v_add_u32 v16, 40960, v12
    v_add_u32 v17, 40960, v13
    v_add_u32 v18, 40960, v14
    v_add_u32 v19, 40960, v15
    ds_read_b128 v[20:23], v16 offset:0
    ds_read_b128 v[28:31], v16 offset:2048
    ds_read_b128 v[36:39], v16 offset:4096
    ds_read_b128 v[44:47], v16 offset:6144
    ds_read_b128 v[52:55], v18 offset:0
    ds_read_b128 v[60:63], v18 offset:2048
    ds_read_b128 v[68:71], v18 offset:4096
    ds_read_b128 v[76:79], v18 offset:6144
    ds_read_b128 v[24:27], v17 offset:0
    ds_read_b128 v[32:35], v17 offset:2048
    ds_read_b128 v[40:43], v17 offset:4096
    ds_read_b128 v[48:51], v17 offset:6144
    ds_read_b128 v[56:59], v19 offset:0
    ds_read_b128 v[64:67], v19 offset:2048
    ds_read_b128 v[72:75], v19 offset:4096
    ds_read_b128 v[80:83], v19 offset:6144
    s_waitcnt lgkmcnt(8)
    v_mfma_f32_16x16x32_bf16 v[84:87], v[20:23], v[52:55], v[84:87]
    v_mfma_f32_16x16x32_bf16 v[88:91], v[20:23], v[60:63], v[88:91]
    v_mfma_f32_16x16x32_bf16 v[92:95], v[20:23], v[68:71], v[92:95]
    v_mfma_f32_16x16x32_bf16 v[96:99], v[20:23], v[76:79], v[96:99]
    v_mfma_f32_16x16x32_bf16 v[100:103], v[28:31], v[52:55], v[100:103]
    v_mfma_f32_16x16x32_bf16 v[104:107], v[28:31], v[60:63], v[104:107]
    v_mfma_f32_16x16x32_bf16 v[108:111], v[28:31], v[68:71], v[108:111]
    v_mfma_f32_16x16x32_bf16 v[112:115], v[28:31], v[76:79], v[112:115]
    v_mfma_f32_16x16x32_bf16 v[116:119], v[36:39], v[52:55], v[116:119]
    v_mfma_f32_16x16x32_bf16 v[120:123], v[36:39], v[60:63], v[120:123]
    v_mfma_f32_16x16x32_bf16 v[124:127], v[36:39], v[68:71], v[124:127]
    v_mfma_f32_16x16x32_bf16 v[128:131], v[36:39], v[76:79], v[128:131]
    v_mfma_f32_16x16x32_bf16 v[132:135], v[44:47], v[52:55], v[132:135]
    v_mfma_f32_16x16x32_bf16 v[136:139], v[44:47], v[60:63], v[136:139]
    v_mfma_f32_16x16x32_bf16 v[140:143], v[44:47], v[68:71], v[140:143]
    v_mfma_f32_16x16x32_bf16 v[144:147], v[44:47], v[76:79], v[144:147]
    s_waitcnt lgkmcnt(0)
    v_mfma_f32_16x16x32_bf16 v[84:87], v[24:27], v[56:59], v[84:87]
    v_mfma_f32_16x16x32_bf16 v[88:91], v[24:27], v[64:67], v[88:91]
    v_mfma_f32_16x16x32_bf16 v[92:95], v[24:27], v[72:75], v[92:95]
    v_mfma_f32_16x16x32_bf16 v[96:99], v[24:27], v[80:83], v[96:99]
    v_mfma_f32_16x16x32_bf16 v[100:103], v[32:35], v[56:59], v[100:103]
    v_mfma_f32_16x16x32_bf16 v[104:107], v[32:35], v[64:67], v[104:107]
    v_mfma_f32_16x16x32_bf16 v[108:111], v[32:35], v[72:75], v[108:111]
    v_mfma_f32_16x16x32_bf16 v[112:115], v[32:35], v[80:83], v[112:115]
    v_mfma_f32_16x16x32_bf16 v[116:119], v[40:43], v[56:59], v[116:119]
    v_mfma_f32_16x16x32_bf16 v[120:123], v[40:43], v[64:67], v[120:123]
    v_mfma_f32_16x16x32_bf16 v[124:127], v[40:43], v[72:75], v[124:127]
    v_mfma_f32_16x16x32_bf16 v[128:131], v[40:43], v[80:83], v[128:131]
    v_mfma_f32_16x16x32_bf16 v[132:135], v[48:51], v[56:59], v[132:135]
    v_mfma_f32_16x16x32_bf16 v[136:139], v[48:51], v[64:67], v[136:139]
    v_mfma_f32_16x16x32_bf16 v[140:143], v[48:51], v[72:75], v[140:143]
    v_mfma_f32_16x16x32_bf16 v[144:147], v[48:51], v[80:83], v[144:147]
    s_waitcnt vmcnt(10)
    s_barrier
    s_add_u32 m0, s37, 40960
    s_nop 0
    buffer_load_dwordx4 v2, s[28:31], s47 offen lds
    s_add_u32 m0, s37, 45056
    s_nop 0
    buffer_load_dwordx4 v3, s[28:31], s47 offen lds
    s_add_u32 m0, s37, 49152
    s_nop 0
    buffer_load_dwordx4 v4, s[28:31], s47 offen lds
    s_add_u32 m0, s37, 53248
    s_nop 0
    buffer_load_dwordx4 v5, s[28:31], s47 offen lds
    s_add_u32 m0, s37, 57344
    s_nop 0
    buffer_load_dwordx4 v6, s[28:31], s47 offen lds
    s_add_u32 m0, s37, 61440
    s_nop 0
    buffer_load_dwordx4 v7, s[28:31], s47 offen lds
    s_add_u32 m0, s37, 65536
    s_nop 0
    buffer_load_dwordx4 v8, s[28:31], s47 offen lds
    s_add_u32 m0, s37, 69632
    s_nop 0
    buffer_load_dwordx4 v9, s[28:31], s47 offen lds
    s_add_u32 m0, s37, 73728
    s_nop 0
    buffer_load_dwordx4 v10, s[32:35], s48 offen lds
    s_add_u32 m0, s37, 77824
    s_nop 0
    buffer_load_dwordx4 v11, s[32:35], s48 offen lds
    s_add_u32 s47, s47, 128
    s_add_u32 s48, s48, 128
    v_add_u32 v16, 81920, v12
    v_add_u32 v17, 81920, v13
    v_add_u32 v18, 81920, v14
    v_add_u32 v19, 81920, v15
    ds_read_b128 v[20:23], v16 offset:0
    ds_read_b128 v[28:31], v16 offset:2048
    ds_read_b128 v[36:39], v16 offset:4096
    ds_read_b128 v[44:47], v16 offset:6144
    ds_read_b128 v[52:55], v18 offset:0
    ds_read_b128 v[60:63], v18 offset:2048
    ds_read_b128 v[68:71], v18 offset:4096
    ds_read_b128 v[76:79], v18 offset:6144
    ds_read_b128 v[24:27], v17 offset:0
    ds_read_b128 v[32:35], v17 offset:2048
    ds_read_b128 v[40:43], v17 offset:4096
    ds_read_b128 v[48:51], v17 offset:6144
    ds_read_b128 v[56:59], v19 offset:0
    ds_read_b128 v[64:67], v19 offset:2048
    ds_read_b128 v[72:75], v19 offset:4096
    ds_read_b128 v[80:83], v19 offset:6144
    s_waitcnt lgkmcnt(8)
    v_mfma_f32_16x16x32_bf16 v[84:87], v[20:23], v[52:55], v[84:87]
    v_mfma_f32_16x16x32_bf16 v[88:91], v[20:23], v[60:63], v[88:91]
    v_mfma_f32_16x16x32_bf16 v[92:95], v[20:23], v[68:71], v[92:95]
    v_mfma_f32_16x16x32_bf16 v[96:99], v[20:23], v[76:79], v[96:99]
    v_mfma_f32_16x16x32_bf16 v[100:103], v[28:31], v[52:55], v[100:103]
    v_mfma_f32_16x16x32_bf16 v[104:107], v[28:31], v[60:63], v[104:107]
    v_mfma_f32_16x16x32_bf16 v[108:111], v[28:31], v[68:71], v[108:111]
    v_mfma_f32_16x16x32_bf16 v[112:115], v[28:31], v[76:79], v[112:115]
    v_mfma_f32_16x16x32_bf16 v[116:119], v[36:39], v[52:55], v[116:119]
    v_mfma_f32_16x16x32_bf16 v[120:123], v[36:39], v[60:63], v[120:123]
    v_mfma_f32_16x16x32_bf16 v[124:127], v[36:39], v[68:71], v[124:127]
    v_mfma_f32_16x16x32_bf16 v[128:131], v[36:39], v[76:79], v[128:131]
    v_mfma_f32_16x16x32_bf16 v[132:135], v[44:47], v[52:55], v[132:135]
    v_mfma_f32_16x16x32_bf16 v[136:139], v[44:47], v[60:63], v[136:139]
    v_mfma_f32_16x16x32_bf16 v[140:143], v[44:47], v[68:71], v[140:143]
    v_mfma_f32_16x16x32_bf16 v[144:147], v[44:47], v[76:79], v[144:147]
    s_waitcnt lgkmcnt(0)
    v_mfma_f32_16x16x32_bf16 v[84:87], v[24:27], v[56:59], v[84:87]
    v_mfma_f32_16x16x32_bf16 v[88:91], v[24:27], v[64:67], v[88:91]
    v_mfma_f32_16x16x32_bf16 v[92:95], v[24:27], v[72:75], v[92:95]
    v_mfma_f32_16x16x32_bf16 v[96:99], v[24:27], v[80:83], v[96:99]
    v_mfma_f32_16x16x32_bf16 v[100:103], v[32:35], v[56:59], v[100:103]
    v_mfma_f32_16x16x32_bf16 v[104:107], v[32:35], v[64:67], v[104:107]
    v_mfma_f32_16x16x32_bf16 v[108:111], v[32:35], v[72:75], v[108:111]
    v_mfma_f32_16x16x32_bf16 v[112:115], v[32:35], v[80:83], v[112:115]
    v_mfma_f32_16x16x32_bf16 v[116:119], v[40:43], v[56:59], v[116:119]
    v_mfma_f32_16x16x32_bf16 v[120:123], v[40:43], v[64:67], v[120:123]
    v_mfma_f32_16x16x32_bf16 v[124:127], v[40:43], v[72:75], v[124:127]
    v_mfma_f32_16x16x32_bf16 v[128:131], v[40:43], v[80:83], v[128:131]
    v_mfma_f32_16x16x32_bf16 v[132:135], v[48:51], v[56:59], v[132:135]
    v_mfma_f32_16x16x32_bf16 v[136:139], v[48:51], v[64:67], v[136:139]
    v_mfma_f32_16x16x32_bf16 v[140:143], v[48:51], v[72:75], v[140:143]
    v_mfma_f32_16x16x32_bf16 v[144:147], v[48:51], v[80:83], v[144:147]
    s_sub_u32 s49, s49, 1
    s_cmp_lg_u32 s49, 0
    s_cbranch_scc1 L_qkv_kernel_loop
    s_waitcnt vmcnt(10)
    s_barrier
    s_add_u32 m0, s37, 81920
    s_nop 0
    buffer_load_dwordx4 v2, s[28:31], s47 offen lds
    s_add_u32 m0, s37, 86016
    s_nop 0
    buffer_load_dwordx4 v3, s[28:31], s47 offen lds
    s_add_u32 m0, s37, 90112
    s_nop 0
    buffer_load_dwordx4 v4, s[28:31], s47 offen lds
    s_add_u32 m0, s37, 94208
    s_nop 0
    buffer_load_dwordx4 v5, s[28:31], s47 offen lds
    s_add_u32 m0, s37, 98304
    s_nop 0
    buffer_load_dwordx4 v6, s[28:31], s47 offen lds
    s_add_u32 m0, s37, 102400
    s_nop 0
    buffer_load_dwordx4 v7, s[28:31], s47 offen lds
    s_add_u32 m0, s37, 106496
    s_nop 0
    buffer_load_dwordx4 v8, s[28:31], s47 offen lds
    s_add_u32 m0, s37, 110592
    s_nop 0
    buffer_load_dwordx4 v9, s[28:31], s47 offen lds
    s_add_u32 m0, s37, 114688
    s_nop 0
    buffer_load_dwordx4 v10, s[32:35], s48 offen lds
    s_add_u32 m0, s37, 118784
    s_nop 0
    buffer_load_dwordx4 v11, s[32:35], s48 offen lds
    s_add_u32 s47, s47, 128
    s_add_u32 s48, s48, 128
    ds_read_b128 v[20:23], v12 offset:0
    ds_read_b128 v[28:31], v12 offset:2048
    ds_read_b128 v[36:39], v12 offset:4096
    ds_read_b128 v[44:47], v12 offset:6144
    ds_read_b128 v[52:55], v14 offset:0
    ds_read_b128 v[60:63], v14 offset:2048
    ds_read_b128 v[68:71], v14 offset:4096
    ds_read_b128 v[76:79], v14 offset:6144
    ds_read_b128 v[24:27], v13 offset:0
    ds_read_b128 v[32:35], v13 offset:2048
    ds_read_b128 v[40:43], v13 offset:4096
    ds_read_b128 v[48:51], v13 offset:6144
    ds_read_b128 v[56:59], v15 offset:0
    ds_read_b128 v[64:67], v15 offset:2048
    ds_read_b128 v[72:75], v15 offset:4096
    ds_read_b128 v[80:83], v15 offset:6144
    s_waitcnt lgkmcnt(8)
    v_mfma_f32_16x16x32_bf16 v[84:87], v[20:23], v[52:55], v[84:87]
    v_mfma_f32_16x16x32_bf16 v[88:91], v[20:23], v[60:63], v[88:91]
    v_mfma_f32_16x16x32_bf16 v[92:95], v[20:23], v[68:71], v[92:95]
    v_mfma_f32_16x16x32_bf16 v[96:99], v[20:23], v[76:79], v[96:99]
    v_mfma_f32_16x16x32_bf16 v[100:103], v[28:31], v[52:55], v[100:103]
    v_mfma_f32_16x16x32_bf16 v[104:107], v[28:31], v[60:63], v[104:107]
    v_mfma_f32_16x16x32_bf16 v[108:111], v[28:31], v[68:71], v[108:111]
    v_mfma_f32_16x16x32_bf16 v[112:115], v[28:31], v[76:79], v[112:115]
    v_mfma_f32_16x16x32_bf16 v[116:119], v[36:39], v[52:55], v[116:119]
    v_mfma_f32_16x16x32_bf16 v[120:123], v[36:39], v[60:63], v[120:123]
    v_mfma_f32_16x16x32_bf16 v[124:127], v[36:39], v[68:71], v[124:127]
    v_mfma_f32_16x16x32_bf16 v[128:131], v[36:39], v[76:79], v[128:131]
    v_mfma_f32_16x16x32_bf16 v[132:135], v[44:47], v[52:55], v[132:135]
    v_mfma_f32_16x16x32_bf16 v[136:139], v[44:47], v[60:63], v[136:139]
    v_mfma_f32_16x16x32_bf16 v[140:143], v[44:47], v[68:71], v[140:143]
    v_mfma_f32_16x16x32_bf16 v[144:147], v[44:47], v[76:79], v[144:147]
    s_waitcnt lgkmcnt(0)
    v_mfma_f32_16x16x32_bf16 v[84:87], v[24:27], v[56:59], v[84:87]
    v_mfma_f32_16x16x32_bf16 v[88:91], v[24:27], v[64:67], v[88:91]
    v_mfma_f32_16x16x32_bf16 v[92:95], v[24:27], v[72:75], v[92:95]
    v_mfma_f32_16x16x32_bf16 v[96:99], v[24:27], v[80:83], v[96:99]
    v_mfma_f32_16x16x32_bf16 v[100:103], v[32:35], v[56:59], v[100:103]
    v_mfma_f32_16x16x32_bf16 v[104:107], v[32:35], v[64:67], v[104:107]
    v_mfma_f32_16x16x32_bf16 v[108:111], v[32:35], v[72:75], v[108:111]
    v_mfma_f32_16x16x32_bf16 v[112:115], v[32:35], v[80:83], v[112:115]
    v_mfma_f32_16x16x32_bf16 v[116:119], v[40:43], v[56:59], v[116:119]
    v_mfma_f32_16x16x32_bf16 v[120:123], v[40:43], v[64:67], v[120:123]
    v_mfma_f32_16x16x32_bf16 v[124:127], v[40:43], v[72:75], v[124:127]
    v_mfma_f32_16x16x32_bf16 v[128:131], v[40:43], v[80:83], v[128:131]
    v_mfma_f32_16x16x32_bf16 v[132:135], v[48:51], v[56:59], v[132:135]
    v_mfma_f32_16x16x32_bf16 v[136:139], v[48:51], v[64:67], v[136:139]
    v_mfma_f32_16x16x32_bf16 v[140:143], v[48:51], v[72:75], v[140:143]
    v_mfma_f32_16x16x32_bf16 v[144:147], v[48:51], v[80:83], v[144:147]
    s_waitcnt vmcnt(10)
    s_barrier
    v_add_u32 v16, 40960, v12
    v_add_u32 v17, 40960, v13
    v_add_u32 v18, 40960, v14
    v_add_u32 v19, 40960, v15
    ds_read_b128 v[20:23], v16 offset:0
    ds_read_b128 v[28:31], v16 offset:2048
    ds_read_b128 v[36:39], v16 offset:4096
    ds_read_b128 v[44:47], v16 offset:6144
    ds_read_b128 v[52:55], v18 offset:0
    ds_read_b128 v[60:63], v18 offset:2048
    ds_read_b128 v[68:71], v18 offset:4096
    ds_read_b128 v[76:79], v18 offset:6144
    ds_read_b128 v[24:27], v17 offset:0
    ds_read_b128 v[32:35], v17 offset:2048
    ds_read_b128 v[40:43], v17 offset:4096
    ds_read_b128 v[48:51], v17 offset:6144
    ds_read_b128 v[56:59], v19 offset:0
    ds_read_b128 v[64:67], v19 offset:2048
    ds_read_b128 v[72:75], v19 offset:4096
    ds_read_b128 v[80:83], v19 offset:6144
    s_waitcnt lgkmcnt(8)
    v_mfma_f32_16x16x32_bf16 v[84:87], v[20:23], v[52:55], v[84:87]
    v_mfma_f32_16x16x32_bf16 v[88:91], v[20:23], v[60:63], v[88:91]
    v_mfma_f32_16x16x32_bf16 v[92:95], v[20:23], v[68:71], v[92:95]
    v_mfma_f32_16x16x32_bf16 v[96:99], v[20:23], v[76:79], v[96:99]
    v_mfma_f32_16x16x32_bf16 v[100:103], v[28:31], v[52:55], v[100:103]
    v_mfma_f32_16x16x32_bf16 v[104:107], v[28:31], v[60:63], v[104:107]
    v_mfma_f32_16x16x32_bf16 v[108:111], v[28:31], v[68:71], v[108:111]
    v_mfma_f32_16x16x32_bf16 v[112:115], v[28:31], v[76:79], v[112:115]
    v_mfma_f32_16x16x32_bf16 v[116:119], v[36:39], v[52:55], v[116:119]
    v_mfma_f32_16x16x32_bf16 v[120:123], v[36:39], v[60:63], v[120:123]
    v_mfma_f32_16x16x32_bf16 v[124:127], v[36:39], v[68:71], v[124:127]
    v_mfma_f32_16x16x32_bf16 v[128:131], v[36:39], v[76:79], v[128:131]
    v_mfma_f32_16x16x32_bf16 v[132:135], v[44:47], v[52:55], v[132:135]
    v_mfma_f32_16x16x32_bf16 v[136:139], v[44:47], v[60:63], v[136:139]
    v_mfma_f32_16x16x32_bf16 v[140:143], v[44:47], v[68:71], v[140:143]
    v_mfma_f32_16x16x32_bf16 v[144:147], v[44:47], v[76:79], v[144:147]
    s_waitcnt lgkmcnt(0)
    v_mfma_f32_16x16x32_bf16 v[84:87], v[24:27], v[56:59], v[84:87]
    v_mfma_f32_16x16x32_bf16 v[88:91], v[24:27], v[64:67], v[88:91]
    v_mfma_f32_16x16x32_bf16 v[92:95], v[24:27], v[72:75], v[92:95]
    v_mfma_f32_16x16x32_bf16 v[96:99], v[24:27], v[80:83], v[96:99]
    v_mfma_f32_16x16x32_bf16 v[100:103], v[32:35], v[56:59], v[100:103]
    v_mfma_f32_16x16x32_bf16 v[104:107], v[32:35], v[64:67], v[104:107]
    v_mfma_f32_16x16x32_bf16 v[108:111], v[32:35], v[72:75], v[108:111]
    v_mfma_f32_16x16x32_bf16 v[112:115], v[32:35], v[80:83], v[112:115]
    v_mfma_f32_16x16x32_bf16 v[116:119], v[40:43], v[56:59], v[116:119]
    v_mfma_f32_16x16x32_bf16 v[120:123], v[40:43], v[64:67], v[120:123]
    v_mfma_f32_16x16x32_bf16 v[124:127], v[40:43], v[72:75], v[124:127]
    v_mfma_f32_16x16x32_bf16 v[128:131], v[40:43], v[80:83], v[128:131]
    v_mfma_f32_16x16x32_bf16 v[132:135], v[48:51], v[56:59], v[132:135]
    v_mfma_f32_16x16x32_bf16 v[136:139], v[48:51], v[64:67], v[136:139]
    v_mfma_f32_16x16x32_bf16 v[140:143], v[48:51], v[72:75], v[140:143]
    v_mfma_f32_16x16x32_bf16 v[144:147], v[48:51], v[80:83], v[144:147]
    s_waitcnt vmcnt(0)
    s_barrier
    v_add_u32 v16, 81920, v12
    v_add_u32 v17, 81920, v13
    v_add_u32 v18, 81920, v14
    v_add_u32 v19, 81920, v15
    ds_read_b128 v[20:23], v16 offset:0
    ds_read_b128 v[28:31], v16 offset:2048
    ds_read_b128 v[36:39], v16 offset:4096
    ds_read_b128 v[44:47], v16 offset:6144
    ds_read_b128 v[52:55], v18 offset:0
    ds_read_b128 v[60:63], v18 offset:2048
    ds_read_b128 v[68:71], v18 offset:4096
    ds_read_b128 v[76:79], v18 offset:6144
    ds_read_b128 v[24:27], v17 offset:0
    ds_read_b128 v[32:35], v17 offset:2048
    ds_read_b128 v[40:43], v17 offset:4096
    ds_read_b128 v[48:51], v17 offset:6144
    ds_read_b128 v[56:59], v19 offset:0
    ds_read_b128 v[64:67], v19 offset:2048
    ds_read_b128 v[72:75], v19 offset:4096
    ds_read_b128 v[80:83], v19 offset:6144
    s_waitcnt lgkmcnt(8)
    v_mfma_f32_16x16x32_bf16 v[84:87], v[20:23], v[52:55], v[84:87]
    v_mfma_f32_16x16x32_bf16 v[88:91], v[20:23], v[60:63], v[88:91]
    v_mfma_f32_16x16x32_bf16 v[92:95], v[20:23], v[68:71], v[92:95]
    v_mfma_f32_16x16x32_bf16 v[96:99], v[20:23], v[76:79], v[96:99]
    v_mfma_f32_16x16x32_bf16 v[100:103], v[28:31], v[52:55], v[100:103]
    v_mfma_f32_16x16x32_bf16 v[104:107], v[28:31], v[60:63], v[104:107]
    v_mfma_f32_16x16x32_bf16 v[108:111], v[28:31], v[68:71], v[108:111]
    v_mfma_f32_16x16x32_bf16 v[112:115], v[28:31], v[76:79], v[112:115]
    v_mfma_f32_16x16x32_bf16 v[116:119], v[36:39], v[52:55], v[116:119]
    v_mfma_f32_16x16x32_bf16 v[120:123], v[36:39], v[60:63], v[120:123]
    v_mfma_f32_16x16x32_bf16 v[124:127], v[36:39], v[68:71], v[124:127]
    v_mfma_f32_16x16x32_bf16 v[128:131], v[36:39], v[76:79], v[128:131]
    v_mfma_f32_16x16x32_bf16 v[132:135], v[44:47], v[52:55], v[132:135]
    v_mfma_f32_16x16x32_bf16 v[136:139], v[44:47], v[60:63], v[136:139]
    v_mfma_f32_16x16x32_bf16 v[140:143], v[44:47], v[68:71], v[140:143]
    v_mfma_f32_16x16x32_bf16 v[144:147], v[44:47], v[76:79], v[144:147]
    s_waitcnt lgkmcnt(0)
    v_mfma_f32_16x16x32_bf16 v[84:87], v[24:27], v[56:59], v[84:87]
    v_mfma_f32_16x16x32_bf16 v[88:91], v[24:27], v[64:67], v[88:91]
    v_mfma_f32_16x16x32_bf16 v[92:95], v[24:27], v[72:75], v[92:95]
    v_mfma_f32_16x16x32_bf16 v[96:99], v[24:27], v[80:83], v[96:99]
    v_mfma_f32_16x16x32_bf16 v[100:103], v[32:35], v[56:59], v[100:103]
    v_mfma_f32_16x16x32_bf16 v[104:107], v[32:35], v[64:67], v[104:107]
    v_mfma_f32_16x16x32_bf16 v[108:111], v[32:35], v[72:75], v[108:111]
    v_mfma_f32_16x16x32_bf16 v[112:115], v[32:35], v[80:83], v[112:115]
    v_mfma_f32_16x16x32_bf16 v[116:119], v[40:43], v[56:59], v[116:119]
    v_mfma_f32_16x16x32_bf16 v[120:123], v[40:43], v[64:67], v[120:123]
    v_mfma_f32_16x16x32_bf16 v[124:127], v[40:43], v[72:75], v[124:127]
    v_mfma_f32_16x16x32_bf16 v[128:131], v[40:43], v[80:83], v[128:131]
    v_mfma_f32_16x16x32_bf16 v[132:135], v[48:51], v[56:59], v[132:135]
    v_mfma_f32_16x16x32_bf16 v[136:139], v[48:51], v[64:67], v[136:139]
    v_mfma_f32_16x16x32_bf16 v[140:143], v[48:51], v[72:75], v[140:143]
    v_mfma_f32_16x16x32_bf16 v[144:147], v[48:51], v[80:83], v[144:147]
    s_mov_b32 s28, s26
    s_mov_b32 s29, s27
    s_and_b32 s29, s29, 0xffff
    s_mov_b32 s30, 0x10000000
    s_mov_b32 s31, 0x00020000
    v_lshrrev_b32 v151, 4, v1
    v_lshlrev_b32 v151, 2, v151
    s_lshl_b32 s55, s36, 6
    s_add_u32 s55, s55, s53
    v_add_u32 v151, s55, v151
    s_lshl_b32 s56, s52, 11
    s_lshl_b32 s57, s52, 5
    v_and_b32 v149, 15, v1
    v_cmp_le_u32 vcc, 18, v149
    s_nop 1
    v_cndmask_b32 v150, 0, 18, vcc
    v_sub_u32 v150, v149, v150
    v_mov_b32 v152, 0x4d8000
    v_mov_b32 v153, 0x8d8000
    v_cndmask_b32 v152, v152, v153, vcc
    v_cmp_le_u32 vcc, 36, v149
    s_nop 1
    v_cndmask_b32 v153, 0, 18, vcc
    v_sub_u32 v150, v150, v153
    v_add_u32 v153, s56, v151
    v_lshl_add_u32 v152, v153, 6, v152
    v_lshl_add_u32 v152, v150, 1, v152
    v_add_u32 v153, s57, v150
    v_lshlrev_b32 v153, 12, v153
    v_lshl_add_u32 v153, v151, 1, v153
    v_add_u32 v153, 0xcd8000, v153
    v_cmp_gt_u32 s[58:59], 36, v149
    v_cmp_le_u32 vcc, 36, v149
    v_cmp_gt_u32 s[60:61], 54, v149
    s_and_b64 s[60:61], s[60:61], vcc
    v_cvt_pk_bf16_f32 v154, v84, v85
    v_cvt_pk_bf16_f32 v155, v86, v87
    v_lshrrev_b32 v156, 16, v154
    v_lshrrev_b32 v157, 16, v155
    s_mov_b64 exec, s[58:59]
    buffer_store_short v154, v152, s[28:31], 0 offen offset:0
    buffer_store_short v156, v152, s[28:31], 0 offen offset:64
    buffer_store_short v155, v152, s[28:31], 0 offen offset:128
    buffer_store_short v157, v152, s[28:31], 0 offen offset:192
    s_mov_b64 exec, s[60:61]
    buffer_store_dwordx2 v[154:155], v153, s[28:31], 0 offen offset:0
    s_mov_b64 exec, -1
    v_cvt_pk_bf16_f32 v154, v100, v101
    v_cvt_pk_bf16_f32 v155, v102, v103
    v_lshrrev_b32 v156, 16, v154
    v_lshrrev_b32 v157, 16, v155
    s_mov_b64 exec, s[58:59]
    buffer_store_short v154, v152, s[28:31], 0 offen offset:1024
    buffer_store_short v156, v152, s[28:31], 0 offen offset:1088
    buffer_store_short v155, v152, s[28:31], 0 offen offset:1152
    buffer_store_short v157, v152, s[28:31], 0 offen offset:1216
    s_mov_b64 exec, s[60:61]
    buffer_store_dwordx2 v[154:155], v153, s[28:31], 0 offen offset:32
    s_mov_b64 exec, -1
    v_cvt_pk_bf16_f32 v154, v116, v117
    v_cvt_pk_bf16_f32 v155, v118, v119
    v_lshrrev_b32 v156, 16, v154
    v_lshrrev_b32 v157, 16, v155
    s_mov_b64 exec, s[58:59]
    buffer_store_short v154, v152, s[28:31], 0 offen offset:2048
    buffer_store_short v156, v152, s[28:31], 0 offen offset:2112
    buffer_store_short v155, v152, s[28:31], 0 offen offset:2176
    buffer_store_short v157, v152, s[28:31], 0 offen offset:2240
    s_mov_b64 exec, s[60:61]
    buffer_store_dwordx2 v[154:155], v153, s[28:31], 0 offen offset:64
    s_mov_b64 exec, -1
    v_cvt_pk_bf16_f32 v154, v132, v133
    v_cvt_pk_bf16_f32 v155, v134, v135
    v_lshrrev_b32 v156, 16, v154
    v_lshrrev_b32 v157, 16, v155
    s_mov_b64 exec, s[58:59]
    buffer_store_short v154, v152, s[28:31], 0 offen offset:3072
    buffer_store_short v156, v152, s[28:31], 0 offen offset:3136
    buffer_store_short v155, v152, s[28:31], 0 offen offset:3200
    buffer_store_short v157, v152, s[28:31], 0 offen offset:3264
    s_mov_b64 exec, s[60:61]
    buffer_store_dwordx2 v[154:155], v153, s[28:31], 0 offen offset:96
    s_mov_b64 exec, -1
    v_and_b32 v149, 15, v1
    v_add_u32 v149, 16, v149
    v_cmp_le_u32 vcc, 18, v149
    s_nop 1
    v_cndmask_b32 v150, 0, 18, vcc
    v_sub_u32 v150, v149, v150
    v_mov_b32 v152, 0x4d8000
    v_mov_b32 v153, 0x8d8000
    v_cndmask_b32 v152, v152, v153, vcc
    v_cmp_le_u32 vcc, 36, v149
    s_nop 1
    v_cndmask_b32 v153, 0, 18, vcc
    v_sub_u32 v150, v150, v153
    v_add_u32 v153, s56, v151
    v_lshl_add_u32 v152, v153, 6, v152
    v_lshl_add_u32 v152, v150, 1, v152
    v_add_u32 v153, s57, v150
    v_lshlrev_b32 v153, 12, v153
    v_lshl_add_u32 v153, v151, 1, v153
    v_add_u32 v153, 0xcd8000, v153
    v_cmp_gt_u32 s[58:59], 36, v149
    v_cmp_le_u32 vcc, 36, v149
    v_cmp_gt_u32 s[60:61], 54, v149
    s_and_b64 s[60:61], s[60:61], vcc
    v_cvt_pk_bf16_f32 v154, v88, v89
    v_cvt_pk_bf16_f32 v155, v90, v91
    v_lshrrev_b32 v156, 16, v154
    v_lshrrev_b32 v157, 16, v155
    s_mov_b64 exec, s[58:59]
    buffer_store_short v154, v152, s[28:31], 0 offen offset:0
    buffer_store_short v156, v152, s[28:31], 0 offen offset:64
    buffer_store_short v155, v152, s[28:31], 0 offen offset:128
    buffer_store_short v157, v152, s[28:31], 0 offen offset:192
    s_mov_b64 exec, s[60:61]
    buffer_store_dwordx2 v[154:155], v153, s[28:31], 0 offen offset:0
    s_mov_b64 exec, -1
    v_cvt_pk_bf16_f32 v154, v104, v105
    v_cvt_pk_bf16_f32 v155, v106, v107
    v_lshrrev_b32 v156, 16, v154
    v_lshrrev_b32 v157, 16, v155
    s_mov_b64 exec, s[58:59]
    buffer_store_short v154, v152, s[28:31], 0 offen offset:1024
    buffer_store_short v156, v152, s[28:31], 0 offen offset:1088
    buffer_store_short v155, v152, s[28:31], 0 offen offset:1152
    buffer_store_short v157, v152, s[28:31], 0 offen offset:1216
    s_mov_b64 exec, s[60:61]
    buffer_store_dwordx2 v[154:155], v153, s[28:31], 0 offen offset:32
    s_mov_b64 exec, -1
    v_cvt_pk_bf16_f32 v154, v120, v121
    v_cvt_pk_bf16_f32 v155, v122, v123
    v_lshrrev_b32 v156, 16, v154
    v_lshrrev_b32 v157, 16, v155
    s_mov_b64 exec, s[58:59]
    buffer_store_short v154, v152, s[28:31], 0 offen offset:2048
    buffer_store_short v156, v152, s[28:31], 0 offen offset:2112
    buffer_store_short v155, v152, s[28:31], 0 offen offset:2176
    buffer_store_short v157, v152, s[28:31], 0 offen offset:2240
    s_mov_b64 exec, s[60:61]
    buffer_store_dwordx2 v[154:155], v153, s[28:31], 0 offen offset:64
    s_mov_b64 exec, -1
    v_cvt_pk_bf16_f32 v154, v136, v137
    v_cvt_pk_bf16_f32 v155, v138, v139
    v_lshrrev_b32 v156, 16, v154
    v_lshrrev_b32 v157, 16, v155
    s_mov_b64 exec, s[58:59]
    buffer_store_short v154, v152, s[28:31], 0 offen offset:3072
    buffer_store_short v156, v152, s[28:31], 0 offen offset:3136
    buffer_store_short v155, v152, s[28:31], 0 offen offset:3200
    buffer_store_short v157, v152, s[28:31], 0 offen offset:3264
    s_mov_b64 exec, s[60:61]
    buffer_store_dwordx2 v[154:155], v153, s[28:31], 0 offen offset:96
    s_mov_b64 exec, -1
    v_and_b32 v149, 15, v1
    v_add_u32 v149, 32, v149
    v_cmp_le_u32 vcc, 18, v149
    s_nop 1
    v_cndmask_b32 v150, 0, 18, vcc
    v_sub_u32 v150, v149, v150
    v_mov_b32 v152, 0x4d8000
    v_mov_b32 v153, 0x8d8000
    v_cndmask_b32 v152, v152, v153, vcc
    v_cmp_le_u32 vcc, 36, v149
    s_nop 1
    v_cndmask_b32 v153, 0, 18, vcc
    v_sub_u32 v150, v150, v153
    v_add_u32 v153, s56, v151
    v_lshl_add_u32 v152, v153, 6, v152
    v_lshl_add_u32 v152, v150, 1, v152
    v_add_u32 v153, s57, v150
    v_lshlrev_b32 v153, 12, v153
    v_lshl_add_u32 v153, v151, 1, v153
    v_add_u32 v153, 0xcd8000, v153
    v_cmp_gt_u32 s[58:59], 36, v149
    v_cmp_le_u32 vcc, 36, v149
    v_cmp_gt_u32 s[60:61], 54, v149
    s_and_b64 s[60:61], s[60:61], vcc
    v_cvt_pk_bf16_f32 v154, v92, v93
    v_cvt_pk_bf16_f32 v155, v94, v95
    v_lshrrev_b32 v156, 16, v154
    v_lshrrev_b32 v157, 16, v155
    s_mov_b64 exec, s[58:59]
    buffer_store_short v154, v152, s[28:31], 0 offen offset:0
    buffer_store_short v156, v152, s[28:31], 0 offen offset:64
    buffer_store_short v155, v152, s[28:31], 0 offen offset:128
    buffer_store_short v157, v152, s[28:31], 0 offen offset:192
    s_mov_b64 exec, s[60:61]
    buffer_store_dwordx2 v[154:155], v153, s[28:31], 0 offen offset:0
    s_mov_b64 exec, -1
    v_cvt_pk_bf16_f32 v154, v108, v109
    v_cvt_pk_bf16_f32 v155, v110, v111
    v_lshrrev_b32 v156, 16, v154
    v_lshrrev_b32 v157, 16, v155
    s_mov_b64 exec, s[58:59]
    buffer_store_short v154, v152, s[28:31], 0 offen offset:1024
    buffer_store_short v156, v152, s[28:31], 0 offen offset:1088
    buffer_store_short v155, v152, s[28:31], 0 offen offset:1152
    buffer_store_short v157, v152, s[28:31], 0 offen offset:1216
    s_mov_b64 exec, s[60:61]
    buffer_store_dwordx2 v[154:155], v153, s[28:31], 0 offen offset:32
    s_mov_b64 exec, -1
    v_cvt_pk_bf16_f32 v154, v124, v125
    v_cvt_pk_bf16_f32 v155, v126, v127
    v_lshrrev_b32 v156, 16, v154
    v_lshrrev_b32 v157, 16, v155
    s_mov_b64 exec, s[58:59]
    buffer_store_short v154, v152, s[28:31], 0 offen offset:2048
    buffer_store_short v156, v152, s[28:31], 0 offen offset:2112
    buffer_store_short v155, v152, s[28:31], 0 offen offset:2176
    buffer_store_short v157, v152, s[28:31], 0 offen offset:2240
    s_mov_b64 exec, s[60:61]
    buffer_store_dwordx2 v[154:155], v153, s[28:31], 0 offen offset:64
    s_mov_b64 exec, -1
    v_cvt_pk_bf16_f32 v154, v140, v141
    v_cvt_pk_bf16_f32 v155, v142, v143
    v_lshrrev_b32 v156, 16, v154
    v_lshrrev_b32 v157, 16, v155
    s_mov_b64 exec, s[58:59]
    buffer_store_short v154, v152, s[28:31], 0 offen offset:3072
    buffer_store_short v156, v152, s[28:31], 0 offen offset:3136
    buffer_store_short v155, v152, s[28:31], 0 offen offset:3200
    buffer_store_short v157, v152, s[28:31], 0 offen offset:3264
    s_mov_b64 exec, s[60:61]
    buffer_store_dwordx2 v[154:155], v153, s[28:31], 0 offen offset:96
    s_mov_b64 exec, -1
    v_and_b32 v149, 15, v1
    v_add_u32 v149, 48, v149
    v_cmp_le_u32 vcc, 18, v149
    s_nop 1
    v_cndmask_b32 v150, 0, 18, vcc
    v_sub_u32 v150, v149, v150
    v_mov_b32 v152, 0x4d8000
    v_mov_b32 v153, 0x8d8000
    v_cndmask_b32 v152, v152, v153, vcc
    v_cmp_le_u32 vcc, 36, v149
    s_nop 1
    v_cndmask_b32 v153, 0, 18, vcc
    v_sub_u32 v150, v150, v153
    v_add_u32 v153, s56, v151
    v_lshl_add_u32 v152, v153, 6, v152
    v_lshl_add_u32 v152, v150, 1, v152
    v_add_u32 v153, s57, v150
    v_lshlrev_b32 v153, 12, v153
    v_lshl_add_u32 v153, v151, 1, v153
    v_add_u32 v153, 0xcd8000, v153
    v_cmp_gt_u32 s[58:59], 36, v149
    v_cmp_le_u32 vcc, 36, v149
    v_cmp_gt_u32 s[60:61], 54, v149
    s_and_b64 s[60:61], s[60:61], vcc
    v_cvt_pk_bf16_f32 v154, v96, v97
    v_cvt_pk_bf16_f32 v155, v98, v99
    v_lshrrev_b32 v156, 16, v154
    v_lshrrev_b32 v157, 16, v155
    s_mov_b64 exec, s[58:59]
    buffer_store_short v154, v152, s[28:31], 0 offen offset:0
    buffer_store_short v156, v152, s[28:31], 0 offen offset:64
    buffer_store_short v155, v152, s[28:31], 0 offen offset:128
    buffer_store_short v157, v152, s[28:31], 0 offen offset:192
    s_mov_b64 exec, s[60:61]
    buffer_store_dwordx2 v[154:155], v153, s[28:31], 0 offen offset:0
    s_mov_b64 exec, -1
    v_cvt_pk_bf16_f32 v154, v112, v113
    v_cvt_pk_bf16_f32 v155, v114, v115
    v_lshrrev_b32 v156, 16, v154
    v_lshrrev_b32 v157, 16, v155
    s_mov_b64 exec, s[58:59]
    buffer_store_short v154, v152, s[28:31], 0 offen offset:1024
    buffer_store_short v156, v152, s[28:31], 0 offen offset:1088
    buffer_store_short v155, v152, s[28:31], 0 offen offset:1152
    buffer_store_short v157, v152, s[28:31], 0 offen offset:1216
    s_mov_b64 exec, s[60:61]
    buffer_store_dwordx2 v[154:155], v153, s[28:31], 0 offen offset:32
    s_mov_b64 exec, -1
    v_cvt_pk_bf16_f32 v154, v128, v129
    v_cvt_pk_bf16_f32 v155, v130, v131
    v_lshrrev_b32 v156, 16, v154
    v_lshrrev_b32 v157, 16, v155
    s_mov_b64 exec, s[58:59]
    buffer_store_short v154, v152, s[28:31], 0 offen offset:2048
    buffer_store_short v156, v152, s[28:31], 0 offen offset:2112
    buffer_store_short v155, v152, s[28:31], 0 offen offset:2176
    buffer_store_short v157, v152, s[28:31], 0 offen offset:2240
    s_mov_b64 exec, s[60:61]
    buffer_store_dwordx2 v[154:155], v153, s[28:31], 0 offen offset:64
    s_mov_b64 exec, -1
    v_cvt_pk_bf16_f32 v154, v144, v145
    v_cvt_pk_bf16_f32 v155, v146, v147
    v_lshrrev_b32 v156, 16, v154
    v_lshrrev_b32 v157, 16, v155
    s_mov_b64 exec, s[58:59]
    buffer_store_short v154, v152, s[28:31], 0 offen offset:3072
    buffer_store_short v156, v152, s[28:31], 0 offen offset:3136
    buffer_store_short v155, v152, s[28:31], 0 offen offset:3200
    buffer_store_short v157, v152, s[28:31], 0 offen offset:3264
    s_mov_b64 exec, s[60:61]
    buffer_store_dwordx2 v[154:155], v153, s[28:31], 0 offen offset:96
    s_mov_b64 exec, -1
L_qkv_kernel_end:
    s_endpgm
.globl kv_kernel
.p2align 8
.type kv_kernel,@function
kv_kernel:
    s_cmp_ge_u32 s2, 256
    s_cbranch_scc1 L_kv_kernel_end
    s_load_dwordx16 s[4:19], s[0:1], 0
    s_load_dwordx8 s[20:27], s[0:1], 64
    v_lshrrev_b32 v1, 6, v0
    s_nop 0
    v_readfirstlane_b32 s36, v1
    v_and_b32 v1, 63, v0
    v_and_b32 v2, 15, v1
    v_lshrrev_b32 v3, 4, v1
    s_and_b32 s51, s2, 7
    s_lshr_b32 s52, s2, 3
    s_lshl_b32 s53, s51, 8
    s_lshl_b32 s54, s36, 6
    s_add_u32 s53, s53, s54
    s_waitcnt lgkmcnt(0)
    s_mov_b32 s28, s26
    s_mov_b32 s29, s27
    s_and_b32 s29, s29, 0xffff
    s_mov_b32 s30, 0x10000000
    s_mov_b32 s31, 0x00020000
    s_lshl_b32 s55, s52, 11
    v_lshlrev_b32 v4, 6, v2
    v_lshl_add_u32 v4, v3, 4, v4
    s_add_u32 s55, s55, 0x288000
    buffer_load_dwordx4 v[8:11], v4, s[28:31], s55 offen
    buffer_load_dwordx4 v[12:15], v4, s[28:31], s55 offen offset:1024
    v_cmp_gt_u32 s[56:57], 2, v2
    v_lshrrev_b32 v5, 2, v2
    v_lshlrev_b32 v5, 3, v5
    v_and_b32 v6, 3, v2
    v_add_u32 v5, v5, v6
    v_lshlrev_b32 v5, 6, v5
    v_lshl_add_u32 v5, v3, 4, v5
    v_lshlrev_b32 v6, 12, v2
    v_lshl_add_u32 v6, v3, 4, v6
    v_mov_b32 v16, 0
    v_mov_b32 v17, 0
    v_mov_b32 v18, 0
    v_mov_b32 v19, 0
    v_mov_b32 v20, 0
    v_mov_b32 v21, 0
    v_mov_b32 v22, 0
    v_mov_b32 v23, 0
    v_mov_b32 v24, 0
    v_mov_b32 v25, 0
    v_mov_b32 v26, 0
    v_mov_b32 v27, 0
    v_mov_b32 v28, 0
    v_mov_b32 v29, 0
    v_mov_b32 v30, 0
    v_mov_b32 v31, 0
    v_mov_b32 v32, 0
    v_mov_b32 v33, 0
    v_mov_b32 v34, 0
    v_mov_b32 v35, 0
    v_mov_b32 v36, 0
    v_mov_b32 v37, 0
    v_mov_b32 v38, 0
    v_mov_b32 v39, 0
    v_mov_b32 v40, 0
    v_mov_b32 v41, 0
    v_mov_b32 v42, 0
    v_mov_b32 v43, 0
    v_mov_b32 v44, 0
    v_mov_b32 v45, 0
    v_mov_b32 v46, 0
    v_mov_b32 v47, 0
    s_lshl_b32 s55, s52, 11
    s_add_u32 s55, s55, s53
    s_add_u32 s55, s55, 0
    s_lshl_b32 s55, s55, 6
    s_add_u32 s55, s55, 0x8d8000
    buffer_load_dwordx4 v[48:51], v5, s[28:31], s55 offen
    buffer_load_dwordx4 v[52:55], v5, s[28:31], s55 offen offset:256
    s_lshl_b32 s58, s52, 17
    s_add_u32 s59, s53, 0
    s_lshl_b32 s59, s59, 1
    s_add_u32 s58, s58, s59
    s_add_u32 s58, s58, 0xcd8000
    buffer_load_dwordx4 v[56:59], v6, s[28:31], s58 offen
    s_add_u32 s58, s58, 65536
    buffer_load_dwordx4 v[60:63], v6, s[28:31], s58 offen
    s_waitcnt vmcnt(2)
    v_mfma_f32_16x16x32_bf16 v[64:67], v[48:51], v[8:11], 0
    v_mfma_f32_16x16x32_bf16 v[68:71], v[48:51], v[12:15], 0
    v_mfma_f32_16x16x32_bf16 v[72:75], v[52:55], v[8:11], 0
    v_mfma_f32_16x16x32_bf16 v[76:79], v[52:55], v[12:15], 0
    s_nop 4
    v_cvt_pk_bf16_f32 v64, v64, v64
    v_lshlrev_b32 v64, 16, v64
    v_cvt_pk_bf16_f32 v65, v65, v65
    v_lshlrev_b32 v65, 16, v65
    v_cvt_pk_bf16_f32 v66, v66, v66
    v_lshlrev_b32 v66, 16, v66
    v_cvt_pk_bf16_f32 v67, v67, v67
    v_lshlrev_b32 v67, 16, v67
    v_cvt_pk_bf16_f32 v68, v68, v68
    v_lshlrev_b32 v68, 16, v68
    v_cvt_pk_bf16_f32 v69, v69, v69
    v_lshlrev_b32 v69, 16, v69
    v_cvt_pk_bf16_f32 v70, v70, v70
    v_lshlrev_b32 v70, 16, v70
    v_cvt_pk_bf16_f32 v71, v71, v71
    v_lshlrev_b32 v71, 16, v71
    v_cvt_pk_bf16_f32 v72, v72, v72
    v_lshlrev_b32 v72, 16, v72
    v_cvt_pk_bf16_f32 v73, v73, v73
    v_lshlrev_b32 v73, 16, v73
    v_cvt_pk_bf16_f32 v74, v74, v74
    v_lshlrev_b32 v74, 16, v74
    v_cvt_pk_bf16_f32 v75, v75, v75
    v_lshlrev_b32 v75, 16, v75
    v_cvt_pk_bf16_f32 v76, v76, v76
    v_lshlrev_b32 v76, 16, v76
    v_cvt_pk_bf16_f32 v77, v77, v77
    v_lshlrev_b32 v77, 16, v77
    v_cvt_pk_bf16_f32 v78, v78, v78
    v_lshlrev_b32 v78, 16, v78
    v_cvt_pk_bf16_f32 v79, v79, v79
    v_lshlrev_b32 v79, 16, v79
    v_mov_b32 v96, v64
    v_mov_b32 v97, 0xff800000
    v_cndmask_b32 v97, v97, v68, s[56:57]
    v_max_f32 v98, v96, v97
    v_mov_b32 v100, v65
    v_mov_b32 v101, 0xff800000
    v_cndmask_b32 v101, v101, v69, s[56:57]
    v_max_f32 v102, v100, v101
    v_mov_b32 v104, v66
    v_mov_b32 v105, 0xff800000
    v_cndmask_b32 v105, v105, v70, s[56:57]
    v_max_f32 v106, v104, v105
    v_mov_b32 v108, v67
    v_mov_b32 v109, 0xff800000
    v_cndmask_b32 v109, v109, v71, s[56:57]
    v_max_f32 v110, v108, v109
    v_mov_b32 v112, v72
    v_mov_b32 v113, 0xff800000
    v_cndmask_b32 v113, v113, v76, s[56:57]
    v_max_f32 v114, v112, v113
    v_mov_b32 v116, v73
    v_mov_b32 v117, 0xff800000
    v_cndmask_b32 v117, v117, v77, s[56:57]
    v_max_f32 v118, v116, v117
    v_mov_b32 v120, v74
    v_mov_b32 v121, 0xff800000
    v_cndmask_b32 v121, v121, v78, s[56:57]
    v_max_f32 v122, v120, v121
    v_mov_b32 v124, v75
    v_mov_b32 v125, 0xff800000
    v_cndmask_b32 v125, v125, v79, s[56:57]
    v_max_f32 v126, v124, v125
    v_max_f32_dpp v98, v98, v98 row_ror:8 row_mask:0xf bank_mask:0xf
    v_max_f32_dpp v102, v102, v102 row_ror:8 row_mask:0xf bank_mask:0xf
    v_max_f32_dpp v106, v106, v106 row_ror:8 row_mask:0xf bank_mask:0xf
    v_max_f32_dpp v110, v110, v110 row_ror:8 row_mask:0xf bank_mask:0xf
    v_max_f32_dpp v114, v114, v114 row_ror:8 row_mask:0xf bank_mask:0xf
    v_max_f32_dpp v118, v118, v118 row_ror:8 row_mask:0xf bank_mask:0xf
    v_max_f32_dpp v122, v122, v122 row_ror:8 row_mask:0xf bank_mask:0xf
    v_max_f32_dpp v126, v126, v126 row_ror:8 row_mask:0xf bank_mask:0xf
    v_max_f32_dpp v98, v98, v98 row_ror:4 row_mask:0xf bank_mask:0xf
    v_max_f32_dpp v102, v102, v102 row_ror:4 row_mask:0xf bank_mask:0xf
    v_max_f32_dpp v106, v106, v106 row_ror:4 row_mask:0xf bank_mask:0xf
    v_max_f32_dpp v110, v110, v110 row_ror:4 row_mask:0xf bank_mask:0xf
    v_max_f32_dpp v114, v114, v114 row_ror:4 row_mask:0xf bank_mask:0xf
    v_max_f32_dpp v118, v118, v118 row_ror:4 row_mask:0xf bank_mask:0xf
    v_max_f32_dpp v122, v122, v122 row_ror:4 row_mask:0xf bank_mask:0xf
    v_max_f32_dpp v126, v126, v126 row_ror:4 row_mask:0xf bank_mask:0xf
    v_max_f32_dpp v98, v98, v98 row_ror:2 row_mask:0xf bank_mask:0xf
    v_max_f32_dpp v102, v102, v102 row_ror:2 row_mask:0xf bank_mask:0xf
    v_max_f32_dpp v106, v106, v106 row_ror:2 row_mask:0xf bank_mask:0xf
    v_max_f32_dpp v110, v110, v110 row_ror:2 row_mask:0xf bank_mask:0xf
    v_max_f32_dpp v114, v114, v114 row_ror:2 row_mask:0xf bank_mask:0xf
    v_max_f32_dpp v118, v118, v118 row_ror:2 row_mask:0xf bank_mask:0xf
    v_max_f32_dpp v122, v122, v122 row_ror:2 row_mask:0xf bank_mask:0xf
    v_max_f32_dpp v126, v126, v126 row_ror:2 row_mask:0xf bank_mask:0xf
    v_max_f32_dpp v98, v98, v98 row_ror:1 row_mask:0xf bank_mask:0xf
    v_max_f32_dpp v102, v102, v102 row_ror:1 row_mask:0xf bank_mask:0xf
    v_max_f32_dpp v106, v106, v106 row_ror:1 row_mask:0xf bank_mask:0xf
    v_max_f32_dpp v110, v110, v110 row_ror:1 row_mask:0xf bank_mask:0xf
    v_max_f32_dpp v114, v114, v114 row_ror:1 row_mask:0xf bank_mask:0xf
    v_max_f32_dpp v118, v118, v118 row_ror:1 row_mask:0xf bank_mask:0xf
    v_max_f32_dpp v122, v122, v122 row_ror:1 row_mask:0xf bank_mask:0xf
    v_max_f32_dpp v126, v126, v126 row_ror:1 row_mask:0xf bank_mask:0xf
    v_sub_f32 v96, v96, v98
    v_sub_f32 v97, v97, v98
    v_mul_f32 v96, 0x3fb8aa3b, v96
    v_mul_f32 v97, 0x3fb8aa3b, v97
    v_exp_f32 v96, v96
    v_exp_f32 v97, v97
    s_nop 0
    v_add_f32 v99, v96, v97
    v_sub_f32 v100, v100, v102
    v_sub_f32 v101, v101, v102
    v_mul_f32 v100, 0x3fb8aa3b, v100
    v_mul_f32 v101, 0x3fb8aa3b, v101
    v_exp_f32 v100, v100
    v_exp_f32 v101, v101
    s_nop 0
    v_add_f32 v103, v100, v101
    v_sub_f32 v104, v104, v106
    v_sub_f32 v105, v105, v106
    v_mul_f32 v104, 0x3fb8aa3b, v104
    v_mul_f32 v105, 0x3fb8aa3b, v105
    v_exp_f32 v104, v104
    v_exp_f32 v105, v105
    s_nop 0
    v_add_f32 v107, v104, v105
    v_sub_f32 v108, v108, v110
    v_sub_f32 v109, v109, v110
    v_mul_f32 v108, 0x3fb8aa3b, v108
    v_mul_f32 v109, 0x3fb8aa3b, v109
    v_exp_f32 v108, v108
    v_exp_f32 v109, v109
    s_nop 0
    v_add_f32 v111, v108, v109
    v_sub_f32 v112, v112, v114
    v_sub_f32 v113, v113, v114
    v_mul_f32 v112, 0x3fb8aa3b, v112
    v_mul_f32 v113, 0x3fb8aa3b, v113
    v_exp_f32 v112, v112
    v_exp_f32 v113, v113
    s_nop 0
    v_add_f32 v115, v112, v113
    v_sub_f32 v116, v116, v118
    v_sub_f32 v117, v117, v118
    v_mul_f32 v116, 0x3fb8aa3b, v116
    v_mul_f32 v117, 0x3fb8aa3b, v117
    v_exp_f32 v116, v116
    v_exp_f32 v117, v117
    s_nop 0
    v_add_f32 v119, v116, v117
    v_sub_f32 v120, v120, v122
    v_sub_f32 v121, v121, v122
    v_mul_f32 v120, 0x3fb8aa3b, v120
    v_mul_f32 v121, 0x3fb8aa3b, v121
    v_exp_f32 v120, v120
    v_exp_f32 v121, v121
    s_nop 0
    v_add_f32 v123, v120, v121
    v_sub_f32 v124, v124, v126
    v_sub_f32 v125, v125, v126
    v_mul_f32 v124, 0x3fb8aa3b, v124
    v_mul_f32 v125, 0x3fb8aa3b, v125
    v_exp_f32 v124, v124
    v_exp_f32 v125, v125
    s_nop 0
    v_add_f32 v127, v124, v125
    v_add_f32_dpp v99, v99, v99 row_ror:8 row_mask:0xf bank_mask:0xf
    v_add_f32_dpp v103, v103, v103 row_ror:8 row_mask:0xf bank_mask:0xf
    v_add_f32_dpp v107, v107, v107 row_ror:8 row_mask:0xf bank_mask:0xf
    v_add_f32_dpp v111, v111, v111 row_ror:8 row_mask:0xf bank_mask:0xf
    v_add_f32_dpp v115, v115, v115 row_ror:8 row_mask:0xf bank_mask:0xf
    v_add_f32_dpp v119, v119, v119 row_ror:8 row_mask:0xf bank_mask:0xf
    v_add_f32_dpp v123, v123, v123 row_ror:8 row_mask:0xf bank_mask:0xf
    v_add_f32_dpp v127, v127, v127 row_ror:8 row_mask:0xf bank_mask:0xf
    v_add_f32_dpp v99, v99, v99 row_ror:4 row_mask:0xf bank_mask:0xf
    v_add_f32_dpp v103, v103, v103 row_ror:4 row_mask:0xf bank_mask:0xf
    v_add_f32_dpp v107, v107, v107 row_ror:4 row_mask:0xf bank_mask:0xf
    v_add_f32_dpp v111, v111, v111 row_ror:4 row_mask:0xf bank_mask:0xf
    v_add_f32_dpp v115, v115, v115 row_ror:4 row_mask:0xf bank_mask:0xf
    v_add_f32_dpp v119, v119, v119 row_ror:4 row_mask:0xf bank_mask:0xf
    v_add_f32_dpp v123, v123, v123 row_ror:4 row_mask:0xf bank_mask:0xf
    v_add_f32_dpp v127, v127, v127 row_ror:4 row_mask:0xf bank_mask:0xf
    v_add_f32_dpp v99, v99, v99 row_ror:2 row_mask:0xf bank_mask:0xf
    v_add_f32_dpp v103, v103, v103 row_ror:2 row_mask:0xf bank_mask:0xf
    v_add_f32_dpp v107, v107, v107 row_ror:2 row_mask:0xf bank_mask:0xf
    v_add_f32_dpp v111, v111, v111 row_ror:2 row_mask:0xf bank_mask:0xf
    v_add_f32_dpp v115, v115, v115 row_ror:2 row_mask:0xf bank_mask:0xf
    v_add_f32_dpp v119, v119, v119 row_ror:2 row_mask:0xf bank_mask:0xf
    v_add_f32_dpp v123, v123, v123 row_ror:2 row_mask:0xf bank_mask:0xf
    v_add_f32_dpp v127, v127, v127 row_ror:2 row_mask:0xf bank_mask:0xf
    v_add_f32_dpp v99, v99, v99 row_ror:1 row_mask:0xf bank_mask:0xf
    v_add_f32_dpp v103, v103, v103 row_ror:1 row_mask:0xf bank_mask:0xf
    v_add_f32_dpp v107, v107, v107 row_ror:1 row_mask:0xf bank_mask:0xf
    v_add_f32_dpp v111, v111, v111 row_ror:1 row_mask:0xf bank_mask:0xf
    v_add_f32_dpp v115, v115, v115 row_ror:1 row_mask:0xf bank_mask:0xf
    v_add_f32_dpp v119, v119, v119 row_ror:1 row_mask:0xf bank_mask:0xf
    v_add_f32_dpp v123, v123, v123 row_ror:1 row_mask:0xf bank_mask:0xf
    v_add_f32_dpp v127, v127, v127 row_ror:1 row_mask:0xf bank_mask:0xf
    v_rcp_f32 v99, v99
    s_nop 0
    v_mul_f32 v96, v96, v99
    v_mul_f32 v97, v97, v99
    v_rcp_f32 v103, v103
    s_nop 0
    v_mul_f32 v100, v100, v103
    v_mul_f32 v101, v101, v103
    v_rcp_f32 v107, v107
    s_nop 0
    v_mul_f32 v104, v104, v107
    v_mul_f32 v105, v105, v107
    v_rcp_f32 v111, v111
    s_nop 0
    v_mul_f32 v108, v108, v111
    v_mul_f32 v109, v109, v111
    v_rcp_f32 v115, v115
    s_nop 0
    v_mul_f32 v112, v112, v115
    v_mul_f32 v113, v113, v115
    v_rcp_f32 v119, v119
    s_nop 0
    v_mul_f32 v116, v116, v119
    v_mul_f32 v117, v117, v119
    v_rcp_f32 v123, v123
    s_nop 0
    v_mul_f32 v120, v120, v123
    v_mul_f32 v121, v121, v123
    v_rcp_f32 v127, v127
    s_nop 0
    v_mul_f32 v124, v124, v127
    v_mul_f32 v125, v125, v127
    v_cvt_pk_bf16_f32 v80, v96, v100
    v_cvt_pk_bf16_f32 v81, v104, v108
    v_cvt_pk_bf16_f32 v82, v112, v116
    v_cvt_pk_bf16_f32 v83, v120, v124
    v_cvt_pk_bf16_f32 v84, v97, v101
    v_cvt_pk_bf16_f32 v85, v105, v109
    v_cvt_pk_bf16_f32 v86, v113, v117
    v_cvt_pk_bf16_f32 v87, v121, v125
    v_sub_f32 v96, 0, v64
    v_sub_f32 v98, 0, v68
    v_mov_b32 v97, 0xff800000
    v_cndmask_b32 v97, v97, v98, s[56:57]
    v_max_f32 v98, v96, v97
    v_sub_f32 v100, 0, v65
    v_sub_f32 v102, 0, v69
    v_mov_b32 v101, 0xff800000
    v_cndmask_b32 v101, v101, v102, s[56:57]
    v_max_f32 v102, v100, v101
    v_sub_f32 v104, 0, v66
    v_sub_f32 v106, 0, v70
    v_mov_b32 v105, 0xff800000
    v_cndmask_b32 v105, v105, v106, s[56:57]
    v_max_f32 v106, v104, v105
    v_sub_f32 v108, 0, v67
    v_sub_f32 v110, 0, v71
    v_mov_b32 v109, 0xff800000
    v_cndmask_b32 v109, v109, v110, s[56:57]
    v_max_f32 v110, v108, v109
    v_sub_f32 v112, 0, v72
    v_sub_f32 v114, 0, v76
    v_mov_b32 v113, 0xff800000
    v_cndmask_b32 v113, v113, v114, s[56:57]
    v_max_f32 v114, v112, v113
    v_sub_f32 v116, 0, v73
    v_sub_f32 v118, 0, v77
    v_mov_b32 v117, 0xff800000
    v_cndmask_b32 v117, v117, v118, s[56:57]
    v_max_f32 v118, v116, v117
    v_sub_f32 v120, 0, v74
    v_sub_f32 v122, 0, v78
    v_mov_b32 v121, 0xff800000
    v_cndmask_b32 v121, v121, v122, s[56:57]
    v_max_f32 v122, v120, v121
    v_sub_f32 v124, 0, v75
    v_sub_f32 v126, 0, v79
    v_mov_b32 v125, 0xff800000
    v_cndmask_b32 v125, v125, v126, s[56:57]
    v_max_f32 v126, v124, v125
    v_max_f32_dpp v98, v98, v98 row_ror:8 row_mask:0xf bank_mask:0xf
    v_max_f32_dpp v102, v102, v102 row_ror:8 row_mask:0xf bank_mask:0xf
    v_max_f32_dpp v106, v106, v106 row_ror:8 row_mask:0xf bank_mask:0xf
    v_max_f32_dpp v110, v110, v110 row_ror:8 row_mask:0xf bank_mask:0xf
    v_max_f32_dpp v114, v114, v114 row_ror:8 row_mask:0xf bank_mask:0xf
    v_max_f32_dpp v118, v118, v118 row_ror:8 row_mask:0xf bank_mask:0xf
    v_max_f32_dpp v122, v122, v122 row_ror:8 row_mask:0xf bank_mask:0xf
    v_max_f32_dpp v126, v126, v126 row_ror:8 row_mask:0xf bank_mask:0xf
    v_max_f32_dpp v98, v98, v98 row_ror:4 row_mask:0xf bank_mask:0xf
    v_max_f32_dpp v102, v102, v102 row_ror:4 row_mask:0xf bank_mask:0xf
    v_max_f32_dpp v106, v106, v106 row_ror:4 row_mask:0xf bank_mask:0xf
    v_max_f32_dpp v110, v110, v110 row_ror:4 row_mask:0xf bank_mask:0xf
    v_max_f32_dpp v114, v114, v114 row_ror:4 row_mask:0xf bank_mask:0xf
    v_max_f32_dpp v118, v118, v118 row_ror:4 row_mask:0xf bank_mask:0xf
    v_max_f32_dpp v122, v122, v122 row_ror:4 row_mask:0xf bank_mask:0xf
    v_max_f32_dpp v126, v126, v126 row_ror:4 row_mask:0xf bank_mask:0xf
    v_max_f32_dpp v98, v98, v98 row_ror:2 row_mask:0xf bank_mask:0xf
    v_max_f32_dpp v102, v102, v102 row_ror:2 row_mask:0xf bank_mask:0xf
    v_max_f32_dpp v106, v106, v106 row_ror:2 row_mask:0xf bank_mask:0xf
    v_max_f32_dpp v110, v110, v110 row_ror:2 row_mask:0xf bank_mask:0xf
    v_max_f32_dpp v114, v114, v114 row_ror:2 row_mask:0xf bank_mask:0xf
    v_max_f32_dpp v118, v118, v118 row_ror:2 row_mask:0xf bank_mask:0xf
    v_max_f32_dpp v122, v122, v122 row_ror:2 row_mask:0xf bank_mask:0xf
    v_max_f32_dpp v126, v126, v126 row_ror:2 row_mask:0xf bank_mask:0xf
    v_max_f32_dpp v98, v98, v98 row_ror:1 row_mask:0xf bank_mask:0xf
    v_max_f32_dpp v102, v102, v102 row_ror:1 row_mask:0xf bank_mask:0xf
    v_max_f32_dpp v106, v106, v106 row_ror:1 row_mask:0xf bank_mask:0xf
    v_max_f32_dpp v110, v110, v110 row_ror:1 row_mask:0xf bank_mask:0xf
    v_max_f32_dpp v114, v114, v114 row_ror:1 row_mask:0xf bank_mask:0xf
    v_max_f32_dpp v118, v118, v118 row_ror:1 row_mask:0xf bank_mask:0xf
    v_max_f32_dpp v122, v122, v122 row_ror:1 row_mask:0xf bank_mask:0xf
    v_max_f32_dpp v126, v126, v126 row_ror:1 row_mask:0xf bank_mask:0xf
    v_sub_f32 v96, v96, v98
    v_sub_f32 v97, v97, v98
    v_mul_f32 v96, 0x3fb8aa3b, v96
    v_mul_f32 v97, 0x3fb8aa3b, v97
    v_exp_f32 v96, v96
    v_exp_f32 v97, v97
    s_nop 0
    v_add_f32 v99, v96, v97
    v_sub_f32 v100, v100, v102
    v_sub_f32 v101, v101, v102
    v_mul_f32 v100, 0x3fb8aa3b, v100
    v_mul_f32 v101, 0x3fb8aa3b, v101
    v_exp_f32 v100, v100
    v_exp_f32 v101, v101
    s_nop 0
    v_add_f32 v103, v100, v101
    v_sub_f32 v104, v104, v106
    v_sub_f32 v105, v105, v106
    v_mul_f32 v104, 0x3fb8aa3b, v104
    v_mul_f32 v105, 0x3fb8aa3b, v105
    v_exp_f32 v104, v104
    v_exp_f32 v105, v105
    s_nop 0
    v_add_f32 v107, v104, v105
    v_sub_f32 v108, v108, v110
    v_sub_f32 v109, v109, v110
    v_mul_f32 v108, 0x3fb8aa3b, v108
    v_mul_f32 v109, 0x3fb8aa3b, v109
    v_exp_f32 v108, v108
    v_exp_f32 v109, v109
    s_nop 0
    v_add_f32 v111, v108, v109
    v_sub_f32 v112, v112, v114
    v_sub_f32 v113, v113, v114
    v_mul_f32 v112, 0x3fb8aa3b, v112
    v_mul_f32 v113, 0x3fb8aa3b, v113
    v_exp_f32 v112, v112
    v_exp_f32 v113, v113
    s_nop 0
    v_add_f32 v115, v112, v113
    v_sub_f32 v116, v116, v118
    v_sub_f32 v117, v117, v118
    v_mul_f32 v116, 0x3fb8aa3b, v116
    v_mul_f32 v117, 0x3fb8aa3b, v117
    v_exp_f32 v116, v116
    v_exp_f32 v117, v117
    s_nop 0
    v_add_f32 v119, v116, v117
    v_sub_f32 v120, v120, v122
    v_sub_f32 v121, v121, v122
    v_mul_f32 v120, 0x3fb8aa3b, v120
    v_mul_f32 v121, 0x3fb8aa3b, v121
    v_exp_f32 v120, v120
    v_exp_f32 v121, v121
    s_nop 0
    v_add_f32 v123, v120, v121
    v_sub_f32 v124, v124, v126
    v_sub_f32 v125, v125, v126
    v_mul_f32 v124, 0x3fb8aa3b, v124
    v_mul_f32 v125, 0x3fb8aa3b, v125
    v_exp_f32 v124, v124
    v_exp_f32 v125, v125
    s_nop 0
    v_add_f32 v127, v124, v125
    v_add_f32_dpp v99, v99, v99 row_ror:8 row_mask:0xf bank_mask:0xf
    v_add_f32_dpp v103, v103, v103 row_ror:8 row_mask:0xf bank_mask:0xf
    v_add_f32_dpp v107, v107, v107 row_ror:8 row_mask:0xf bank_mask:0xf
    v_add_f32_dpp v111, v111, v111 row_ror:8 row_mask:0xf bank_mask:0xf
    v_add_f32_dpp v115, v115, v115 row_ror:8 row_mask:0xf bank_mask:0xf
    v_add_f32_dpp v119, v119, v119 row_ror:8 row_mask:0xf bank_mask:0xf
    v_add_f32_dpp v123, v123, v123 row_ror:8 row_mask:0xf bank_mask:0xf
    v_add_f32_dpp v127, v127, v127 row_ror:8 row_mask:0xf bank_mask:0xf
    v_add_f32_dpp v99, v99, v99 row_ror:4 row_mask:0xf bank_mask:0xf
    v_add_f32_dpp v103, v103, v103 row_ror:4 row_mask:0xf bank_mask:0xf
    v_add_f32_dpp v107, v107, v107 row_ror:4 row_mask:0xf bank_mask:0xf
    v_add_f32_dpp v111, v111, v111 row_ror:4 row_mask:0xf bank_mask:0xf
    v_add_f32_dpp v115, v115, v115 row_ror:4 row_mask:0xf bank_mask:0xf
    v_add_f32_dpp v119, v119, v119 row_ror:4 row_mask:0xf bank_mask:0xf
    v_add_f32_dpp v123, v123, v123 row_ror:4 row_mask:0xf bank_mask:0xf
    v_add_f32_dpp v127, v127, v127 row_ror:4 row_mask:0xf bank_mask:0xf
    v_add_f32_dpp v99, v99, v99 row_ror:2 row_mask:0xf bank_mask:0xf
    v_add_f32_dpp v103, v103, v103 row_ror:2 row_mask:0xf bank_mask:0xf
    v_add_f32_dpp v107, v107, v107 row_ror:2 row_mask:0xf bank_mask:0xf
    v_add_f32_dpp v111, v111, v111 row_ror:2 row_mask:0xf bank_mask:0xf
    v_add_f32_dpp v115, v115, v115 row_ror:2 row_mask:0xf bank_mask:0xf
    v_add_f32_dpp v119, v119, v119 row_ror:2 row_mask:0xf bank_mask:0xf
    v_add_f32_dpp v123, v123, v123 row_ror:2 row_mask:0xf bank_mask:0xf
    v_add_f32_dpp v127, v127, v127 row_ror:2 row_mask:0xf bank_mask:0xf
    v_add_f32_dpp v99, v99, v99 row_ror:1 row_mask:0xf bank_mask:0xf
    v_add_f32_dpp v103, v103, v103 row_ror:1 row_mask:0xf bank_mask:0xf
    v_add_f32_dpp v107, v107, v107 row_ror:1 row_mask:0xf bank_mask:0xf
    v_add_f32_dpp v111, v111, v111 row_ror:1 row_mask:0xf bank_mask:0xf
    v_add_f32_dpp v115, v115, v115 row_ror:1 row_mask:0xf bank_mask:0xf
    v_add_f32_dpp v119, v119, v119 row_ror:1 row_mask:0xf bank_mask:0xf
    v_add_f32_dpp v123, v123, v123 row_ror:1 row_mask:0xf bank_mask:0xf
    v_add_f32_dpp v127, v127, v127 row_ror:1 row_mask:0xf bank_mask:0xf
    v_rcp_f32 v99, v99
    s_nop 0
    v_mul_f32 v96, v96, v99
    v_mul_f32 v97, v97, v99
    v_rcp_f32 v103, v103
    s_nop 0
    v_mul_f32 v100, v100, v103
    v_mul_f32 v101, v101, v103
    v_rcp_f32 v107, v107
    s_nop 0
    v_mul_f32 v104, v104, v107
    v_mul_f32 v105, v105, v107
    v_rcp_f32 v111, v111
    s_nop 0
    v_mul_f32 v108, v108, v111
    v_mul_f32 v109, v109, v111
    v_rcp_f32 v115, v115
    s_nop 0
    v_mul_f32 v112, v112, v115
    v_mul_f32 v113, v113, v115
    v_rcp_f32 v119, v119
    s_nop 0
    v_mul_f32 v116, v116, v119
    v_mul_f32 v117, v117, v119
    v_rcp_f32 v123, v123
    s_nop 0
    v_mul_f32 v120, v120, v123
    v_mul_f32 v121, v121, v123
    v_rcp_f32 v127, v127
    s_nop 0
    v_mul_f32 v124, v124, v127
    v_mul_f32 v125, v125, v127
    v_cvt_pk_bf16_f32 v88, v96, v100
    v_cvt_pk_bf16_f32 v89, v104, v108
    v_cvt_pk_bf16_f32 v90, v112, v116
    v_cvt_pk_bf16_f32 v91, v120, v124
    v_cvt_pk_bf16_f32 v92, v97, v101
    v_cvt_pk_bf16_f32 v93, v105, v109
    v_cvt_pk_bf16_f32 v94, v113, v117
    v_cvt_pk_bf16_f32 v95, v121, v125
    s_waitcnt vmcnt(0)
    v_mfma_f32_16x16x32_bf16 v[16:19], v[80:83], v[56:59], v[16:19]
    v_mfma_f32_16x16x32_bf16 v[20:23], v[80:83], v[60:63], v[20:23]
    v_mfma_f32_16x16x32_bf16 v[24:27], v[84:87], v[56:59], v[24:27]
    v_mfma_f32_16x16x32_bf16 v[28:31], v[84:87], v[60:63], v[28:31]
    v_mfma_f32_16x16x32_bf16 v[32:35], v[88:91], v[56:59], v[32:35]
    v_mfma_f32_16x16x32_bf16 v[36:39], v[88:91], v[60:63], v[36:39]
    v_mfma_f32_16x16x32_bf16 v[40:43], v[92:95], v[56:59], v[40:43]
    v_mfma_f32_16x16x32_bf16 v[44:47], v[92:95], v[60:63], v[44:47]
    s_lshl_b32 s55, s52, 11
    s_add_u32 s55, s55, s53
    s_add_u32 s55, s55, 32
    s_lshl_b32 s55, s55, 6
    s_add_u32 s55, s55, 0x8d8000
    buffer_load_dwordx4 v[48:51], v5, s[28:31], s55 offen
    buffer_load_dwordx4 v[52:55], v5, s[28:31], s55 offen offset:256
    s_lshl_b32 s58, s52, 17
    s_add_u32 s59, s53, 32
    s_lshl_b32 s59, s59, 1
    s_add_u32 s58, s58, s59
    s_add_u32 s58, s58, 0xcd8000
    buffer_load_dwordx4 v[56:59], v6, s[28:31], s58 offen
    s_add_u32 s58, s58, 65536
    buffer_load_dwordx4 v[60:63], v6, s[28:31], s58 offen
    s_waitcnt vmcnt(2)
    v_mfma_f32_16x16x32_bf16 v[64:67], v[48:51], v[8:11], 0
    v_mfma_f32_16x16x32_bf16 v[68:71], v[48:51], v[12:15], 0
    v_mfma_f32_16x16x32_bf16 v[72:75], v[52:55], v[8:11], 0
    v_mfma_f32_16x16x32_bf16 v[76:79], v[52:55], v[12:15], 0
    s_nop 4
    v_cvt_pk_bf16_f32 v64, v64, v64
    v_lshlrev_b32 v64, 16, v64
    v_cvt_pk_bf16_f32 v65, v65, v65
    v_lshlrev_b32 v65, 16, v65
    v_cvt_pk_bf16_f32 v66, v66, v66
    v_lshlrev_b32 v66, 16, v66
    v_cvt_pk_bf16_f32 v67, v67, v67
    v_lshlrev_b32 v67, 16, v67
    v_cvt_pk_bf16_f32 v68, v68, v68
    v_lshlrev_b32 v68, 16, v68
    v_cvt_pk_bf16_f32 v69, v69, v69
    v_lshlrev_b32 v69, 16, v69
    v_cvt_pk_bf16_f32 v70, v70, v70
    v_lshlrev_b32 v70, 16, v70
    v_cvt_pk_bf16_f32 v71, v71, v71
    v_lshlrev_b32 v71, 16, v71
    v_cvt_pk_bf16_f32 v72, v72, v72
    v_lshlrev_b32 v72, 16, v72
    v_cvt_pk_bf16_f32 v73, v73, v73
    v_lshlrev_b32 v73, 16, v73
    v_cvt_pk_bf16_f32 v74, v74, v74
    v_lshlrev_b32 v74, 16, v74
    v_cvt_pk_bf16_f32 v75, v75, v75
    v_lshlrev_b32 v75, 16, v75
    v_cvt_pk_bf16_f32 v76, v76, v76
    v_lshlrev_b32 v76, 16, v76
    v_cvt_pk_bf16_f32 v77, v77, v77
    v_lshlrev_b32 v77, 16, v77
    v_cvt_pk_bf16_f32 v78, v78, v78
    v_lshlrev_b32 v78, 16, v78
    v_cvt_pk_bf16_f32 v79, v79, v79
    v_lshlrev_b32 v79, 16, v79
    v_mov_b32 v96, v64
    v_mov_b32 v97, 0xff800000
    v_cndmask_b32 v97, v97, v68, s[56:57]
    v_max_f32 v98, v96, v97
    v_mov_b32 v100, v65
    v_mov_b32 v101, 0xff800000
    v_cndmask_b32 v101, v101, v69, s[56:57]
    v_max_f32 v102, v100, v101
    v_mov_b32 v104, v66
    v_mov_b32 v105, 0xff800000
    v_cndmask_b32 v105, v105, v70, s[56:57]
    v_max_f32 v106, v104, v105
    v_mov_b32 v108, v67
    v_mov_b32 v109, 0xff800000
    v_cndmask_b32 v109, v109, v71, s[56:57]
    v_max_f32 v110, v108, v109
    v_mov_b32 v112, v72
    v_mov_b32 v113, 0xff800000
    v_cndmask_b32 v113, v113, v76, s[56:57]
    v_max_f32 v114, v112, v113
    v_mov_b32 v116, v73
    v_mov_b32 v117, 0xff800000
    v_cndmask_b32 v117, v117, v77, s[56:57]
    v_max_f32 v118, v116, v117
    v_mov_b32 v120, v74
    v_mov_b32 v121, 0xff800000
    v_cndmask_b32 v121, v121, v78, s[56:57]
    v_max_f32 v122, v120, v121
    v_mov_b32 v124, v75
    v_mov_b32 v125, 0xff800000
    v_cndmask_b32 v125, v125, v79, s[56:57]
    v_max_f32 v126, v124, v125
    v_max_f32_dpp v98, v98, v98 row_ror:8 row_mask:0xf bank_mask:0xf
    v_max_f32_dpp v102, v102, v102 row_ror:8 row_mask:0xf bank_mask:0xf
    v_max_f32_dpp v106, v106, v106 row_ror:8 row_mask:0xf bank_mask:0xf
    v_max_f32_dpp v110, v110, v110 row_ror:8 row_mask:0xf bank_mask:0xf
    v_max_f32_dpp v114, v114, v114 row_ror:8 row_mask:0xf bank_mask:0xf
    v_max_f32_dpp v118, v118, v118 row_ror:8 row_mask:0xf bank_mask:0xf
    v_max_f32_dpp v122, v122, v122 row_ror:8 row_mask:0xf bank_mask:0xf
    v_max_f32_dpp v126, v126, v126 row_ror:8 row_mask:0xf bank_mask:0xf
    v_max_f32_dpp v98, v98, v98 row_ror:4 row_mask:0xf bank_mask:0xf
    v_max_f32_dpp v102, v102, v102 row_ror:4 row_mask:0xf bank_mask:0xf
    v_max_f32_dpp v106, v106, v106 row_ror:4 row_mask:0xf bank_mask:0xf
    v_max_f32_dpp v110, v110, v110 row_ror:4 row_mask:0xf bank_mask:0xf
    v_max_f32_dpp v114, v114, v114 row_ror:4 row_mask:0xf bank_mask:0xf
    v_max_f32_dpp v118, v118, v118 row_ror:4 row_mask:0xf bank_mask:0xf
    v_max_f32_dpp v122, v122, v122 row_ror:4 row_mask:0xf bank_mask:0xf
    v_max_f32_dpp v126, v126, v126 row_ror:4 row_mask:0xf bank_mask:0xf
    v_max_f32_dpp v98, v98, v98 row_ror:2 row_mask:0xf bank_mask:0xf
    v_max_f32_dpp v102, v102, v102 row_ror:2 row_mask:0xf bank_mask:0xf
    v_max_f32_dpp v106, v106, v106 row_ror:2 row_mask:0xf bank_mask:0xf
    v_max_f32_dpp v110, v110, v110 row_ror:2 row_mask:0xf bank_mask:0xf
    v_max_f32_dpp v114, v114, v114 row_ror:2 row_mask:0xf bank_mask:0xf
    v_max_f32_dpp v118, v118, v118 row_ror:2 row_mask:0xf bank_mask:0xf
    v_max_f32_dpp v122, v122, v122 row_ror:2 row_mask:0xf bank_mask:0xf
    v_max_f32_dpp v126, v126, v126 row_ror:2 row_mask:0xf bank_mask:0xf
    v_max_f32_dpp v98, v98, v98 row_ror:1 row_mask:0xf bank_mask:0xf
    v_max_f32_dpp v102, v102, v102 row_ror:1 row_mask:0xf bank_mask:0xf
    v_max_f32_dpp v106, v106, v106 row_ror:1 row_mask:0xf bank_mask:0xf
    v_max_f32_dpp v110, v110, v110 row_ror:1 row_mask:0xf bank_mask:0xf
    v_max_f32_dpp v114, v114, v114 row_ror:1 row_mask:0xf bank_mask:0xf
    v_max_f32_dpp v118, v118, v118 row_ror:1 row_mask:0xf bank_mask:0xf
    v_max_f32_dpp v122, v122, v122 row_ror:1 row_mask:0xf bank_mask:0xf
    v_max_f32_dpp v126, v126, v126 row_ror:1 row_mask:0xf bank_mask:0xf
    v_sub_f32 v96, v96, v98
    v_sub_f32 v97, v97, v98
    v_mul_f32 v96, 0x3fb8aa3b, v96
    v_mul_f32 v97, 0x3fb8aa3b, v97
    v_exp_f32 v96, v96
    v_exp_f32 v97, v97
    s_nop 0
    v_add_f32 v99, v96, v97
    v_sub_f32 v100, v100, v102
    v_sub_f32 v101, v101, v102
    v_mul_f32 v100, 0x3fb8aa3b, v100
    v_mul_f32 v101, 0x3fb8aa3b, v101
    v_exp_f32 v100, v100
    v_exp_f32 v101, v101
    s_nop 0
    v_add_f32 v103, v100, v101
    v_sub_f32 v104, v104, v106
    v_sub_f32 v105, v105, v106
    v_mul_f32 v104, 0x3fb8aa3b, v104
    v_mul_f32 v105, 0x3fb8aa3b, v105
    v_exp_f32 v104, v104
    v_exp_f32 v105, v105
    s_nop 0
    v_add_f32 v107, v104, v105
    v_sub_f32 v108, v108, v110
    v_sub_f32 v109, v109, v110
    v_mul_f32 v108, 0x3fb8aa3b, v108
    v_mul_f32 v109, 0x3fb8aa3b, v109
    v_exp_f32 v108, v108
    v_exp_f32 v109, v109
    s_nop 0
    v_add_f32 v111, v108, v109
    v_sub_f32 v112, v112, v114
    v_sub_f32 v113, v113, v114
    v_mul_f32 v112, 0x3fb8aa3b, v112
    v_mul_f32 v113, 0x3fb8aa3b, v113
    v_exp_f32 v112, v112
    v_exp_f32 v113, v113
    s_nop 0
    v_add_f32 v115, v112, v113
    v_sub_f32 v116, v116, v118
    v_sub_f32 v117, v117, v118
    v_mul_f32 v116, 0x3fb8aa3b, v116
    v_mul_f32 v117, 0x3fb8aa3b, v117
    v_exp_f32 v116, v116
    v_exp_f32 v117, v117
    s_nop 0
    v_add_f32 v119, v116, v117
    v_sub_f32 v120, v120, v122
    v_sub_f32 v121, v121, v122
    v_mul_f32 v120, 0x3fb8aa3b, v120
    v_mul_f32 v121, 0x3fb8aa3b, v121
    v_exp_f32 v120, v120
    v_exp_f32 v121, v121
    s_nop 0
    v_add_f32 v123, v120, v121
    v_sub_f32 v124, v124, v126
    v_sub_f32 v125, v125, v126
    v_mul_f32 v124, 0x3fb8aa3b, v124
    v_mul_f32 v125, 0x3fb8aa3b, v125
    v_exp_f32 v124, v124
    v_exp_f32 v125, v125
    s_nop 0
    v_add_f32 v127, v124, v125
    v_add_f32_dpp v99, v99, v99 row_ror:8 row_mask:0xf bank_mask:0xf
    v_add_f32_dpp v103, v103, v103 row_ror:8 row_mask:0xf bank_mask:0xf
    v_add_f32_dpp v107, v107, v107 row_ror:8 row_mask:0xf bank_mask:0xf
    v_add_f32_dpp v111, v111, v111 row_ror:8 row_mask:0xf bank_mask:0xf
    v_add_f32_dpp v115, v115, v115 row_ror:8 row_mask:0xf bank_mask:0xf
    v_add_f32_dpp v119, v119, v119 row_ror:8 row_mask:0xf bank_mask:0xf
    v_add_f32_dpp v123, v123, v123 row_ror:8 row_mask:0xf bank_mask:0xf
    v_add_f32_dpp v127, v127, v127 row_ror:8 row_mask:0xf bank_mask:0xf
    v_add_f32_dpp v99, v99, v99 row_ror:4 row_mask:0xf bank_mask:0xf
    v_add_f32_dpp v103, v103, v103 row_ror:4 row_mask:0xf bank_mask:0xf
    v_add_f32_dpp v107, v107, v107 row_ror:4 row_mask:0xf bank_mask:0xf
    v_add_f32_dpp v111, v111, v111 row_ror:4 row_mask:0xf bank_mask:0xf
    v_add_f32_dpp v115, v115, v115 row_ror:4 row_mask:0xf bank_mask:0xf
    v_add_f32_dpp v119, v119, v119 row_ror:4 row_mask:0xf bank_mask:0xf
    v_add_f32_dpp v123, v123, v123 row_ror:4 row_mask:0xf bank_mask:0xf
    v_add_f32_dpp v127, v127, v127 row_ror:4 row_mask:0xf bank_mask:0xf
    v_add_f32_dpp v99, v99, v99 row_ror:2 row_mask:0xf bank_mask:0xf
    v_add_f32_dpp v103, v103, v103 row_ror:2 row_mask:0xf bank_mask:0xf
    v_add_f32_dpp v107, v107, v107 row_ror:2 row_mask:0xf bank_mask:0xf
    v_add_f32_dpp v111, v111, v111 row_ror:2 row_mask:0xf bank_mask:0xf
    v_add_f32_dpp v115, v115, v115 row_ror:2 row_mask:0xf bank_mask:0xf
    v_add_f32_dpp v119, v119, v119 row_ror:2 row_mask:0xf bank_mask:0xf
    v_add_f32_dpp v123, v123, v123 row_ror:2 row_mask:0xf bank_mask:0xf
    v_add_f32_dpp v127, v127, v127 row_ror:2 row_mask:0xf bank_mask:0xf
    v_add_f32_dpp v99, v99, v99 row_ror:1 row_mask:0xf bank_mask:0xf
    v_add_f32_dpp v103, v103, v103 row_ror:1 row_mask:0xf bank_mask:0xf
    v_add_f32_dpp v107, v107, v107 row_ror:1 row_mask:0xf bank_mask:0xf
    v_add_f32_dpp v111, v111, v111 row_ror:1 row_mask:0xf bank_mask:0xf
    v_add_f32_dpp v115, v115, v115 row_ror:1 row_mask:0xf bank_mask:0xf
    v_add_f32_dpp v119, v119, v119 row_ror:1 row_mask:0xf bank_mask:0xf
    v_add_f32_dpp v123, v123, v123 row_ror:1 row_mask:0xf bank_mask:0xf
    v_add_f32_dpp v127, v127, v127 row_ror:1 row_mask:0xf bank_mask:0xf
    v_rcp_f32 v99, v99
    s_nop 0
    v_mul_f32 v96, v96, v99
    v_mul_f32 v97, v97, v99
    v_rcp_f32 v103, v103
    s_nop 0
    v_mul_f32 v100, v100, v103
    v_mul_f32 v101, v101, v103
    v_rcp_f32 v107, v107
    s_nop 0
    v_mul_f32 v104, v104, v107
    v_mul_f32 v105, v105, v107
    v_rcp_f32 v111, v111
    s_nop 0
    v_mul_f32 v108, v108, v111
    v_mul_f32 v109, v109, v111
    v_rcp_f32 v115, v115
    s_nop 0
    v_mul_f32 v112, v112, v115
    v_mul_f32 v113, v113, v115
    v_rcp_f32 v119, v119
    s_nop 0
    v_mul_f32 v116, v116, v119
    v_mul_f32 v117, v117, v119
    v_rcp_f32 v123, v123
    s_nop 0
    v_mul_f32 v120, v120, v123
    v_mul_f32 v121, v121, v123
    v_rcp_f32 v127, v127
    s_nop 0
    v_mul_f32 v124, v124, v127
    v_mul_f32 v125, v125, v127
    v_cvt_pk_bf16_f32 v80, v96, v100
    v_cvt_pk_bf16_f32 v81, v104, v108
    v_cvt_pk_bf16_f32 v82, v112, v116
    v_cvt_pk_bf16_f32 v83, v120, v124
    v_cvt_pk_bf16_f32 v84, v97, v101
    v_cvt_pk_bf16_f32 v85, v105, v109
    v_cvt_pk_bf16_f32 v86, v113, v117
    v_cvt_pk_bf16_f32 v87, v121, v125
    v_sub_f32 v96, 0, v64
    v_sub_f32 v98, 0, v68
    v_mov_b32 v97, 0xff800000
    v_cndmask_b32 v97, v97, v98, s[56:57]
    v_max_f32 v98, v96, v97
    v_sub_f32 v100, 0, v65
    v_sub_f32 v102, 0, v69
    v_mov_b32 v101, 0xff800000
    v_cndmask_b32 v101, v101, v102, s[56:57]
    v_max_f32 v102, v100, v101
    v_sub_f32 v104, 0, v66
    v_sub_f32 v106, 0, v70
    v_mov_b32 v105, 0xff800000
    v_cndmask_b32 v105, v105, v106, s[56:57]
    v_max_f32 v106, v104, v105
    v_sub_f32 v108, 0, v67
    v_sub_f32 v110, 0, v71
    v_mov_b32 v109, 0xff800000
    v_cndmask_b32 v109, v109, v110, s[56:57]
    v_max_f32 v110, v108, v109
    v_sub_f32 v112, 0, v72
    v_sub_f32 v114, 0, v76
    v_mov_b32 v113, 0xff800000
    v_cndmask_b32 v113, v113, v114, s[56:57]
    v_max_f32 v114, v112, v113
    v_sub_f32 v116, 0, v73
    v_sub_f32 v118, 0, v77
    v_mov_b32 v117, 0xff800000
    v_cndmask_b32 v117, v117, v118, s[56:57]
    v_max_f32 v118, v116, v117
    v_sub_f32 v120, 0, v74
    v_sub_f32 v122, 0, v78
    v_mov_b32 v121, 0xff800000
    v_cndmask_b32 v121, v121, v122, s[56:57]
    v_max_f32 v122, v120, v121
    v_sub_f32 v124, 0, v75
    v_sub_f32 v126, 0, v79
    v_mov_b32 v125, 0xff800000
    v_cndmask_b32 v125, v125, v126, s[56:57]
    v_max_f32 v126, v124, v125
    v_max_f32_dpp v98, v98, v98 row_ror:8 row_mask:0xf bank_mask:0xf
    v_max_f32_dpp v102, v102, v102 row_ror:8 row_mask:0xf bank_mask:0xf
    v_max_f32_dpp v106, v106, v106 row_ror:8 row_mask:0xf bank_mask:0xf
    v_max_f32_dpp v110, v110, v110 row_ror:8 row_mask:0xf bank_mask:0xf
    v_max_f32_dpp v114, v114, v114 row_ror:8 row_mask:0xf bank_mask:0xf
    v_max_f32_dpp v118, v118, v118 row_ror:8 row_mask:0xf bank_mask:0xf
    v_max_f32_dpp v122, v122, v122 row_ror:8 row_mask:0xf bank_mask:0xf
    v_max_f32_dpp v126, v126, v126 row_ror:8 row_mask:0xf bank_mask:0xf
    v_max_f32_dpp v98, v98, v98 row_ror:4 row_mask:0xf bank_mask:0xf
    v_max_f32_dpp v102, v102, v102 row_ror:4 row_mask:0xf bank_mask:0xf
    v_max_f32_dpp v106, v106, v106 row_ror:4 row_mask:0xf bank_mask:0xf
    v_max_f32_dpp v110, v110, v110 row_ror:4 row_mask:0xf bank_mask:0xf
    v_max_f32_dpp v114, v114, v114 row_ror:4 row_mask:0xf bank_mask:0xf
    v_max_f32_dpp v118, v118, v118 row_ror:4 row_mask:0xf bank_mask:0xf
    v_max_f32_dpp v122, v122, v122 row_ror:4 row_mask:0xf bank_mask:0xf
    v_max_f32_dpp v126, v126, v126 row_ror:4 row_mask:0xf bank_mask:0xf
    v_max_f32_dpp v98, v98, v98 row_ror:2 row_mask:0xf bank_mask:0xf
    v_max_f32_dpp v102, v102, v102 row_ror:2 row_mask:0xf bank_mask:0xf
    v_max_f32_dpp v106, v106, v106 row_ror:2 row_mask:0xf bank_mask:0xf
    v_max_f32_dpp v110, v110, v110 row_ror:2 row_mask:0xf bank_mask:0xf
    v_max_f32_dpp v114, v114, v114 row_ror:2 row_mask:0xf bank_mask:0xf
    v_max_f32_dpp v118, v118, v118 row_ror:2 row_mask:0xf bank_mask:0xf
    v_max_f32_dpp v122, v122, v122 row_ror:2 row_mask:0xf bank_mask:0xf
    v_max_f32_dpp v126, v126, v126 row_ror:2 row_mask:0xf bank_mask:0xf
    v_max_f32_dpp v98, v98, v98 row_ror:1 row_mask:0xf bank_mask:0xf
    v_max_f32_dpp v102, v102, v102 row_ror:1 row_mask:0xf bank_mask:0xf
    v_max_f32_dpp v106, v106, v106 row_ror:1 row_mask:0xf bank_mask:0xf
    v_max_f32_dpp v110, v110, v110 row_ror:1 row_mask:0xf bank_mask:0xf
    v_max_f32_dpp v114, v114, v114 row_ror:1 row_mask:0xf bank_mask:0xf
    v_max_f32_dpp v118, v118, v118 row_ror:1 row_mask:0xf bank_mask:0xf
    v_max_f32_dpp v122, v122, v122 row_ror:1 row_mask:0xf bank_mask:0xf
    v_max_f32_dpp v126, v126, v126 row_ror:1 row_mask:0xf bank_mask:0xf
    v_sub_f32 v96, v96, v98
    v_sub_f32 v97, v97, v98
    v_mul_f32 v96, 0x3fb8aa3b, v96
    v_mul_f32 v97, 0x3fb8aa3b, v97
    v_exp_f32 v96, v96
    v_exp_f32 v97, v97
    s_nop 0
    v_add_f32 v99, v96, v97
    v_sub_f32 v100, v100, v102
    v_sub_f32 v101, v101, v102
    v_mul_f32 v100, 0x3fb8aa3b, v100
    v_mul_f32 v101, 0x3fb8aa3b, v101
    v_exp_f32 v100, v100
    v_exp_f32 v101, v101
    s_nop 0
    v_add_f32 v103, v100, v101
    v_sub_f32 v104, v104, v106
    v_sub_f32 v105, v105, v106
    v_mul_f32 v104, 0x3fb8aa3b, v104
    v_mul_f32 v105, 0x3fb8aa3b, v105
    v_exp_f32 v104, v104
    v_exp_f32 v105, v105
    s_nop 0
    v_add_f32 v107, v104, v105
    v_sub_f32 v108, v108, v110
    v_sub_f32 v109, v109, v110
    v_mul_f32 v108, 0x3fb8aa3b, v108
    v_mul_f32 v109, 0x3fb8aa3b, v109
    v_exp_f32 v108, v108
    v_exp_f32 v109, v109
    s_nop 0
    v_add_f32 v111, v108, v109
    v_sub_f32 v112, v112, v114
    v_sub_f32 v113, v113, v114
    v_mul_f32 v112, 0x3fb8aa3b, v112
    v_mul_f32 v113, 0x3fb8aa3b, v113
    v_exp_f32 v112, v112
    v_exp_f32 v113, v113
    s_nop 0
    v_add_f32 v115, v112, v113
    v_sub_f32 v116, v116, v118
    v_sub_f32 v117, v117, v118
    v_mul_f32 v116, 0x3fb8aa3b, v116
    v_mul_f32 v117, 0x3fb8aa3b, v117
    v_exp_f32 v116, v116
    v_exp_f32 v117, v117
    s_nop 0
    v_add_f32 v119, v116, v117
    v_sub_f32 v120, v120, v122
    v_sub_f32 v121, v121, v122
    v_mul_f32 v120, 0x3fb8aa3b, v120
    v_mul_f32 v121, 0x3fb8aa3b, v121
    v_exp_f32 v120, v120
    v_exp_f32 v121, v121
    s_nop 0
    v_add_f32 v123, v120, v121
    v_sub_f32 v124, v124, v126
    v_sub_f32 v125, v125, v126
    v_mul_f32 v124, 0x3fb8aa3b, v124
    v_mul_f32 v125, 0x3fb8aa3b, v125
    v_exp_f32 v124, v124
    v_exp_f32 v125, v125
    s_nop 0
    v_add_f32 v127, v124, v125
    v_add_f32_dpp v99, v99, v99 row_ror:8 row_mask:0xf bank_mask:0xf
    v_add_f32_dpp v103, v103, v103 row_ror:8 row_mask:0xf bank_mask:0xf
    v_add_f32_dpp v107, v107, v107 row_ror:8 row_mask:0xf bank_mask:0xf
    v_add_f32_dpp v111, v111, v111 row_ror:8 row_mask:0xf bank_mask:0xf
    v_add_f32_dpp v115, v115, v115 row_ror:8 row_mask:0xf bank_mask:0xf
    v_add_f32_dpp v119, v119, v119 row_ror:8 row_mask:0xf bank_mask:0xf
    v_add_f32_dpp v123, v123, v123 row_ror:8 row_mask:0xf bank_mask:0xf
    v_add_f32_dpp v127, v127, v127 row_ror:8 row_mask:0xf bank_mask:0xf
    v_add_f32_dpp v99, v99, v99 row_ror:4 row_mask:0xf bank_mask:0xf
    v_add_f32_dpp v103, v103, v103 row_ror:4 row_mask:0xf bank_mask:0xf
    v_add_f32_dpp v107, v107, v107 row_ror:4 row_mask:0xf bank_mask:0xf
    v_add_f32_dpp v111, v111, v111 row_ror:4 row_mask:0xf bank_mask:0xf
    v_add_f32_dpp v115, v115, v115 row_ror:4 row_mask:0xf bank_mask:0xf
    v_add_f32_dpp v119, v119, v119 row_ror:4 row_mask:0xf bank_mask:0xf
    v_add_f32_dpp v123, v123, v123 row_ror:4 row_mask:0xf bank_mask:0xf
    v_add_f32_dpp v127, v127, v127 row_ror:4 row_mask:0xf bank_mask:0xf
    v_add_f32_dpp v99, v99, v99 row_ror:2 row_mask:0xf bank_mask:0xf
    v_add_f32_dpp v103, v103, v103 row_ror:2 row_mask:0xf bank_mask:0xf
    v_add_f32_dpp v107, v107, v107 row_ror:2 row_mask:0xf bank_mask:0xf
    v_add_f32_dpp v111, v111, v111 row_ror:2 row_mask:0xf bank_mask:0xf
    v_add_f32_dpp v115, v115, v115 row_ror:2 row_mask:0xf bank_mask:0xf
    v_add_f32_dpp v119, v119, v119 row_ror:2 row_mask:0xf bank_mask:0xf
    v_add_f32_dpp v123, v123, v123 row_ror:2 row_mask:0xf bank_mask:0xf
    v_add_f32_dpp v127, v127, v127 row_ror:2 row_mask:0xf bank_mask:0xf
    v_add_f32_dpp v99, v99, v99 row_ror:1 row_mask:0xf bank_mask:0xf
    v_add_f32_dpp v103, v103, v103 row_ror:1 row_mask:0xf bank_mask:0xf
    v_add_f32_dpp v107, v107, v107 row_ror:1 row_mask:0xf bank_mask:0xf
    v_add_f32_dpp v111, v111, v111 row_ror:1 row_mask:0xf bank_mask:0xf
    v_add_f32_dpp v115, v115, v115 row_ror:1 row_mask:0xf bank_mask:0xf
    v_add_f32_dpp v119, v119, v119 row_ror:1 row_mask:0xf bank_mask:0xf
    v_add_f32_dpp v123, v123, v123 row_ror:1 row_mask:0xf bank_mask:0xf
    v_add_f32_dpp v127, v127, v127 row_ror:1 row_mask:0xf bank_mask:0xf
    v_rcp_f32 v99, v99
    s_nop 0
    v_mul_f32 v96, v96, v99
    v_mul_f32 v97, v97, v99
    v_rcp_f32 v103, v103
    s_nop 0
    v_mul_f32 v100, v100, v103
    v_mul_f32 v101, v101, v103
    v_rcp_f32 v107, v107
    s_nop 0
    v_mul_f32 v104, v104, v107
    v_mul_f32 v105, v105, v107
    v_rcp_f32 v111, v111
    s_nop 0
    v_mul_f32 v108, v108, v111
    v_mul_f32 v109, v109, v111
    v_rcp_f32 v115, v115
    s_nop 0
    v_mul_f32 v112, v112, v115
    v_mul_f32 v113, v113, v115
    v_rcp_f32 v119, v119
    s_nop 0
    v_mul_f32 v116, v116, v119
    v_mul_f32 v117, v117, v119
    v_rcp_f32 v123, v123
    s_nop 0
    v_mul_f32 v120, v120, v123
    v_mul_f32 v121, v121, v123
    v_rcp_f32 v127, v127
    s_nop 0
    v_mul_f32 v124, v124, v127
    v_mul_f32 v125, v125, v127
    v_cvt_pk_bf16_f32 v88, v96, v100
    v_cvt_pk_bf16_f32 v89, v104, v108
    v_cvt_pk_bf16_f32 v90, v112, v116
    v_cvt_pk_bf16_f32 v91, v120, v124
    v_cvt_pk_bf16_f32 v92, v97, v101
    v_cvt_pk_bf16_f32 v93, v105, v109
    v_cvt_pk_bf16_f32 v94, v113, v117
    v_cvt_pk_bf16_f32 v95, v121, v125
    s_waitcnt vmcnt(0)
    v_mfma_f32_16x16x32_bf16 v[16:19], v[80:83], v[56:59], v[16:19]
    v_mfma_f32_16x16x32_bf16 v[20:23], v[80:83], v[60:63], v[20:23]
    v_mfma_f32_16x16x32_bf16 v[24:27], v[84:87], v[56:59], v[24:27]
    v_mfma_f32_16x16x32_bf16 v[28:31], v[84:87], v[60:63], v[28:31]
    v_mfma_f32_16x16x32_bf16 v[32:35], v[88:91], v[56:59], v[32:35]
    v_mfma_f32_16x16x32_bf16 v[36:39], v[88:91], v[60:63], v[36:39]
    v_mfma_f32_16x16x32_bf16 v[40:43], v[92:95], v[56:59], v[40:43]
    v_mfma_f32_16x16x32_bf16 v[44:47], v[92:95], v[60:63], v[44:47]
    v_lshlrev_b32 v4, 2, v1
    s_lshl_b32 s55, s36, 13
    v_add_u32 v4, s55, v4
    ds_write_b32 v4, v16 offset:0
    ds_write_b32 v4, v17 offset:256
    ds_write_b32 v4, v18 offset:512
    ds_write_b32 v4, v19 offset:768
    ds_write_b32 v4, v20 offset:1024
    ds_write_b32 v4, v21 offset:1280
    ds_write_b32 v4, v22 offset:1536
    ds_write_b32 v4, v23 offset:1792
    ds_write_b32 v4, v24 offset:2048
    ds_write_b32 v4, v25 offset:2304
    ds_write_b32 v4, v26 offset:2560
    ds_write_b32 v4, v27 offset:2816
    ds_write_b32 v4, v28 offset:3072
    ds_write_b32 v4, v29 offset:3328
    ds_write_b32 v4, v30 offset:3584
    ds_write_b32 v4, v31 offset:3840
    ds_write_b32 v4, v32 offset:4096
    ds_write_b32 v4, v33 offset:4352
    ds_write_b32 v4, v34 offset:4608
    ds_write_b32 v4, v35 offset:4864
    ds_write_b32 v4, v36 offset:5120
    ds_write_b32 v4, v37 offset:5376
    ds_write_b32 v4, v38 offset:5632
    ds_write_b32 v4, v39 offset:5888
    ds_write_b32 v4, v40 offset:6144
    ds_write_b32 v4, v41 offset:6400
    ds_write_b32 v4, v42 offset:6656
    ds_write_b32 v4, v43 offset:6912
    ds_write_b32 v4, v44 offset:7168
    ds_write_b32 v4, v45 offset:7424
    ds_write_b32 v4, v46 offset:7680
    ds_write_b32 v4, v47 offset:7936
    s_waitcnt lgkmcnt(0)
    s_barrier
    v_lshlrev_b32 v4, 2, v1
    s_lshl_b32 s55, s36, 11
    v_add_u32 v4, s55, v4
    ds_read_b32 v96, v4 offset:0
    ds_read_b32 v97, v4 offset:8192
    ds_read_b32 v98, v4 offset:16384
    ds_read_b32 v99, v4 offset:24576
    ds_read_b32 v100, v4 offset:256
    ds_read_b32 v101, v4 offset:8448
    ds_read_b32 v102, v4 offset:16640
    ds_read_b32 v103, v4 offset:24832
    ds_read_b32 v104, v4 offset:512
    ds_read_b32 v105, v4 offset:8704
    ds_read_b32 v106, v4 offset:16896
    ds_read_b32 v107, v4 offset:25088
    ds_read_b32 v108, v4 offset:768
    ds_read_b32 v109, v4 offset:8960
    ds_read_b32 v110, v4 offset:17152
    ds_read_b32 v111, v4 offset:25344
    ds_read_b32 v112, v4 offset:1024
    ds_read_b32 v113, v4 offset:9216
    ds_read_b32 v114, v4 offset:17408
    ds_read_b32 v115, v4 offset:25600
    ds_read_b32 v116, v4 offset:1280
    ds_read_b32 v117, v4 offset:9472
    ds_read_b32 v118, v4 offset:17664
    ds_read_b32 v119, v4 offset:25856
    ds_read_b32 v120, v4 offset:1536
    ds_read_b32 v121, v4 offset:9728
    ds_read_b32 v122, v4 offset:17920
    ds_read_b32 v123, v4 offset:26112
    ds_read_b32 v124, v4 offset:1792
    ds_read_b32 v125, v4 offset:9984
    ds_read_b32 v126, v4 offset:18176
    ds_read_b32 v127, v4 offset:26368
    s_waitcnt lgkmcnt(0)
    v_add_f32 v96, v96, v97
    v_add_f32 v98, v98, v99
    v_add_f32 v96, v96, v98
    v_add_f32 v100, v100, v101
    v_add_f32 v102, v102, v103
    v_add_f32 v100, v100, v102
    v_add_f32 v104, v104, v105
    v_add_f32 v106, v106, v107
    v_add_f32 v104, v104, v106
    v_add_f32 v108, v108, v109
    v_add_f32 v110, v110, v111
    v_add_f32 v108, v108, v110
    v_add_f32 v112, v112, v113
    v_add_f32 v114, v114, v115
    v_add_f32 v112, v112, v114
    v_add_f32 v116, v116, v117
    v_add_f32 v118, v118, v119
    v_add_f32 v116, v116, v118
    v_add_f32 v120, v120, v121
    v_add_f32 v122, v122, v123
    v_add_f32 v120, v120, v122
    v_add_f32 v124, v124, v125
    v_add_f32 v126, v126, v127
    v_add_f32 v124, v124, v126
    s_lshl_b32 s55, s2, 13
    s_add_u32 s55, s55, 0x10d8000
    s_lshl_b32 s58, s36, 11
    s_add_u32 s55, s55, s58
    v_lshlrev_b32 v4, 2, v1
    buffer_store_dword v96, v4, s[28:31], s55 offen offset:0 sc0 sc1
    buffer_store_dword v100, v4, s[28:31], s55 offen offset:256 sc0 sc1
    buffer_store_dword v104, v4, s[28:31], s55 offen offset:512 sc0 sc1
    buffer_store_dword v108, v4, s[28:31], s55 offen offset:768 sc0 sc1
    buffer_store_dword v112, v4, s[28:31], s55 offen offset:1024 sc0 sc1
    buffer_store_dword v116, v4, s[28:31], s55 offen offset:1280 sc0 sc1
    buffer_store_dword v120, v4, s[28:31], s55 offen offset:1536 sc0 sc1
    buffer_store_dword v124, v4, s[28:31], s55 offen offset:1792 sc0 sc1
    s_waitcnt vmcnt(0)
    s_barrier
    s_mov_b32 s32, s24
    s_mov_b32 s33, s25
    s_and_b32 s33, s33, 0xffff
    s_mov_b32 s34, 0x100
    s_mov_b32 s35, 0x00020000
    s_cmp_lg_u32 s36, 0
    s_cbranch_scc1 L_kv_kernel_skipatom
    v_mov_b32 v4, 1
    s_lshl_b32 s55, s52, 2
    v_mov_b32 v5, s55
    s_mov_b64 exec, 1
    buffer_atomic_add v4, v5, s[32:35], 0 offen sc0
    s_waitcnt vmcnt(0)
    v_mov_b32 v5, 0
    ds_write_b32 v5, v4
    s_mov_b64 exec, -1
    s_waitcnt lgkmcnt(0)
L_kv_kernel_skipatom:
    s_barrier
    v_mov_b32 v5, 0
    ds_read_b32 v4, v5
    s_waitcnt lgkmcnt(0)
    v_readfirstlane_b32 s55, v4
    s_cmp_lg_u32 s55, 7
    s_cbranch_scc1 L_kv_kernel_end
    buffer_inv sc1
    s_lshl_b32 s55, s52, 16
    s_add_u32 s55, s55, 0x10d8000
    s_lshl_b32 s58, s36, 11
    s_add_u32 s55, s55, s58
    v_lshlrev_b32 v4, 2, v1
    buffer_load_dword v16, v4, s[28:31], s55 offen offset:0 sc0 sc1
    buffer_load_dword v17, v4, s[28:31], s55 offen offset:256 sc0 sc1
    buffer_load_dword v18, v4, s[28:31], s55 offen offset:512 sc0 sc1
    buffer_load_dword v19, v4, s[28:31], s55 offen offset:768 sc0 sc1
    buffer_load_dword v20, v4, s[28:31], s55 offen offset:1024 sc0 sc1
    buffer_load_dword v21, v4, s[28:31], s55 offen offset:1280 sc0 sc1
    buffer_load_dword v22, v4, s[28:31], s55 offen offset:1536 sc0 sc1
    buffer_load_dword v23, v4, s[28:31], s55 offen offset:1792 sc0 sc1
    s_add_u32 s55, s55, 8192
    buffer_load_dword v24, v4, s[28:31], s55 offen offset:0 sc0 sc1
    buffer_load_dword v25, v4, s[28:31], s55 offen offset:256 sc0 sc1
    buffer_load_dword v26, v4, s[28:31], s55 offen offset:512 sc0 sc1
    buffer_load_dword v27, v4, s[28:31], s55 offen offset:768 sc0 sc1
    buffer_load_dword v28, v4, s[28:31], s55 offen offset:1024 sc0 sc1
    buffer_load_dword v29, v4, s[28:31], s55 offen offset:1280 sc0 sc1
    buffer_load_dword v30, v4, s[28:31], s55 offen offset:1536 sc0 sc1
    buffer_load_dword v31, v4, s[28:31], s55 offen offset:1792 sc0 sc1
    s_add_u32 s55, s55, 8192
    buffer_load_dword v32, v4, s[28:31], s55 offen offset:0 sc0 sc1
    buffer_load_dword v33, v4, s[28:31], s55 offen offset:256 sc0 sc1
    buffer_load_dword v34, v4, s[28:31], s55 offen offset:512 sc0 sc1
    buffer_load_dword v35, v4, s[28:31], s55 offen offset:768 sc0 sc1
    buffer_load_dword v36, v4, s[28:31], s55 offen offset:1024 sc0 sc1
    buffer_load_dword v37, v4, s[28:31], s55 offen offset:1280 sc0 sc1
    buffer_load_dword v38, v4, s[28:31], s55 offen offset:1536 sc0 sc1
    buffer_load_dword v39, v4, s[28:31], s55 offen offset:1792 sc0 sc1
    s_add_u32 s55, s55, 8192
    buffer_load_dword v40, v4, s[28:31], s55 offen offset:0 sc0 sc1
    buffer_load_dword v41, v4, s[28:31], s55 offen offset:256 sc0 sc1
    buffer_load_dword v42, v4, s[28:31], s55 offen offset:512 sc0 sc1
    buffer_load_dword v43, v4, s[28:31], s55 offen offset:768 sc0 sc1
    buffer_load_dword v44, v4, s[28:31], s55 offen offset:1024 sc0 sc1
    buffer_load_dword v45, v4, s[28:31], s55 offen offset:1280 sc0 sc1
    buffer_load_dword v46, v4, s[28:31], s55 offen offset:1536 sc0 sc1
    buffer_load_dword v47, v4, s[28:31], s55 offen offset:1792 sc0 sc1
    s_add_u32 s55, s55, 8192
    buffer_load_dword v48, v4, s[28:31], s55 offen offset:0 sc0 sc1
    buffer_load_dword v49, v4, s[28:31], s55 offen offset:256 sc0 sc1
    buffer_load_dword v50, v4, s[28:31], s55 offen offset:512 sc0 sc1
    buffer_load_dword v51, v4, s[28:31], s55 offen offset:768 sc0 sc1
    buffer_load_dword v52, v4, s[28:31], s55 offen offset:1024 sc0 sc1
    buffer_load_dword v53, v4, s[28:31], s55 offen offset:1280 sc0 sc1
    buffer_load_dword v54, v4, s[28:31], s55 offen offset:1536 sc0 sc1
    buffer_load_dword v55, v4, s[28:31], s55 offen offset:1792 sc0 sc1
    s_add_u32 s55, s55, 8192
    buffer_load_dword v56, v4, s[28:31], s55 offen offset:0 sc0 sc1
    buffer_load_dword v57, v4, s[28:31], s55 offen offset:256 sc0 sc1
    buffer_load_dword v58, v4, s[28:31], s55 offen offset:512 sc0 sc1
    buffer_load_dword v59, v4, s[28:31], s55 offen offset:768 sc0 sc1
    buffer_load_dword v60, v4, s[28:31], s55 offen offset:1024 sc0 sc1
    buffer_load_dword v61, v4, s[28:31], s55 offen offset:1280 sc0 sc1
    buffer_load_dword v62, v4, s[28:31], s55 offen offset:1536 sc0 sc1
    buffer_load_dword v63, v4, s[28:31], s55 offen offset:1792 sc0 sc1
    s_add_u32 s55, s55, 8192
    buffer_load_dword v64, v4, s[28:31], s55 offen offset:0 sc0 sc1
    buffer_load_dword v65, v4, s[28:31], s55 offen offset:256 sc0 sc1
    buffer_load_dword v66, v4, s[28:31], s55 offen offset:512 sc0 sc1
    buffer_load_dword v67, v4, s[28:31], s55 offen offset:768 sc0 sc1
    buffer_load_dword v68, v4, s[28:31], s55 offen offset:1024 sc0 sc1
    buffer_load_dword v69, v4, s[28:31], s55 offen offset:1280 sc0 sc1
    buffer_load_dword v70, v4, s[28:31], s55 offen offset:1536 sc0 sc1
    buffer_load_dword v71, v4, s[28:31], s55 offen offset:1792 sc0 sc1
    s_add_u32 s55, s55, 8192
    buffer_load_dword v72, v4, s[28:31], s55 offen offset:0 sc0 sc1
    buffer_load_dword v73, v4, s[28:31], s55 offen offset:256 sc0 sc1
    buffer_load_dword v74, v4, s[28:31], s55 offen offset:512 sc0 sc1
    buffer_load_dword v75, v4, s[28:31], s55 offen offset:768 sc0 sc1
    buffer_load_dword v76, v4, s[28:31], s55 offen offset:1024 sc0 sc1
    buffer_load_dword v77, v4, s[28:31], s55 offen offset:1280 sc0 sc1
    buffer_load_dword v78, v4, s[28:31], s55 offen offset:1536 sc0 sc1
    buffer_load_dword v79, v4, s[28:31], s55 offen offset:1792 sc0 sc1
    s_add_u32 s55, s55, 8192
    s_waitcnt vmcnt(0)
    v_add_f32 v16, v16, v24
    v_add_f32 v17, v17, v25
    v_add_f32 v18, v18, v26
    v_add_f32 v19, v19, v27
    v_add_f32 v20, v20, v28
    v_add_f32 v21, v21, v29
    v_add_f32 v22, v22, v30
    v_add_f32 v23, v23, v31
    v_add_f32 v16, v16, v32
    v_add_f32 v17, v17, v33
    v_add_f32 v18, v18, v34
    v_add_f32 v19, v19, v35
    v_add_f32 v20, v20, v36
    v_add_f32 v21, v21, v37
    v_add_f32 v22, v22, v38
    v_add_f32 v23, v23, v39
    v_add_f32 v16, v16, v40
    v_add_f32 v17, v17, v41
    v_add_f32 v18, v18, v42
    v_add_f32 v19, v19, v43
    v_add_f32 v20, v20, v44
    v_add_f32 v21, v21, v45
    v_add_f32 v22, v22, v46
    v_add_f32 v23, v23, v47
    v_add_f32 v16, v16, v48
    v_add_f32 v17, v17, v49
    v_add_f32 v18, v18, v50
    v_add_f32 v19, v19, v51
    v_add_f32 v20, v20, v52
    v_add_f32 v21, v21, v53
    v_add_f32 v22, v22, v54
    v_add_f32 v23, v23, v55
    v_add_f32 v16, v16, v56
    v_add_f32 v17, v17, v57
    v_add_f32 v18, v18, v58
    v_add_f32 v19, v19, v59
    v_add_f32 v20, v20, v60
    v_add_f32 v21, v21, v61
    v_add_f32 v22, v22, v62
    v_add_f32 v23, v23, v63
    v_add_f32 v16, v16, v64
    v_add_f32 v17, v17, v65
    v_add_f32 v18, v18, v66
    v_add_f32 v19, v19, v67
    v_add_f32 v20, v20, v68
    v_add_f32 v21, v21, v69
    v_add_f32 v22, v22, v70
    v_add_f32 v23, v23, v71
    v_add_f32 v16, v16, v72
    v_add_f32 v17, v17, v73
    v_add_f32 v18, v18, v74
    v_add_f32 v19, v19, v75
    v_add_f32 v20, v20, v76
    v_add_f32 v21, v21, v77
    v_add_f32 v22, v22, v78
    v_add_f32 v23, v23, v79
    s_lshr_b32 s58, s36, 1
    s_and_b32 s59, s36, 1
    s_lshl_b32 s58, s58, 6
    s_lshl_b32 s59, s59, 3
    s_add_u32 s58, s58, s59
    s_lshl_b32 s59, s52, 12
    s_add_u32 s58, s58, s59
    s_add_u32 s58, s58, 0x12d8000
    v_lshlrev_b32 v4, 7, v2
    v_lshl_add_u32 v4, v3, 4, v4
    v_cvt_pk_bf16_f32 v96, v16, v17
    v_cvt_pk_bf16_f32 v97, v18, v19
    buffer_store_dwordx2 v[96:97], v4, s[28:31], s58 offen offset:0
    v_cvt_pk_bf16_f32 v96, v20, v21
    v_cvt_pk_bf16_f32 v97, v22, v23
    buffer_store_dwordx2 v[96:97], v4, s[28:31], s58 offen offset:2048
L_kv_kernel_end:
    s_endpgm
.globl o_kernel
.p2align 8
.type o_kernel,@function
o_kernel:
    s_cmp_ge_u32 s2, 256
    s_cbranch_scc1 L_o_kernel_end
    s_load_dwordx16 s[4:19], s[0:1], 0
    s_load_dwordx8 s[20:27], s[0:1], 64
    v_lshrrev_b32 v1, 6, v0
    s_nop 0
    v_readfirstlane_b32 s36, v1
    v_and_b32 v1, 63, v0
    v_and_b32 v2, 15, v1
    v_lshrrev_b32 v3, 4, v1
    s_and_b32 s51, s2, 7
    s_lshr_b32 s52, s2, 3
    s_lshl_b32 s53, s51, 8
    s_lshl_b32 s54, s36, 6
    s_add_u32 s53, s53, s54
    s_waitcnt lgkmcnt(0)
    s_mov_b32 s28, s26
    s_mov_b32 s29, s27
    s_and_b32 s29, s29, 0xffff
    s_mov_b32 s30, 0x10000000
    s_mov_b32 s31, 0x00020000
    s_lshl_b32 s55, s52, 11
    v_lshlrev_b32 v4, 6, v2
    v_lshl_add_u32 v4, v3, 4, v4
    s_add_u32 s55, s55, 0x288000
    buffer_load_dwordx4 v[8:11], v4, s[28:31], s55 offen
    buffer_load_dwordx4 v[12:15], v4, s[28:31], s55 offen offset:1024
    s_lshl_b32 s55, s52, 12
    s_add_u32 s55, s55, 0x12d8000
    v_lshlrev_b32 v4, 7, v2
    v_lshl_add_u32 v4, v3, 4, v4
    buffer_load_dwordx4 v[16:19], v4, s[28:31], s55 offen offset:0
    buffer_load_dwordx4 v[20:23], v4, s[28:31], s55 offen offset:64
    buffer_load_dwordx4 v[24:27], v4, s[28:31], s55 offen offset:2048
    buffer_load_dwordx4 v[28:31], v4, s[28:31], s55 offen offset:2112
    v_cmp_eq_u32 s[56:57], 0, v3
    v_lshlrev_b32 v5, 6, v2
    v_lshl_add_u32 v5, v3, 4, v5
    s_movk_i32 s58, 1152
    v_mul_lo_u32 v6, v2, s58
    v_lshl_add_u32 v6, v3, 3, v6
    s_lshl_b32 s55, s52, 11
    s_add_u32 s55, s55, s53
    s_add_u32 s55, s55, 0
    s_lshl_b32 s55, s55, 6
    s_add_u32 s55, s55, 0x4d8000
    buffer_load_dwordx4 v[32:35], v5, s[28:31], s55 offen
    s_waitcnt vmcnt(0)
    v_mfma_f32_16x16x32_bf16 v[36:39], v[8:11], v[32:35], 0
    v_mfma_f32_16x16x32_bf16 v[40:43], v[12:15], v[32:35], 0
    s_nop 6
    v_cvt_pk_bf16_f32 v36, v36, v36
    v_lshlrev_b32 v36, 16, v36
    v_cvt_pk_bf16_f32 v37, v37, v37
    v_lshlrev_b32 v37, 16, v37
    v_cvt_pk_bf16_f32 v38, v38, v38
    v_lshlrev_b32 v38, 16, v38
    v_cvt_pk_bf16_f32 v39, v39, v39
    v_lshlrev_b32 v39, 16, v39
    v_cvt_pk_bf16_f32 v40, v40, v40
    v_lshlrev_b32 v40, 16, v40
    v_cvt_pk_bf16_f32 v41, v41, v41
    v_lshlrev_b32 v41, 16, v41
    v_mov_b32 v44, v36
    v_mov_b32 v45, v37
    v_mov_b32 v46, v38
    v_mov_b32 v47, v39
    v_mov_b32 v52, v40
    v_mov_b32 v48, 0xff800000
    v_cndmask_b32 v48, v48, v52, s[56:57]
    v_mov_b32 v52, v41
    v_mov_b32 v49, 0xff800000
    v_cndmask_b32 v49, v49, v52, s[56:57]
    v_max3_f32 v50, v44, v45, v46
    v_max3_f32 v50, v50, v47, v48
    v_max_f32 v50, v50, v49
    v_mov_b32 v52, v50
    s_nop 1
    v_permlane16_swap_b32 v50, v52
    v_max_f32 v50, v50, v52
    v_mov_b32 v52, v50
    s_nop 1
    v_permlane32_swap_b32 v50, v52
    v_max_f32 v50, v50, v52
    v_sub_f32 v44, v44, v50
    v_mul_f32 v44, 0x3fb8aa3b, v44
    v_exp_f32 v44, v44
    v_sub_f32 v45, v45, v50
    v_mul_f32 v45, 0x3fb8aa3b, v45
    v_exp_f32 v45, v45
    v_sub_f32 v46, v46, v50
    v_mul_f32 v46, 0x3fb8aa3b, v46
    v_exp_f32 v46, v46
    v_sub_f32 v47, v47, v50
    v_mul_f32 v47, 0x3fb8aa3b, v47
    v_exp_f32 v47, v47
    v_sub_f32 v48, v48, v50
    v_mul_f32 v48, 0x3fb8aa3b, v48
    v_exp_f32 v48, v48
    v_sub_f32 v49, v49, v50
    v_mul_f32 v49, 0x3fb8aa3b, v49
    v_exp_f32 v49, v49
    v_add_f32 v51, v44, v45
    v_add_f32 v51, v51, v46
    v_add_f32 v51, v51, v47
    v_add_f32 v51, v51, v48
    v_add_f32 v51, v51, v49
    v_mov_b32 v52, v51
    s_nop 1
    v_permlane16_swap_b32 v51, v52
    v_add_f32 v51, v51, v52
    v_mov_b32 v52, v51
    s_nop 1
    v_permlane32_swap_b32 v51, v52
    v_add_f32 v51, v51, v52
    v_rcp_f32 v51, v51
    s_nop 0
    v_mul_f32 v44, v44, v51
    v_mul_f32 v45, v45, v51
    v_mul_f32 v46, v46, v51
    v_mul_f32 v47, v47, v51
    v_mul_f32 v48, v48, v51
    v_mul_f32 v49, v49, v51
    v_cvt_pk_bf16_f32 v64, v44, v45
    v_cvt_pk_bf16_f32 v65, v46, v47
    v_cvt_pk_bf16_f32 v66, v48, v49
    v_mov_b32 v67, 0
    v_sub_f32 v44, 0, v36
    v_sub_f32 v45, 0, v37
    v_sub_f32 v46, 0, v38
    v_sub_f32 v47, 0, v39
    v_sub_f32 v52, 0, v40
    v_mov_b32 v48, 0xff800000
    v_cndmask_b32 v48, v48, v52, s[56:57]
    v_sub_f32 v52, 0, v41
    v_mov_b32 v49, 0xff800000
    v_cndmask_b32 v49, v49, v52, s[56:57]
    v_max3_f32 v50, v44, v45, v46
    v_max3_f32 v50, v50, v47, v48
    v_max_f32 v50, v50, v49
    v_mov_b32 v52, v50
    s_nop 1
    v_permlane16_swap_b32 v50, v52
    v_max_f32 v50, v50, v52
    v_mov_b32 v52, v50
    s_nop 1
    v_permlane32_swap_b32 v50, v52
    v_max_f32 v50, v50, v52
    v_sub_f32 v44, v44, v50
    v_mul_f32 v44, 0x3fb8aa3b, v44
    v_exp_f32 v44, v44
    v_sub_f32 v45, v45, v50
    v_mul_f32 v45, 0x3fb8aa3b, v45
    v_exp_f32 v45, v45
    v_sub_f32 v46, v46, v50
    v_mul_f32 v46, 0x3fb8aa3b, v46
    v_exp_f32 v46, v46
    v_sub_f32 v47, v47, v50
    v_mul_f32 v47, 0x3fb8aa3b, v47
    v_exp_f32 v47, v47
    v_sub_f32 v48, v48, v50
    v_mul_f32 v48, 0x3fb8aa3b, v48
    v_exp_f32 v48, v48
    v_sub_f32 v49, v49, v50
    v_mul_f32 v49, 0x3fb8aa3b, v49
    v_exp_f32 v49, v49
    v_add_f32 v51, v44, v45
    v_add_f32 v51, v51, v46
    v_add_f32 v51, v51, v47
    v_add_f32 v51, v51, v48
    v_add_f32 v51, v51, v49
    v_mov_b32 v52, v51
    s_nop 1
    v_permlane16_swap_b32 v51, v52
    v_add_f32 v51, v51, v52
    v_mov_b32 v52, v51
    s_nop 1
    v_permlane32_swap_b32 v51, v52
    v_add_f32 v51, v51, v52
    v_rcp_f32 v51, v51
    s_nop 0
    v_mul_f32 v44, v44, v51
    v_mul_f32 v45, v45, v51
    v_mul_f32 v46, v46, v51
    v_mul_f32 v47, v47, v51
    v_mul_f32 v48, v48, v51
    v_mul_f32 v49, v49, v51
    v_cvt_pk_bf16_f32 v68, v44, v45
    v_cvt_pk_bf16_f32 v69, v46, v47
    v_cvt_pk_bf16_f32 v70, v48, v49
    v_mov_b32 v71, 0
    v_mfma_f32_16x16x32_bf16 v[72:75], v[16:19], v[64:67], 0
    s_nop 0
    v_mfma_f32_16x16x32_bf16 v[72:75], v[20:23], v[68:71], v[72:75]
    v_mfma_f32_16x16x32_bf16 v[76:79], v[24:27], v[64:67], 0
    v_mfma_f32_16x16x32_bf16 v[76:79], v[28:31], v[68:71], v[76:79]
    s_nop 7
    v_cvt_pk_bf16_f32 v78, v78, v78
    v_lshlrev_b32 v78, 16, v78
    v_add_f32 v78, 0x358637bd, v78
    v_cvt_pk_bf16_f32 v78, v78, v78
    v_lshlrev_b32 v78, 16, v78
    v_mov_b32 v44, 0xff800000
    v_cndmask_b32 v44, v44, v78, s[56:57]
    v_mov_b32 v45, v44
    s_nop 1
    v_permlane16_swap_b32 v44, v45
    v_max_f32 v44, v44, v45
    v_mov_b32 v45, v44
    s_nop 1
    v_permlane32_swap_b32 v44, v45
    v_max_f32 v44, v44, v45
    v_rcp_f32 v46, v44
    v_cvt_pk_bf16_f32 v72, v72, v72
    v_lshlrev_b32 v72, 16, v72
    v_mul_f32 v45, v72, v46
    v_fma_f32 v47, -v45, v44, v72
    v_fma_f32 v72, v47, v46, v45
    v_cvt_pk_bf16_f32 v73, v73, v73
    v_lshlrev_b32 v73, 16, v73
    v_mul_f32 v45, v73, v46
    v_fma_f32 v47, -v45, v44, v73
    v_fma_f32 v73, v47, v46, v45
    v_cvt_pk_bf16_f32 v74, v74, v74
    v_lshlrev_b32 v74, 16, v74
    v_mul_f32 v45, v74, v46
    v_fma_f32 v47, -v45, v44, v74
    v_fma_f32 v74, v47, v46, v45
    v_cvt_pk_bf16_f32 v75, v75, v75
    v_lshlrev_b32 v75, 16, v75
    v_mul_f32 v45, v75, v46
    v_fma_f32 v47, -v45, v44, v75
    v_fma_f32 v75, v47, v46, v45
    v_cvt_pk_bf16_f32 v76, v76, v76
    v_lshlrev_b32 v76, 16, v76
    v_mul_f32 v45, v76, v46
    v_fma_f32 v47, -v45, v44, v76
    v_fma_f32 v76, v47, v46, v45
    v_cvt_pk_bf16_f32 v77, v77, v77
    v_lshlrev_b32 v77, 16, v77
    v_mul_f32 v45, v77, v46
    v_fma_f32 v47, -v45, v44, v77
    v_fma_f32 v77, v47, v46, v45
    v_cvt_pk_bf16_f32 v48, v72, v73
    v_cvt_pk_bf16_f32 v49, v74, v75
    v_cvt_pk_bf16_f32 v50, v76, v77
    s_add_u32 s55, s53, 0
    s_mul_i32 s55, s55, 1152
    s_mul_i32 s58, s52, 36
    s_add_u32 s55, s55, s58
    s_add_u32 s55, s55, 0x12f8000
    buffer_store_dwordx2 v[48:49], v6, s[28:31], s55 offen
    s_mov_b64 exec, s[56:57]
    buffer_store_dword v50, v6, s[28:31], s55 offen offset:32
    s_mov_b64 exec, -1
    s_lshl_b32 s55, s52, 11
    s_add_u32 s55, s55, s53
    s_add_u32 s55, s55, 16
    s_lshl_b32 s55, s55, 6
    s_add_u32 s55, s55, 0x4d8000
    buffer_load_dwordx4 v[32:35], v5, s[28:31], s55 offen
    s_waitcnt vmcnt(0)
    v_mfma_f32_16x16x32_bf16 v[36:39], v[8:11], v[32:35], 0
    v_mfma_f32_16x16x32_bf16 v[40:43], v[12:15], v[32:35], 0
    s_nop 6
    v_cvt_pk_bf16_f32 v36, v36, v36
    v_lshlrev_b32 v36, 16, v36
    v_cvt_pk_bf16_f32 v37, v37, v37
    v_lshlrev_b32 v37, 16, v37
    v_cvt_pk_bf16_f32 v38, v38, v38
    v_lshlrev_b32 v38, 16, v38
    v_cvt_pk_bf16_f32 v39, v39, v39
    v_lshlrev_b32 v39, 16, v39
    v_cvt_pk_bf16_f32 v40, v40, v40
    v_lshlrev_b32 v40, 16, v40
    v_cvt_pk_bf16_f32 v41, v41, v41
    v_lshlrev_b32 v41, 16, v41
    v_mov_b32 v44, v36
    v_mov_b32 v45, v37
    v_mov_b32 v46, v38
    v_mov_b32 v47, v39
    v_mov_b32 v52, v40
    v_mov_b32 v48, 0xff800000
    v_cndmask_b32 v48, v48, v52, s[56:57]
    v_mov_b32 v52, v41
    v_mov_b32 v49, 0xff800000
    v_cndmask_b32 v49, v49, v52, s[56:57]
    v_max3_f32 v50, v44, v45, v46
    v_max3_f32 v50, v50, v47, v48
    v_max_f32 v50, v50, v49
    v_mov_b32 v52, v50
    s_nop 1
    v_permlane16_swap_b32 v50, v52
    v_max_f32 v50, v50, v52
    v_mov_b32 v52, v50
    s_nop 1
    v_permlane32_swap_b32 v50, v52
    v_max_f32 v50, v50, v52
    v_sub_f32 v44, v44, v50
    v_mul_f32 v44, 0x3fb8aa3b, v44
    v_exp_f32 v44, v44
    v_sub_f32 v45, v45, v50
    v_mul_f32 v45, 0x3fb8aa3b, v45
    v_exp_f32 v45, v45
    v_sub_f32 v46, v46, v50
    v_mul_f32 v46, 0x3fb8aa3b, v46
    v_exp_f32 v46, v46
    v_sub_f32 v47, v47, v50
    v_mul_f32 v47, 0x3fb8aa3b, v47
    v_exp_f32 v47, v47
    v_sub_f32 v48, v48, v50
    v_mul_f32 v48, 0x3fb8aa3b, v48
    v_exp_f32 v48, v48
    v_sub_f32 v49, v49, v50
    v_mul_f32 v49, 0x3fb8aa3b, v49
    v_exp_f32 v49, v49
    v_add_f32 v51, v44, v45
    v_add_f32 v51, v51, v46
    v_add_f32 v51, v51, v47
    v_add_f32 v51, v51, v48
    v_add_f32 v51, v51, v49
    v_mov_b32 v52, v51
    s_nop 1
    v_permlane16_swap_b32 v51, v52
    v_add_f32 v51, v51, v52
    v_mov_b32 v52, v51
    s_nop 1
    v_permlane32_swap_b32 v51, v52
    v_add_f32 v51, v51, v52
    v_rcp_f32 v51, v51
    s_nop 0
    v_mul_f32 v44, v44, v51
    v_mul_f32 v45, v45, v51
    v_mul_f32 v46, v46, v51
    v_mul_f32 v47, v47, v51
    v_mul_f32 v48, v48, v51
    v_mul_f32 v49, v49, v51
    v_cvt_pk_bf16_f32 v64, v44, v45
    v_cvt_pk_bf16_f32 v65, v46, v47
    v_cvt_pk_bf16_f32 v66, v48, v49
    v_mov_b32 v67, 0
    v_sub_f32 v44, 0, v36
    v_sub_f32 v45, 0, v37
    v_sub_f32 v46, 0, v38
    v_sub_f32 v47, 0, v39
    v_sub_f32 v52, 0, v40
    v_mov_b32 v48, 0xff800000
    v_cndmask_b32 v48, v48, v52, s[56:57]
    v_sub_f32 v52, 0, v41
    v_mov_b32 v49, 0xff800000
    v_cndmask_b32 v49, v49, v52, s[56:57]
    v_max3_f32 v50, v44, v45, v46
    v_max3_f32 v50, v50, v47, v48
    v_max_f32 v50, v50, v49
    v_mov_b32 v52, v50
    s_nop 1
    v_permlane16_swap_b32 v50, v52
    v_max_f32 v50, v50, v52
    v_mov_b32 v52, v50
    s_nop 1
    v_permlane32_swap_b32 v50, v52
    v_max_f32 v50, v50, v52
    v_sub_f32 v44, v44, v50
    v_mul_f32 v44, 0x3fb8aa3b, v44
    v_exp_f32 v44, v44
    v_sub_f32 v45, v45, v50
    v_mul_f32 v45, 0x3fb8aa3b, v45
    v_exp_f32 v45, v45
    v_sub_f32 v46, v46, v50
    v_mul_f32 v46, 0x3fb8aa3b, v46
    v_exp_f32 v46, v46
    v_sub_f32 v47, v47, v50
    v_mul_f32 v47, 0x3fb8aa3b, v47
    v_exp_f32 v47, v47
    v_sub_f32 v48, v48, v50
    v_mul_f32 v48, 0x3fb8aa3b, v48
    v_exp_f32 v48, v48
    v_sub_f32 v49, v49, v50
    v_mul_f32 v49, 0x3fb8aa3b, v49
    v_exp_f32 v49, v49
    v_add_f32 v51, v44, v45
    v_add_f32 v51, v51, v46
    v_add_f32 v51, v51, v47
    v_add_f32 v51, v51, v48
    v_add_f32 v51, v51, v49
    v_mov_b32 v52, v51
    s_nop 1
    v_permlane16_swap_b32 v51, v52
    v_add_f32 v51, v51, v52
    v_mov_b32 v52, v51
    s_nop 1
    v_permlane32_swap_b32 v51, v52
    v_add_f32 v51, v51, v52
    v_rcp_f32 v51, v51
    s_nop 0
    v_mul_f32 v44, v44, v51
    v_mul_f32 v45, v45, v51
    v_mul_f32 v46, v46, v51
    v_mul_f32 v47, v47, v51
    v_mul_f32 v48, v48, v51
    v_mul_f32 v49, v49, v51
    v_cvt_pk_bf16_f32 v68, v44, v45
    v_cvt_pk_bf16_f32 v69, v46, v47
    v_cvt_pk_bf16_f32 v70, v48, v49
    v_mov_b32 v71, 0
    v_mfma_f32_16x16x32_bf16 v[72:75], v[16:19], v[64:67], 0
    s_nop 0
    v_mfma_f32_16x16x32_bf16 v[72:75], v[20:23], v[68:71], v[72:75]
    v_mfma_f32_16x16x32_bf16 v[76:79], v[24:27], v[64:67], 0
    v_mfma_f32_16x16x32_bf16 v[76:79], v[28:31], v[68:71], v[76:79]
    s_nop 7
    v_cvt_pk_bf16_f32 v78, v78, v78
    v_lshlrev_b32 v78, 16, v78
    v_add_f32 v78, 0x358637bd, v78
    v_cvt_pk_bf16_f32 v78, v78, v78
    v_lshlrev_b32 v78, 16, v78
    v_mov_b32 v44, 0xff800000
    v_cndmask_b32 v44, v44, v78, s[56:57]
    v_mov_b32 v45, v44
    s_nop 1
    v_permlane16_swap_b32 v44, v45
    v_max_f32 v44, v44, v45
    v_mov_b32 v45, v44
    s_nop 1
    v_permlane32_swap_b32 v44, v45
    v_max_f32 v44, v44, v45
    v_rcp_f32 v46, v44
    v_cvt_pk_bf16_f32 v72, v72, v72
    v_lshlrev_b32 v72, 16, v72
    v_mul_f32 v45, v72, v46
    v_fma_f32 v47, -v45, v44, v72
    v_fma_f32 v72, v47, v46, v45
    v_cvt_pk_bf16_f32 v73, v73, v73
    v_lshlrev_b32 v73, 16, v73
    v_mul_f32 v45, v73, v46
    v_fma_f32 v47, -v45, v44, v73
    v_fma_f32 v73, v47, v46, v45
    v_cvt_pk_bf16_f32 v74, v74, v74
    v_lshlrev_b32 v74, 16, v74
    v_mul_f32 v45, v74, v46
    v_fma_f32 v47, -v45, v44, v74
    v_fma_f32 v74, v47, v46, v45
    v_cvt_pk_bf16_f32 v75, v75, v75
    v_lshlrev_b32 v75, 16, v75
    v_mul_f32 v45, v75, v46
    v_fma_f32 v47, -v45, v44, v75
    v_fma_f32 v75, v47, v46, v45
    v_cvt_pk_bf16_f32 v76, v76, v76
    v_lshlrev_b32 v76, 16, v76
    v_mul_f32 v45, v76, v46
    v_fma_f32 v47, -v45, v44, v76
    v_fma_f32 v76, v47, v46, v45
    v_cvt_pk_bf16_f32 v77, v77, v77
    v_lshlrev_b32 v77, 16, v77
    v_mul_f32 v45, v77, v46
    v_fma_f32 v47, -v45, v44, v77
    v_fma_f32 v77, v47, v46, v45
    v_cvt_pk_bf16_f32 v48, v72, v73
    v_cvt_pk_bf16_f32 v49, v74, v75
    v_cvt_pk_bf16_f32 v50, v76, v77
    s_add_u32 s55, s53, 16
    s_mul_i32 s55, s55, 1152
    s_mul_i32 s58, s52, 36
    s_add_u32 s55, s55, s58
    s_add_u32 s55, s55, 0x12f8000
    buffer_store_dwordx2 v[48:49], v6, s[28:31], s55 offen
    s_mov_b64 exec, s[56:57]
    buffer_store_dword v50, v6, s[28:31], s55 offen offset:32
    s_mov_b64 exec, -1
    s_lshl_b32 s55, s52, 11
    s_add_u32 s55, s55, s53
    s_add_u32 s55, s55, 32
    s_lshl_b32 s55, s55, 6
    s_add_u32 s55, s55, 0x4d8000
    buffer_load_dwordx4 v[32:35], v5, s[28:31], s55 offen
    s_waitcnt vmcnt(0)
    v_mfma_f32_16x16x32_bf16 v[36:39], v[8:11], v[32:35], 0
    v_mfma_f32_16x16x32_bf16 v[40:43], v[12:15], v[32:35], 0
    s_nop 6
    v_cvt_pk_bf16_f32 v36, v36, v36
    v_lshlrev_b32 v36, 16, v36
    v_cvt_pk_bf16_f32 v37, v37, v37
    v_lshlrev_b32 v37, 16, v37
    v_cvt_pk_bf16_f32 v38, v38, v38
    v_lshlrev_b32 v38, 16, v38
    v_cvt_pk_bf16_f32 v39, v39, v39
    v_lshlrev_b32 v39, 16, v39
    v_cvt_pk_bf16_f32 v40, v40, v40
    v_lshlrev_b32 v40, 16, v40
    v_cvt_pk_bf16_f32 v41, v41, v41
    v_lshlrev_b32 v41, 16, v41
    v_mov_b32 v44, v36
    v_mov_b32 v45, v37
    v_mov_b32 v46, v38
    v_mov_b32 v47, v39
    v_mov_b32 v52, v40
    v_mov_b32 v48, 0xff800000
    v_cndmask_b32 v48, v48, v52, s[56:57]
    v_mov_b32 v52, v41
    v_mov_b32 v49, 0xff800000
    v_cndmask_b32 v49, v49, v52, s[56:57]
    v_max3_f32 v50, v44, v45, v46
    v_max3_f32 v50, v50, v47, v48
    v_max_f32 v50, v50, v49
    v_mov_b32 v52, v50
    s_nop 1
    v_permlane16_swap_b32 v50, v52
    v_max_f32 v50, v50, v52
    v_mov_b32 v52, v50
    s_nop 1
    v_permlane32_swap_b32 v50, v52
    v_max_f32 v50, v50, v52
    v_sub_f32 v44, v44, v50
    v_mul_f32 v44, 0x3fb8aa3b, v44
    v_exp_f32 v44, v44
    v_sub_f32 v45, v45, v50
    v_mul_f32 v45, 0x3fb8aa3b, v45
    v_exp_f32 v45, v45
    v_sub_f32 v46, v46, v50
    v_mul_f32 v46, 0x3fb8aa3b, v46
    v_exp_f32 v46, v46
    v_sub_f32 v47, v47, v50
    v_mul_f32 v47, 0x3fb8aa3b, v47
    v_exp_f32 v47, v47
    v_sub_f32 v48, v48, v50
    v_mul_f32 v48, 0x3fb8aa3b, v48
    v_exp_f32 v48, v48
    v_sub_f32 v49, v49, v50
    v_mul_f32 v49, 0x3fb8aa3b, v49
    v_exp_f32 v49, v49
    v_add_f32 v51, v44, v45
    v_add_f32 v51, v51, v46
    v_add_f32 v51, v51, v47
    v_add_f32 v51, v51, v48
    v_add_f32 v51, v51, v49
    v_mov_b32 v52, v51
    s_nop 1
    v_permlane16_swap_b32 v51, v52
    v_add_f32 v51, v51, v52
    v_mov_b32 v52, v51
    s_nop 1
    v_permlane32_swap_b32 v51, v52
    v_add_f32 v51, v51, v52
    v_rcp_f32 v51, v51
    s_nop 0
    v_mul_f32 v44, v44, v51
    v_mul_f32 v45, v45, v51
    v_mul_f32 v46, v46, v51
    v_mul_f32 v47, v47, v51
    v_mul_f32 v48, v48, v51
    v_mul_f32 v49, v49, v51
    v_cvt_pk_bf16_f32 v64, v44, v45
    v_cvt_pk_bf16_f32 v65, v46, v47
    v_cvt_pk_bf16_f32 v66, v48, v49
    v_mov_b32 v67, 0
    v_sub_f32 v44, 0, v36
    v_sub_f32 v45, 0, v37
    v_sub_f32 v46, 0, v38
    v_sub_f32 v47, 0, v39
    v_sub_f32 v52, 0, v40
    v_mov_b32 v48, 0xff800000
    v_cndmask_b32 v48, v48, v52, s[56:57]
    v_sub_f32 v52, 0, v41
    v_mov_b32 v49, 0xff800000
    v_cndmask_b32 v49, v49, v52, s[56:57]
    v_max3_f32 v50, v44, v45, v46
    v_max3_f32 v50, v50, v47, v48
    v_max_f32 v50, v50, v49
    v_mov_b32 v52, v50
    s_nop 1
    v_permlane16_swap_b32 v50, v52
    v_max_f32 v50, v50, v52
    v_mov_b32 v52, v50
    s_nop 1
    v_permlane32_swap_b32 v50, v52
    v_max_f32 v50, v50, v52
    v_sub_f32 v44, v44, v50
    v_mul_f32 v44, 0x3fb8aa3b, v44
    v_exp_f32 v44, v44
    v_sub_f32 v45, v45, v50
    v_mul_f32 v45, 0x3fb8aa3b, v45
    v_exp_f32 v45, v45
    v_sub_f32 v46, v46, v50
    v_mul_f32 v46, 0x3fb8aa3b, v46
    v_exp_f32 v46, v46
    v_sub_f32 v47, v47, v50
    v_mul_f32 v47, 0x3fb8aa3b, v47
    v_exp_f32 v47, v47
    v_sub_f32 v48, v48, v50
    v_mul_f32 v48, 0x3fb8aa3b, v48
    v_exp_f32 v48, v48
    v_sub_f32 v49, v49, v50
    v_mul_f32 v49, 0x3fb8aa3b, v49
    v_exp_f32 v49, v49
    v_add_f32 v51, v44, v45
    v_add_f32 v51, v51, v46
    v_add_f32 v51, v51, v47
    v_add_f32 v51, v51, v48
    v_add_f32 v51, v51, v49
    v_mov_b32 v52, v51
    s_nop 1
    v_permlane16_swap_b32 v51, v52
    v_add_f32 v51, v51, v52
    v_mov_b32 v52, v51
    s_nop 1
    v_permlane32_swap_b32 v51, v52
    v_add_f32 v51, v51, v52
    v_rcp_f32 v51, v51
    s_nop 0
    v_mul_f32 v44, v44, v51
    v_mul_f32 v45, v45, v51
    v_mul_f32 v46, v46, v51
    v_mul_f32 v47, v47, v51
    v_mul_f32 v48, v48, v51
    v_mul_f32 v49, v49, v51
    v_cvt_pk_bf16_f32 v68, v44, v45
    v_cvt_pk_bf16_f32 v69, v46, v47
    v_cvt_pk_bf16_f32 v70, v48, v49
    v_mov_b32 v71, 0
    v_mfma_f32_16x16x32_bf16 v[72:75], v[16:19], v[64:67], 0
    s_nop 0
    v_mfma_f32_16x16x32_bf16 v[72:75], v[20:23], v[68:71], v[72:75]
    v_mfma_f32_16x16x32_bf16 v[76:79], v[24:27], v[64:67], 0
    v_mfma_f32_16x16x32_bf16 v[76:79], v[28:31], v[68:71], v[76:79]
    s_nop 7
    v_cvt_pk_bf16_f32 v78, v78, v78
    v_lshlrev_b32 v78, 16, v78
    v_add_f32 v78, 0x358637bd, v78
    v_cvt_pk_bf16_f32 v78, v78, v78
    v_lshlrev_b32 v78, 16, v78
    v_mov_b32 v44, 0xff800000
    v_cndmask_b32 v44, v44, v78, s[56:57]
    v_mov_b32 v45, v44
    s_nop 1
    v_permlane16_swap_b32 v44, v45
    v_max_f32 v44, v44, v45
    v_mov_b32 v45, v44
    s_nop 1
    v_permlane32_swap_b32 v44, v45
    v_max_f32 v44, v44, v45
    v_rcp_f32 v46, v44
    v_cvt_pk_bf16_f32 v72, v72, v72
    v_lshlrev_b32 v72, 16, v72
    v_mul_f32 v45, v72, v46
    v_fma_f32 v47, -v45, v44, v72
    v_fma_f32 v72, v47, v46, v45
    v_cvt_pk_bf16_f32 v73, v73, v73
    v_lshlrev_b32 v73, 16, v73
    v_mul_f32 v45, v73, v46
    v_fma_f32 v47, -v45, v44, v73
    v_fma_f32 v73, v47, v46, v45
    v_cvt_pk_bf16_f32 v74, v74, v74
    v_lshlrev_b32 v74, 16, v74
    v_mul_f32 v45, v74, v46
    v_fma_f32 v47, -v45, v44, v74
    v_fma_f32 v74, v47, v46, v45
    v_cvt_pk_bf16_f32 v75, v75, v75
    v_lshlrev_b32 v75, 16, v75
    v_mul_f32 v45, v75, v46
    v_fma_f32 v47, -v45, v44, v75
    v_fma_f32 v75, v47, v46, v45
    v_cvt_pk_bf16_f32 v76, v76, v76
    v_lshlrev_b32 v76, 16, v76
    v_mul_f32 v45, v76, v46
    v_fma_f32 v47, -v45, v44, v76
    v_fma_f32 v76, v47, v46, v45
    v_cvt_pk_bf16_f32 v77, v77, v77
    v_lshlrev_b32 v77, 16, v77
    v_mul_f32 v45, v77, v46
    v_fma_f32 v47, -v45, v44, v77
    v_fma_f32 v77, v47, v46, v45
    v_cvt_pk_bf16_f32 v48, v72, v73
    v_cvt_pk_bf16_f32 v49, v74, v75
    v_cvt_pk_bf16_f32 v50, v76, v77
    s_add_u32 s55, s53, 32
    s_mul_i32 s55, s55, 1152
    s_mul_i32 s58, s52, 36
    s_add_u32 s55, s55, s58
    s_add_u32 s55, s55, 0x12f8000
    buffer_store_dwordx2 v[48:49], v6, s[28:31], s55 offen
    s_mov_b64 exec, s[56:57]
    buffer_store_dword v50, v6, s[28:31], s55 offen offset:32
    s_mov_b64 exec, -1
    s_lshl_b32 s55, s52, 11
    s_add_u32 s55, s55, s53
    s_add_u32 s55, s55, 48
    s_lshl_b32 s55, s55, 6
    s_add_u32 s55, s55, 0x4d8000
    buffer_load_dwordx4 v[32:35], v5, s[28:31], s55 offen
    s_waitcnt vmcnt(0)
    v_mfma_f32_16x16x32_bf16 v[36:39], v[8:11], v[32:35], 0
    v_mfma_f32_16x16x32_bf16 v[40:43], v[12:15], v[32:35], 0
    s_nop 6
    v_cvt_pk_bf16_f32 v36, v36, v36
    v_lshlrev_b32 v36, 16, v36
    v_cvt_pk_bf16_f32 v37, v37, v37
    v_lshlrev_b32 v37, 16, v37
    v_cvt_pk_bf16_f32 v38, v38, v38
    v_lshlrev_b32 v38, 16, v38
    v_cvt_pk_bf16_f32 v39, v39, v39
    v_lshlrev_b32 v39, 16, v39
    v_cvt_pk_bf16_f32 v40, v40, v40
    v_lshlrev_b32 v40, 16, v40
    v_cvt_pk_bf16_f32 v41, v41, v41
    v_lshlrev_b32 v41, 16, v41
    v_mov_b32 v44, v36
    v_mov_b32 v45, v37
    v_mov_b32 v46, v38
    v_mov_b32 v47, v39
    v_mov_b32 v52, v40
    v_mov_b32 v48, 0xff800000
    v_cndmask_b32 v48, v48, v52, s[56:57]
    v_mov_b32 v52, v41
    v_mov_b32 v49, 0xff800000
    v_cndmask_b32 v49, v49, v52, s[56:57]
    v_max3_f32 v50, v44, v45, v46
    v_max3_f32 v50, v50, v47, v48
    v_max_f32 v50, v50, v49
    v_mov_b32 v52, v50
    s_nop 1
    v_permlane16_swap_b32 v50, v52
    v_max_f32 v50, v50, v52
    v_mov_b32 v52, v50
    s_nop 1
    v_permlane32_swap_b32 v50, v52
    v_max_f32 v50, v50, v52
    v_sub_f32 v44, v44, v50
    v_mul_f32 v44, 0x3fb8aa3b, v44
    v_exp_f32 v44, v44
    v_sub_f32 v45, v45, v50
    v_mul_f32 v45, 0x3fb8aa3b, v45
    v_exp_f32 v45, v45
    v_sub_f32 v46, v46, v50
    v_mul_f32 v46, 0x3fb8aa3b, v46
    v_exp_f32 v46, v46
    v_sub_f32 v47, v47, v50
    v_mul_f32 v47, 0x3fb8aa3b, v47
    v_exp_f32 v47, v47
    v_sub_f32 v48, v48, v50
    v_mul_f32 v48, 0x3fb8aa3b, v48
    v_exp_f32 v48, v48
    v_sub_f32 v49, v49, v50
    v_mul_f32 v49, 0x3fb8aa3b, v49
    v_exp_f32 v49, v49
    v_add_f32 v51, v44, v45
    v_add_f32 v51, v51, v46
    v_add_f32 v51, v51, v47
    v_add_f32 v51, v51, v48
    v_add_f32 v51, v51, v49
    v_mov_b32 v52, v51
    s_nop 1
    v_permlane16_swap_b32 v51, v52
    v_add_f32 v51, v51, v52
    v_mov_b32 v52, v51
    s_nop 1
    v_permlane32_swap_b32 v51, v52
    v_add_f32 v51, v51, v52
    v_rcp_f32 v51, v51
    s_nop 0
    v_mul_f32 v44, v44, v51
    v_mul_f32 v45, v45, v51
    v_mul_f32 v46, v46, v51
    v_mul_f32 v47, v47, v51
    v_mul_f32 v48, v48, v51
    v_mul_f32 v49, v49, v51
    v_cvt_pk_bf16_f32 v64, v44, v45
    v_cvt_pk_bf16_f32 v65, v46, v47
    v_cvt_pk_bf16_f32 v66, v48, v49
    v_mov_b32 v67, 0
    v_sub_f32 v44, 0, v36
    v_sub_f32 v45, 0, v37
    v_sub_f32 v46, 0, v38
    v_sub_f32 v47, 0, v39
    v_sub_f32 v52, 0, v40
    v_mov_b32 v48, 0xff800000
    v_cndmask_b32 v48, v48, v52, s[56:57]
    v_sub_f32 v52, 0, v41
    v_mov_b32 v49, 0xff800000
    v_cndmask_b32 v49, v49, v52, s[56:57]
    v_max3_f32 v50, v44, v45, v46
    v_max3_f32 v50, v50, v47, v48
    v_max_f32 v50, v50, v49
    v_mov_b32 v52, v50
    s_nop 1
    v_permlane16_swap_b32 v50, v52
    v_max_f32 v50, v50, v52
    v_mov_b32 v52, v50
    s_nop 1
    v_permlane32_swap_b32 v50, v52
    v_max_f32 v50, v50, v52
    v_sub_f32 v44, v44, v50
    v_mul_f32 v44, 0x3fb8aa3b, v44
    v_exp_f32 v44, v44
    v_sub_f32 v45, v45, v50
    v_mul_f32 v45, 0x3fb8aa3b, v45
    v_exp_f32 v45, v45
    v_sub_f32 v46, v46, v50
    v_mul_f32 v46, 0x3fb8aa3b, v46
    v_exp_f32 v46, v46
    v_sub_f32 v47, v47, v50
    v_mul_f32 v47, 0x3fb8aa3b, v47
    v_exp_f32 v47, v47
    v_sub_f32 v48, v48, v50
    v_mul_f32 v48, 0x3fb8aa3b, v48
    v_exp_f32 v48, v48
    v_sub_f32 v49, v49, v50
    v_mul_f32 v49, 0x3fb8aa3b, v49
    v_exp_f32 v49, v49
    v_add_f32 v51, v44, v45
    v_add_f32 v51, v51, v46
    v_add_f32 v51, v51, v47
    v_add_f32 v51, v51, v48
    v_add_f32 v51, v51, v49
    v_mov_b32 v52, v51
    s_nop 1
    v_permlane16_swap_b32 v51, v52
    v_add_f32 v51, v51, v52
    v_mov_b32 v52, v51
    s_nop 1
    v_permlane32_swap_b32 v51, v52
    v_add_f32 v51, v51, v52
    v_rcp_f32 v51, v51
    s_nop 0
    v_mul_f32 v44, v44, v51
    v_mul_f32 v45, v45, v51
    v_mul_f32 v46, v46, v51
    v_mul_f32 v47, v47, v51
    v_mul_f32 v48, v48, v51
    v_mul_f32 v49, v49, v51
    v_cvt_pk_bf16_f32 v68, v44, v45
    v_cvt_pk_bf16_f32 v69, v46, v47
    v_cvt_pk_bf16_f32 v70, v48, v49
    v_mov_b32 v71, 0
    v_mfma_f32_16x16x32_bf16 v[72:75], v[16:19], v[64:67], 0
    s_nop 0
    v_mfma_f32_16x16x32_bf16 v[72:75], v[20:23], v[68:71], v[72:75]
    v_mfma_f32_16x16x32_bf16 v[76:79], v[24:27], v[64:67], 0
    v_mfma_f32_16x16x32_bf16 v[76:79], v[28:31], v[68:71], v[76:79]
    s_nop 7
    v_cvt_pk_bf16_f32 v78, v78, v78
    v_lshlrev_b32 v78, 16, v78
    v_add_f32 v78, 0x358637bd, v78
    v_cvt_pk_bf16_f32 v78, v78, v78
    v_lshlrev_b32 v78, 16, v78
    v_mov_b32 v44, 0xff800000
    v_cndmask_b32 v44, v44, v78, s[56:57]
    v_mov_b32 v45, v44
    s_nop 1
    v_permlane16_swap_b32 v44, v45
    v_max_f32 v44, v44, v45
    v_mov_b32 v45, v44
    s_nop 1
    v_permlane32_swap_b32 v44, v45
    v_max_f32 v44, v44, v45
    v_rcp_f32 v46, v44
    v_cvt_pk_bf16_f32 v72, v72, v72
    v_lshlrev_b32 v72, 16, v72
    v_mul_f32 v45, v72, v46
    v_fma_f32 v47, -v45, v44, v72
    v_fma_f32 v72, v47, v46, v45
    v_cvt_pk_bf16_f32 v73, v73, v73
    v_lshlrev_b32 v73, 16, v73
    v_mul_f32 v45, v73, v46
    v_fma_f32 v47, -v45, v44, v73
    v_fma_f32 v73, v47, v46, v45
    v_cvt_pk_bf16_f32 v74, v74, v74
    v_lshlrev_b32 v74, 16, v74
    v_mul_f32 v45, v74, v46
    v_fma_f32 v47, -v45, v44, v74
    v_fma_f32 v74, v47, v46, v45
    v_cvt_pk_bf16_f32 v75, v75, v75
    v_lshlrev_b32 v75, 16, v75
    v_mul_f32 v45, v75, v46
    v_fma_f32 v47, -v45, v44, v75
    v_fma_f32 v75, v47, v46, v45
    v_cvt_pk_bf16_f32 v76, v76, v76
    v_lshlrev_b32 v76, 16, v76
    v_mul_f32 v45, v76, v46
    v_fma_f32 v47, -v45, v44, v76
    v_fma_f32 v76, v47, v46, v45
    v_cvt_pk_bf16_f32 v77, v77, v77
    v_lshlrev_b32 v77, 16, v77
    v_mul_f32 v45, v77, v46
    v_fma_f32 v47, -v45, v44, v77
    v_fma_f32 v77, v47, v46, v45
    v_cvt_pk_bf16_f32 v48, v72, v73
    v_cvt_pk_bf16_f32 v49, v74, v75
    v_cvt_pk_bf16_f32 v50, v76, v77
    s_add_u32 s55, s53, 48
    s_mul_i32 s55, s55, 1152
    s_mul_i32 s58, s52, 36
    s_add_u32 s55, s55, s58
    s_add_u32 s55, s55, 0x12f8000
    buffer_store_dwordx2 v[48:49], v6, s[28:31], s55 offen
    s_mov_b64 exec, s[56:57]
    buffer_store_dword v50, v6, s[28:31], s55 offen offset:32
    s_mov_b64 exec, -1
L_o_kernel_end:
    s_endpgm
.globl op1_kernel
.p2align 8
.type op1_kernel,@function
op1_kernel:
    s_cmp_ge_u32 s2, 192
    s_cbranch_scc1 L_op1_kernel_end
    s_load_dwordx16 s[4:19], s[0:1], 0
    s_load_dwordx8 s[20:27], s[0:1], 64
    v_lshrrev_b32 v1, 6, v0
    s_nop 0
    v_readfirstlane_b32 s36, v1
    v_and_b32 v1, 63, v0
    s_lshl_b32 s37, s36, 10
    v_and_b32 v80, 15, v1
    v_lshlrev_b32 v80, 7, v80
    v_lshrrev_b32 v81, 4, v1
    v_and_b32 v82, 7, v1
    v_xor_b32 v81, v81, v82
    v_lshl_add_u32 v83, v81, 4, v80
    v_xor_b32 v84, 64, v83
    s_lshr_b32 s38, s36, 1
    s_and_b32 s39, s36, 1
    s_mul_i32 s40, s38, 4096
    s_mul_i32 s41, s39, 6144
    s_add_u32 s41, s41, 8192
    v_add_u32 v7, s40, v83
    v_add_u32 v8, s40, v84
    v_add_u32 v9, s41, v83
    v_add_u32 v10, s41, v84
    s_mov_b32 s42, s38
    s_mov_b32 s43, s39
    s_and_b32 s50, s2, 7
    s_lshr_b32 s51, s2, 3
    s_and_b32 s59, s51, 3
    s_lshl_b32 s50, s50, 2
    s_add_u32 s50, s50, s59
    s_lshr_b32 s52, s51, 2
    s_mov_b32 s51, s50
    s_lshl_b32 s53, s51, 6
    s_mul_i32 s54, s52, 96
    s_waitcnt lgkmcnt(0)
    s_mov_b32 s60, s4
    s_mov_b32 s61, s5
    s_and_b32 s61, s61, 0xffff
    s_mov_b32 s62, 0x240000
    s_mov_b32 s63, 0x00020000
    s_mul_i32 s56, s42, 32
    s_add_u32 s56, s56, s53
    s_mul_i32 s57, s43, 48
    s_add_u32 s57, s57, s54
    v_lshrrev_b32 v80, 4, v1
    v_lshlrev_b32 v80, 2, v80
    v_add_u32 v80, s56, v80
    s_movk_i32 s58, 576
    v_mul_lo_u32 v80, v80, s58
    v_and_b32 v81, 15, v1
    v_add_u32 v80, v80, v81
    v_add_u32 v80, s57, v80
    v_lshlrev_b32 v84, 1, v80
    s_mov_b32 s58, 0
    buffer_load_ushort v85, v84, s[60:63], s58 offen offset:0
    buffer_load_ushort v89, v84, s[60:63], s58 offen offset:32
    buffer_load_ushort v93, v84, s[60:63], s58 offen offset:64
    s_mov_b32 s58, 1152
    buffer_load_ushort v86, v84, s[60:63], s58 offen offset:0
    buffer_load_ushort v90, v84, s[60:63], s58 offen offset:32
    buffer_load_ushort v94, v84, s[60:63], s58 offen offset:64
    s_mov_b32 s58, 2304
    buffer_load_ushort v87, v84, s[60:63], s58 offen offset:0
    buffer_load_ushort v91, v84, s[60:63], s58 offen offset:32
    buffer_load_ushort v95, v84, s[60:63], s58 offen offset:64
    s_mov_b32 s58, 3456
    buffer_load_ushort v88, v84, s[60:63], s58 offen offset:0
    buffer_load_ushort v92, v84, s[60:63], s58 offen offset:32
    buffer_load_ushort v96, v84, s[60:63], s58 offen offset:64
    s_mov_b32 s58, 18432
    buffer_load_ushort v97, v84, s[60:63], s58 offen offset:0
    buffer_load_ushort v101, v84, s[60:63], s58 offen offset:32
    buffer_load_ushort v105, v84, s[60:63], s58 offen offset:64
    s_mov_b32 s58, 19584
    buffer_load_ushort v98, v84, s[60:63], s58 offen offset:0
    buffer_load_ushort v102, v84, s[60:63], s58 offen offset:32
    buffer_load_ushort v106, v84, s[60:63], s58 offen offset:64
    s_mov_b32 s58, 20736
    buffer_load_ushort v99, v84, s[60:63], s58 offen offset:0
    buffer_load_ushort v103, v84, s[60:63], s58 offen offset:32
    buffer_load_ushort v107, v84, s[60:63], s58 offen offset:64
    s_mov_b32 s58, 21888
    buffer_load_ushort v100, v84, s[60:63], s58 offen offset:0
    buffer_load_ushort v104, v84, s[60:63], s58 offen offset:32
    buffer_load_ushort v108, v84, s[60:63], s58 offen offset:64
    s_add_u32 s28, s26, 0x12f8000
    s_addc_u32 s29, s27, 0
    s_and_b32 s29, s29, 0xffff
    s_mov_b32 s30, 0x240000
    s_mov_b32 s31, 0x00020000
    s_add_u32 s32, s26, 0x1e6000
    s_addc_u32 s33, s27, 0
    s_and_b32 s33, s33, 0xffff
    s_mov_b32 s34, 0xa2000
    s_mov_b32 s35, 0x00020000
    v_lshrrev_b32 v80, 3, v1
    v_and_b32 v81, 7, v1
    v_xor_b32 v81, v81, v80
    v_lshlrev_b32 v81, 4, v81
    s_lshl_b32 s44, s36, 3
    v_add_u32 v80, s44, v80
    s_mov_b32 s45, 1152
    s_mov_b32 s46, 1152
    v_add_u32 v82, 0, v80
    v_add_u32 v82, s53, v82
    v_mul_lo_u32 v82, v82, s45
    v_add_u32 v2, v82, v81
    v_add_u32 v82, 32, v80
    v_add_u32 v82, s53, v82
    v_mul_lo_u32 v82, v82, s45
    v_add_u32 v3, v82, v81
    v_add_u32 v82, 0, v80
    v_add_u32 v82, s54, v82
    v_mul_lo_u32 v82, v82, s46
    v_add_u32 v4, v82, v81
    v_add_u32 v82, 32, v80
    v_add_u32 v82, s54, v82
    v_mul_lo_u32 v82, v82, s46
    v_add_u32 v5, v82, v81
    v_add_u32 v82, 64, v80
    v_add_u32 v82, s54, v82
    v_mul_lo_u32 v82, v82, s46
    v_add_u32 v6, v82, v81
    v_mov_b32 v56, 0
    v_mov_b32 v57, 0
    v_mov_b32 v58, 0
    v_mov_b32 v59, 0
    v_mov_b32 v60, 0
    v_mov_b32 v61, 0
    v_mov_b32 v62, 0
    v_mov_b32 v63, 0
    v_mov_b32 v64, 0
    v_mov_b32 v65, 0
    v_mov_b32 v66, 0
    v_mov_b32 v67, 0
    v_mov_b32 v68, 0
    v_mov_b32 v69, 0
    v_mov_b32 v70, 0
    v_mov_b32 v71, 0
    v_mov_b32 v72, 0
    v_mov_b32 v73, 0
    v_mov_b32 v74, 0
    v_mov_b32 v75, 0
    v_mov_b32 v76, 0
    v_mov_b32 v77, 0
    v_mov_b32 v78, 0
    v_mov_b32 v79, 0
    s_mov_b32 s47, 0
    s_mov_b32 s48, 0
    s_add_u32 m0, s37, 0
    s_nop 0
    buffer_load_dwordx4 v2, s[28:31], s47 offen lds
    s_add_u32 m0, s37, 4096
    s_nop 0
    buffer_load_dwordx4 v3, s[28:31], s47 offen lds
    s_add_u32 m0, s37, 8192
    s_nop 0
    buffer_load_dwordx4 v4, s[32:35], s48 offen lds
    s_add_u32 m0, s37, 12288
    s_nop 0
    buffer_load_dwordx4 v5, s[32:35], s48 offen lds
    s_add_u32 m0, s37, 16384
    s_nop 0
    buffer_load_dwordx4 v6, s[32:35], s48 offen lds
    s_add_u32 s47, s47, 128
    s_add_u32 s48, s48, 128
    s_add_u32 m0, s37, 20480
    s_nop 0
    buffer_load_dwordx4 v2, s[28:31], s47 offen lds
    s_add_u32 m0, s37, 24576
    s_nop 0
    buffer_load_dwordx4 v3, s[28:31], s47 offen lds
    s_add_u32 m0, s37, 28672
    s_nop 0
    buffer_load_dwordx4 v4, s[32:35], s48 offen lds
    s_add_u32 m0, s37, 32768
    s_nop 0
    buffer_load_dwordx4 v5, s[32:35], s48 offen lds
    s_add_u32 m0, s37, 36864
    s_nop 0
    buffer_load_dwordx4 v6, s[32:35], s48 offen lds
    s_add_u32 s47, s47, 128
    s_add_u32 s48, s48, 128
    s_mov_b32 s49, 2
L_op1_kernel_loop:
    s_waitcnt vmcnt(5)
    s_barrier
    s_add_u32 m0, s37, 40960
    s_nop 0
    buffer_load_dwordx4 v2, s[28:31], s47 offen lds
    s_add_u32 m0, s37, 45056
    s_nop 0
    buffer_load_dwordx4 v3, s[28:31], s47 offen lds
    s_add_u32 m0, s37, 49152
    s_nop 0
    buffer_load_dwordx4 v4, s[32:35], s48 offen lds
    s_add_u32 m0, s37, 53248
    s_nop 0
    buffer_load_dwordx4 v5, s[32:35], s48 offen lds
    s_add_u32 m0, s37, 57344
    s_nop 0
    buffer_load_dwordx4 v6, s[32:35], s48 offen lds
    s_add_u32 s47, s47, 128
    s_add_u32 s48, s48, 128
    ds_read_b128 v[16:19], v7 offset:0
    ds_read_b128 v[24:27], v7 offset:2048
    ds_read_b128 v[32:35], v9 offset:0
    ds_read_b128 v[40:43], v9 offset:2048
    ds_read_b128 v[48:51], v9 offset:4096
    ds_read_b128 v[20:23], v8 offset:0
    ds_read_b128 v[28:31], v8 offset:2048
    ds_read_b128 v[36:39], v10 offset:0
    ds_read_b128 v[44:47], v10 offset:2048
    ds_read_b128 v[52:55], v10 offset:4096
    s_waitcnt lgkmcnt(5)
    v_mfma_f32_16x16x32_bf16 v[56:59], v[16:19], v[32:35], v[56:59]
    v_mfma_f32_16x16x32_bf16 v[60:63], v[16:19], v[40:43], v[60:63]
    v_mfma_f32_16x16x32_bf16 v[64:67], v[16:19], v[48:51], v[64:67]
    v_mfma_f32_16x16x32_bf16 v[68:71], v[24:27], v[32:35], v[68:71]
    v_mfma_f32_16x16x32_bf16 v[72:75], v[24:27], v[40:43], v[72:75]
    v_mfma_f32_16x16x32_bf16 v[76:79], v[24:27], v[48:51], v[76:79]
    s_waitcnt lgkmcnt(0)
    v_mfma_f32_16x16x32_bf16 v[56:59], v[20:23], v[36:39], v[56:59]
    v_mfma_f32_16x16x32_bf16 v[60:63], v[20:23], v[44:47], v[60:63]
    v_mfma_f32_16x16x32_bf16 v[64:67], v[20:23], v[52:55], v[64:67]
    v_mfma_f32_16x16x32_bf16 v[68:71], v[28:31], v[36:39], v[68:71]
    v_mfma_f32_16x16x32_bf16 v[72:75], v[28:31], v[44:47], v[72:75]
    v_mfma_f32_16x16x32_bf16 v[76:79], v[28:31], v[52:55], v[76:79]
    s_waitcnt vmcnt(5)
    s_barrier
    s_add_u32 m0, s37, 0
    s_nop 0
    buffer_load_dwordx4 v2, s[28:31], s47 offen lds
    s_add_u32 m0, s37, 4096
    s_nop 0
    buffer_load_dwordx4 v3, s[28:31], s47 offen lds
    s_add_u32 m0, s37, 8192
    s_nop 0
    buffer_load_dwordx4 v4, s[32:35], s48 offen lds
    s_add_u32 m0, s37, 12288
    s_nop 0
    buffer_load_dwordx4 v5, s[32:35], s48 offen lds
    s_add_u32 m0, s37, 16384
    s_nop 0
    buffer_load_dwordx4 v6, s[32:35], s48 offen lds
    s_add_u32 s47, s47, 128
    s_add_u32 s48, s48, 128
    v_add_u32 v11, 20480, v7
    v_add_u32 v12, 20480, v8
    v_add_u32 v13, 20480, v9
    v_add_u32 v14, 20480, v10
    ds_read_b128 v[16:19], v11 offset:0
    ds_read_b128 v[24:27], v11 offset:2048
    ds_read_b128 v[32:35], v13 offset:0
    ds_read_b128 v[40:43], v13 offset:2048
    ds_read_b128 v[48:51], v13 offset:4096
    ds_read_b128 v[20:23], v12 offset:0
    ds_read_b128 v[28:31], v12 offset:2048
    ds_read_b128 v[36:39], v14 offset:0
    ds_read_b128 v[44:47], v14 offset:2048
    ds_read_b128 v[52:55], v14 offset:4096
    s_waitcnt lgkmcnt(5)
    v_mfma_f32_16x16x32_bf16 v[56:59], v[16:19], v[32:35], v[56:59]
    v_mfma_f32_16x16x32_bf16 v[60:63], v[16:19], v[40:43], v[60:63]
    v_mfma_f32_16x16x32_bf16 v[64:67], v[16:19], v[48:51], v[64:67]
    v_mfma_f32_16x16x32_bf16 v[68:71], v[24:27], v[32:35], v[68:71]
    v_mfma_f32_16x16x32_bf16 v[72:75], v[24:27], v[40:43], v[72:75]
    v_mfma_f32_16x16x32_bf16 v[76:79], v[24:27], v[48:51], v[76:79]
    s_waitcnt lgkmcnt(0)
    v_mfma_f32_16x16x32_bf16 v[56:59], v[20:23], v[36:39], v[56:59]
    v_mfma_f32_16x16x32_bf16 v[60:63], v[20:23], v[44:47], v[60:63]
    v_mfma_f32_16x16x32_bf16 v[64:67], v[20:23], v[52:55], v[64:67]
    v_mfma_f32_16x16x32_bf16 v[68:71], v[28:31], v[36:39], v[68:71]
    v_mfma_f32_16x16x32_bf16 v[72:75], v[28:31], v[44:47], v[72:75]
    v_mfma_f32_16x16x32_bf16 v[76:79], v[28:31], v[52:55], v[76:79]
    s_waitcnt vmcnt(5)
    s_barrier
    s_add_u32 m0, s37, 20480
    s_nop 0
    buffer_load_dwordx4 v2, s[28:31], s47 offen lds
    s_add_u32 m0, s37, 24576
    s_nop 0
    buffer_load_dwordx4 v3, s[28:31], s47 offen lds
    s_add_u32 m0, s37, 28672
    s_nop 0
    buffer_load_dwordx4 v4, s[32:35], s48 offen lds
    s_add_u32 m0, s37, 32768
    s_nop 0
    buffer_load_dwordx4 v5, s[32:35], s48 offen lds
    s_add_u32 m0, s37, 36864
    s_nop 0
    buffer_load_dwordx4 v6, s[32:35], s48 offen lds
    s_add_u32 s47, s47, 128
    s_add_u32 s48, s48, 128
    v_add_u32 v11, 40960, v7
    v_add_u32 v12, 40960, v8
    v_add_u32 v13, 40960, v9
    v_add_u32 v14, 40960, v10
    ds_read_b128 v[16:19], v11 offset:0
    ds_read_b128 v[24:27], v11 offset:2048
    ds_read_b128 v[32:35], v13 offset:0
    ds_read_b128 v[40:43], v13 offset:2048
    ds_read_b128 v[48:51], v13 offset:4096
    ds_read_b128 v[20:23], v12 offset:0
    ds_read_b128 v[28:31], v12 offset:2048
    ds_read_b128 v[36:39], v14 offset:0
    ds_read_b128 v[44:47], v14 offset:2048
    ds_read_b128 v[52:55], v14 offset:4096
    s_waitcnt lgkmcnt(5)
    v_mfma_f32_16x16x32_bf16 v[56:59], v[16:19], v[32:35], v[56:59]
    v_mfma_f32_16x16x32_bf16 v[60:63], v[16:19], v[40:43], v[60:63]
    v_mfma_f32_16x16x32_bf16 v[64:67], v[16:19], v[48:51], v[64:67]
    v_mfma_f32_16x16x32_bf16 v[68:71], v[24:27], v[32:35], v[68:71]
    v_mfma_f32_16x16x32_bf16 v[72:75], v[24:27], v[40:43], v[72:75]
    v_mfma_f32_16x16x32_bf16 v[76:79], v[24:27], v[48:51], v[76:79]
    s_waitcnt lgkmcnt(0)
    v_mfma_f32_16x16x32_bf16 v[56:59], v[20:23], v[36:39], v[56:59]
    v_mfma_f32_16x16x32_bf16 v[60:63], v[20:23], v[44:47], v[60:63]
    v_mfma_f32_16x16x32_bf16 v[64:67], v[20:23], v[52:55], v[64:67]
    v_mfma_f32_16x16x32_bf16 v[68:71], v[28:31], v[36:39], v[68:71]
    v_mfma_f32_16x16x32_bf16 v[72:75], v[28:31], v[44:47], v[72:75]
    v_mfma_f32_16x16x32_bf16 v[76:79], v[28:31], v[52:55], v[76:79]
    s_sub_u32 s49, s49, 1
    s_cmp_lg_u32 s49, 0
    s_cbranch_scc1 L_op1_kernel_loop
    s_waitcnt vmcnt(5)
    s_barrier
    s_add_u32 m0, s37, 40960
    s_nop 0
    buffer_load_dwordx4 v2, s[28:31], s47 offen lds
    s_add_u32 m0, s37, 45056
    s_nop 0
    buffer_load_dwordx4 v3, s[28:31], s47 offen lds
    s_add_u32 m0, s37, 49152
    s_nop 0
    buffer_load_dwordx4 v4, s[32:35], s48 offen lds
    s_add_u32 m0, s37, 53248
    s_nop 0
    buffer_load_dwordx4 v5, s[32:35], s48 offen lds
    s_add_u32 m0, s37, 57344
    s_nop 0
    buffer_load_dwordx4 v6, s[32:35], s48 offen lds
    s_add_u32 s47, s47, 128
    s_add_u32 s48, s48, 128
    ds_read_b128 v[16:19], v7 offset:0
    ds_read_b128 v[24:27], v7 offset:2048
    ds_read_b128 v[32:35], v9 offset:0
    ds_read_b128 v[40:43], v9 offset:2048
    ds_read_b128 v[48:51], v9 offset:4096
    ds_read_b128 v[20:23], v8 offset:0
    ds_read_b128 v[28:31], v8 offset:2048
    ds_read_b128 v[36:39], v10 offset:0
    ds_read_b128 v[44:47], v10 offset:2048
    ds_read_b128 v[52:55], v10 offset:4096
    s_waitcnt lgkmcnt(5)
    v_mfma_f32_16x16x32_bf16 v[56:59], v[16:19], v[32:35], v[56:59]
    v_mfma_f32_16x16x32_bf16 v[60:63], v[16:19], v[40:43], v[60:63]
    v_mfma_f32_16x16x32_bf16 v[64:67], v[16:19], v[48:51], v[64:67]
    v_mfma_f32_16x16x32_bf16 v[68:71], v[24:27], v[32:35], v[68:71]
    v_mfma_f32_16x16x32_bf16 v[72:75], v[24:27], v[40:43], v[72:75]
    v_mfma_f32_16x16x32_bf16 v[76:79], v[24:27], v[48:51], v[76:79]
    s_waitcnt lgkmcnt(0)
    v_mfma_f32_16x16x32_bf16 v[56:59], v[20:23], v[36:39], v[56:59]
    v_mfma_f32_16x16x32_bf16 v[60:63], v[20:23], v[44:47], v[60:63]
    v_mfma_f32_16x16x32_bf16 v[64:67], v[20:23], v[52:55], v[64:67]
    v_mfma_f32_16x16x32_bf16 v[68:71], v[28:31], v[36:39], v[68:71]
    v_mfma_f32_16x16x32_bf16 v[72:75], v[28:31], v[44:47], v[72:75]
    v_mfma_f32_16x16x32_bf16 v[76:79], v[28:31], v[52:55], v[76:79]
    s_waitcnt vmcnt(5)
    s_barrier
    v_add_u32 v11, 20480, v7
    v_add_u32 v12, 20480, v8
    v_add_u32 v13, 20480, v9
    v_add_u32 v14, 20480, v10
    ds_read_b128 v[16:19], v11 offset:0
    ds_read_b128 v[24:27], v11 offset:2048
    ds_read_b128 v[32:35], v13 offset:0
    ds_read_b128 v[40:43], v13 offset:2048
    ds_read_b128 v[48:51], v13 offset:4096
    ds_read_b128 v[20:23], v12 offset:0
    ds_read_b128 v[28:31], v12 offset:2048
    ds_read_b128 v[36:39], v14 offset:0
    ds_read_b128 v[44:47], v14 offset:2048
    ds_read_b128 v[52:55], v14 offset:4096
    s_waitcnt lgkmcnt(5)
    v_mfma_f32_16x16x32_bf16 v[56:59], v[16:19], v[32:35], v[56:59]
    v_mfma_f32_16x16x32_bf16 v[60:63], v[16:19], v[40:43], v[60:63]
    v_mfma_f32_16x16x32_bf16 v[64:67], v[16:19], v[48:51], v[64:67]
    v_mfma_f32_16x16x32_bf16 v[68:71], v[24:27], v[32:35], v[68:71]
    v_mfma_f32_16x16x32_bf16 v[72:75], v[24:27], v[40:43], v[72:75]
    v_mfma_f32_16x16x32_bf16 v[76:79], v[24:27], v[48:51], v[76:79]
    s_waitcnt lgkmcnt(0)
    v_mfma_f32_16x16x32_bf16 v[56:59], v[20:23], v[36:39], v[56:59]
    v_mfma_f32_16x16x32_bf16 v[60:63], v[20:23], v[44:47], v[60:63]
    v_mfma_f32_16x16x32_bf16 v[64:67], v[20:23], v[52:55], v[64:67]
    v_mfma_f32_16x16x32_bf16 v[68:71], v[28:31], v[36:39], v[68:71]
    v_mfma_f32_16x16x32_bf16 v[72:75], v[28:31], v[44:47], v[72:75]
    v_mfma_f32_16x16x32_bf16 v[76:79], v[28:31], v[52:55], v[76:79]
    s_waitcnt vmcnt(0)
    s_barrier
    v_add_u32 v11, 40960, v7
    v_add_u32 v12, 40960, v8
    v_add_u32 v13, 40960, v9
    v_add_u32 v14, 40960, v10
    ds_read_b128 v[16:19], v11 offset:0
    ds_read_b128 v[24:27], v11 offset:2048
    ds_read_b128 v[32:35], v13 offset:0
    ds_read_b128 v[40:43], v13 offset:2048
    ds_read_b128 v[48:51], v13 offset:4096
    ds_read_b128 v[20:23], v12 offset:0
    ds_read_b128 v[28:31], v12 offset:2048
    ds_read_b128 v[36:39], v14 offset:0
    ds_read_b128 v[44:47], v14 offset:2048
    ds_read_b128 v[52:55], v14 offset:4096
    s_waitcnt lgkmcnt(5)
    v_mfma_f32_16x16x32_bf16 v[56:59], v[16:19], v[32:35], v[56:59]
    v_mfma_f32_16x16x32_bf16 v[60:63], v[16:19], v[40:43], v[60:63]
    v_mfma_f32_16x16x32_bf16 v[64:67], v[16:19], v[48:51], v[64:67]
    v_mfma_f32_16x16x32_bf16 v[68:71], v[24:27], v[32:35], v[68:71]
    v_mfma_f32_16x16x32_bf16 v[72:75], v[24:27], v[40:43], v[72:75]
    v_mfma_f32_16x16x32_bf16 v[76:79], v[24:27], v[48:51], v[76:79]
    s_waitcnt lgkmcnt(0)
    v_mfma_f32_16x16x32_bf16 v[56:59], v[20:23], v[36:39], v[56:59]
    v_mfma_f32_16x16x32_bf16 v[60:63], v[20:23], v[44:47], v[60:63]
    v_mfma_f32_16x16x32_bf16 v[64:67], v[20:23], v[52:55], v[64:67]
    v_mfma_f32_16x16x32_bf16 v[68:71], v[28:31], v[36:39], v[68:71]
    v_mfma_f32_16x16x32_bf16 v[72:75], v[28:31], v[44:47], v[72:75]
    v_mfma_f32_16x16x32_bf16 v[76:79], v[28:31], v[52:55], v[76:79]
    s_add_u32 s60, s26, 0x1538000
    s_addc_u32 s61, s27, 0
    s_and_b32 s61, s61, 0xffff
    s_mov_b32 s62, 0x240000
    s_mov_b32 s63, 0x00020000
    v_cvt_pk_bf16_f32 v80, v56, v56
    v_lshlrev_b32 v80, 16, v80
    v_lshlrev_b32 v85, 16, v85
    v_add_f32 v80, v80, v85
    v_cvt_pk_bf16_f32 v80, v80, v80
    v_cvt_pk_bf16_f32 v81, v57, v57
    v_lshlrev_b32 v81, 16, v81
    v_lshlrev_b32 v86, 16, v86
    v_add_f32 v81, v81, v86
    v_cvt_pk_bf16_f32 v81, v81, v81
    v_cvt_pk_bf16_f32 v82, v58, v58
    v_lshlrev_b32 v82, 16, v82
    v_lshlrev_b32 v87, 16, v87
    v_add_f32 v82, v82, v87
    v_cvt_pk_bf16_f32 v82, v82, v82
    v_cvt_pk_bf16_f32 v83, v59, v59
    v_lshlrev_b32 v83, 16, v83
    v_lshlrev_b32 v88, 16, v88
    v_add_f32 v83, v83, v88
    v_cvt_pk_bf16_f32 v83, v83, v83
    s_mov_b32 s58, 0
    buffer_store_short v80, v84, s[60:63], s58 offen offset:0
    s_mov_b32 s58, 1152
    buffer_store_short v81, v84, s[60:63], s58 offen offset:0
    s_mov_b32 s58, 2304
    buffer_store_short v82, v84, s[60:63], s58 offen offset:0
    s_mov_b32 s58, 3456
    buffer_store_short v83, v84, s[60:63], s58 offen offset:0
    v_cvt_pk_bf16_f32 v80, v60, v60
    v_lshlrev_b32 v80, 16, v80
    v_lshlrev_b32 v89, 16, v89
    v_add_f32 v80, v80, v89
    v_cvt_pk_bf16_f32 v80, v80, v80
    v_cvt_pk_bf16_f32 v81, v61, v61
    v_lshlrev_b32 v81, 16, v81
    v_lshlrev_b32 v90, 16, v90
    v_add_f32 v81, v81, v90
    v_cvt_pk_bf16_f32 v81, v81, v81
    v_cvt_pk_bf16_f32 v82, v62, v62
    v_lshlrev_b32 v82, 16, v82
    v_lshlrev_b32 v91, 16, v91
    v_add_f32 v82, v82, v91
    v_cvt_pk_bf16_f32 v82, v82, v82
    v_cvt_pk_bf16_f32 v83, v63, v63
    v_lshlrev_b32 v83, 16, v83
    v_lshlrev_b32 v92, 16, v92
    v_add_f32 v83, v83, v92
    v_cvt_pk_bf16_f32 v83, v83, v83
    s_mov_b32 s58, 0
    buffer_store_short v80, v84, s[60:63], s58 offen offset:32
    s_mov_b32 s58, 1152
    buffer_store_short v81, v84, s[60:63], s58 offen offset:32
    s_mov_b32 s58, 2304
    buffer_store_short v82, v84, s[60:63], s58 offen offset:32
    s_mov_b32 s58, 3456
    buffer_store_short v83, v84, s[60:63], s58 offen offset:32
    v_cvt_pk_bf16_f32 v80, v64, v64
    v_lshlrev_b32 v80, 16, v80
    v_lshlrev_b32 v93, 16, v93
    v_add_f32 v80, v80, v93
    v_cvt_pk_bf16_f32 v80, v80, v80
    v_cvt_pk_bf16_f32 v81, v65, v65
    v_lshlrev_b32 v81, 16, v81
    v_lshlrev_b32 v94, 16, v94
    v_add_f32 v81, v81, v94
    v_cvt_pk_bf16_f32 v81, v81, v81
    v_cvt_pk_bf16_f32 v82, v66, v66
    v_lshlrev_b32 v82, 16, v82
    v_lshlrev_b32 v95, 16, v95
    v_add_f32 v82, v82, v95
    v_cvt_pk_bf16_f32 v82, v82, v82
    v_cvt_pk_bf16_f32 v83, v67, v67
    v_lshlrev_b32 v83, 16, v83
    v_lshlrev_b32 v96, 16, v96
    v_add_f32 v83, v83, v96
    v_cvt_pk_bf16_f32 v83, v83, v83
    s_mov_b32 s58, 0
    buffer_store_short v80, v84, s[60:63], s58 offen offset:64
    s_mov_b32 s58, 1152
    buffer_store_short v81, v84, s[60:63], s58 offen offset:64
    s_mov_b32 s58, 2304
    buffer_store_short v82, v84, s[60:63], s58 offen offset:64
    s_mov_b32 s58, 3456
    buffer_store_short v83, v84, s[60:63], s58 offen offset:64
    v_cvt_pk_bf16_f32 v80, v68, v68
    v_lshlrev_b32 v80, 16, v80
    v_lshlrev_b32 v97, 16, v97
    v_add_f32 v80, v80, v97
    v_cvt_pk_bf16_f32 v80, v80, v80
    v_cvt_pk_bf16_f32 v81, v69, v69
    v_lshlrev_b32 v81, 16, v81
    v_lshlrev_b32 v98, 16, v98
    v_add_f32 v81, v81, v98
    v_cvt_pk_bf16_f32 v81, v81, v81
    v_cvt_pk_bf16_f32 v82, v70, v70
    v_lshlrev_b32 v82, 16, v82
    v_lshlrev_b32 v99, 16, v99
    v_add_f32 v82, v82, v99
    v_cvt_pk_bf16_f32 v82, v82, v82
    v_cvt_pk_bf16_f32 v83, v71, v71
    v_lshlrev_b32 v83, 16, v83
    v_lshlrev_b32 v100, 16, v100
    v_add_f32 v83, v83, v100
    v_cvt_pk_bf16_f32 v83, v83, v83
    s_mov_b32 s58, 18432
    buffer_store_short v80, v84, s[60:63], s58 offen offset:0
    s_mov_b32 s58, 19584
    buffer_store_short v81, v84, s[60:63], s58 offen offset:0
    s_mov_b32 s58, 20736
    buffer_store_short v82, v84, s[60:63], s58 offen offset:0
    s_mov_b32 s58, 21888
    buffer_store_short v83, v84, s[60:63], s58 offen offset:0
    v_cvt_pk_bf16_f32 v80, v72, v72
    v_lshlrev_b32 v80, 16, v80
    v_lshlrev_b32 v101, 16, v101
    v_add_f32 v80, v80, v101
    v_cvt_pk_bf16_f32 v80, v80, v80
    v_cvt_pk_bf16_f32 v81, v73, v73
    v_lshlrev_b32 v81, 16, v81
    v_lshlrev_b32 v102, 16, v102
    v_add_f32 v81, v81, v102
    v_cvt_pk_bf16_f32 v81, v81, v81
    v_cvt_pk_bf16_f32 v82, v74, v74
    v_lshlrev_b32 v82, 16, v82
    v_lshlrev_b32 v103, 16, v103
    v_add_f32 v82, v82, v103
    v_cvt_pk_bf16_f32 v82, v82, v82
    v_cvt_pk_bf16_f32 v83, v75, v75
    v_lshlrev_b32 v83, 16, v83
    v_lshlrev_b32 v104, 16, v104
    v_add_f32 v83, v83, v104
    v_cvt_pk_bf16_f32 v83, v83, v83
    s_mov_b32 s58, 18432
    buffer_store_short v80, v84, s[60:63], s58 offen offset:32
    s_mov_b32 s58, 19584
    buffer_store_short v81, v84, s[60:63], s58 offen offset:32
    s_mov_b32 s58, 20736
    buffer_store_short v82, v84, s[60:63], s58 offen offset:32
    s_mov_b32 s58, 21888
    buffer_store_short v83, v84, s[60:63], s58 offen offset:32
    v_cvt_pk_bf16_f32 v80, v76, v76
    v_lshlrev_b32 v80, 16, v80
    v_lshlrev_b32 v105, 16, v105
    v_add_f32 v80, v80, v105
    v_cvt_pk_bf16_f32 v80, v80, v80
    v_cvt_pk_bf16_f32 v81, v77, v77
    v_lshlrev_b32 v81, 16, v81
    v_lshlrev_b32 v106, 16, v106
    v_add_f32 v81, v81, v106
    v_cvt_pk_bf16_f32 v81, v81, v81
    v_cvt_pk_bf16_f32 v82, v78, v78
    v_lshlrev_b32 v82, 16, v82
    v_lshlrev_b32 v107, 16, v107
    v_add_f32 v82, v82, v107
    v_cvt_pk_bf16_f32 v82, v82, v82
    v_cvt_pk_bf16_f32 v83, v79, v79
    v_lshlrev_b32 v83, 16, v83
    v_lshlrev_b32 v108, 16, v108
    v_add_f32 v83, v83, v108
    v_cvt_pk_bf16_f32 v83, v83, v83
    s_mov_b32 s58, 18432
    buffer_store_short v80, v84, s[60:63], s58 offen offset:64
    s_mov_b32 s58, 19584
    buffer_store_short v81, v84, s[60:63], s58 offen offset:64
    s_mov_b32 s58, 20736
    buffer_store_short v82, v84, s[60:63], s58 offen offset:64
    s_mov_b32 s58, 21888
    buffer_store_short v83, v84, s[60:63], s58 offen offset:64
L_op1_kernel_end:
    s_endpgm
.globl ln1_kernel
.p2align 8
.type ln1_kernel,@function
ln1_kernel:
    s_cmp_ge_u32 s2, 256
    s_cbranch_scc1 L_ln1_kernel_end
    s_load_dwordx16 s[4:19], s[0:1], 0
    s_load_dwordx8 s[20:27], s[0:1], 64
    v_lshrrev_b32 v1, 6, v0
    v_and_b32 v2, 63, v0
    s_lshl_b32 s28, s2, 3
    v_lshrrev_b32 v3, 3, v0
    v_add_u32 v3, s28, v3
    s_movk_i32 s29, 1152
    v_mul_lo_u32 v3, v3, s29
    v_and_b32 v4, 7, v0
    v_lshl_add_u32 v3, v4, 4, v3
    s_waitcnt lgkmcnt(0)
    s_add_u32 s32, s26, 0x1538000
    s_addc_u32 s33, s27, 0
    s_and_b32 s33, s33, 0xffff
    s_mov_b32 s34, 0x240000
    s_mov_b32 s35, 0x00020000
    s_add_u32 s36, s26, 0x298000
    s_addc_u32 s37, s27, 0
    s_and_b32 s37, s37, 0xffff
    s_mov_b32 s38, 0x240000
    s_mov_b32 s39, 0x00020000
    buffer_load_dwordx4 v[8:11], v3, s[32:35], 0 offen offset:0
    buffer_load_dwordx4 v[12:15], v3, s[32:35], 0 offen offset:128
    buffer_load_dwordx4 v[16:19], v3, s[32:35], 0 offen offset:256
    buffer_load_dwordx4 v[20:23], v3, s[32:35], 0 offen offset:384
    buffer_load_dwordx4 v[24:27], v3, s[32:35], 0 offen offset:512
    buffer_load_dwordx4 v[28:31], v3, s[32:35], 0 offen offset:640
    buffer_load_dwordx4 v[32:35], v3, s[32:35], 0 offen offset:768
    buffer_load_dwordx4 v[36:39], v3, s[32:35], 0 offen offset:896
    buffer_load_dwordx4 v[40:43], v3, s[32:35], 0 offen offset:1024
    s_waitcnt vmcnt(0)
    v_lshlrev_b32 v44, 16, v8
    v_and_b32 v45, 0xffff0000, v8
    v_lshlrev_b32 v46, 16, v9
    v_and_b32 v47, 0xffff0000, v9
    v_lshlrev_b32 v48, 16, v10
    v_and_b32 v49, 0xffff0000, v10
    v_lshlrev_b32 v50, 16, v11
    v_and_b32 v51, 0xffff0000, v11
    v_lshlrev_b32 v52, 16, v12
    v_and_b32 v53, 0xffff0000, v12
    v_lshlrev_b32 v54, 16, v13
    v_and_b32 v55, 0xffff0000, v13
    v_lshlrev_b32 v56, 16, v14
    v_and_b32 v57, 0xffff0000, v14
    v_lshlrev_b32 v58, 16, v15
    v_and_b32 v59, 0xffff0000, v15
    v_lshlrev_b32 v60, 16, v16
    v_and_b32 v61, 0xffff0000, v16
    v_lshlrev_b32 v62, 16, v17
    v_and_b32 v63, 0xffff0000, v17
    v_lshlrev_b32 v64, 16, v18
    v_and_b32 v65, 0xffff0000, v18
    v_lshlrev_b32 v66, 16, v19
    v_and_b32 v67, 0xffff0000, v19
    v_lshlrev_b32 v68, 16, v20
    v_and_b32 v69, 0xffff0000, v20
    v_lshlrev_b32 v70, 16, v21
    v_and_b32 v71, 0xffff0000, v21
    v_lshlrev_b32 v72, 16, v22
    v_and_b32 v73, 0xffff0000, v22
    v_lshlrev_b32 v74, 16, v23
    v_and_b32 v75, 0xffff0000, v23
    v_lshlrev_b32 v76, 16, v24
    v_and_b32 v77, 0xffff0000, v24
    v_lshlrev_b32 v78, 16, v25
    v_and_b32 v79, 0xffff0000, v25
    v_lshlrev_b32 v80, 16, v26
    v_and_b32 v81, 0xffff0000, v26
    v_lshlrev_b32 v82, 16, v27
    v_and_b32 v83, 0xffff0000, v27
    v_lshlrev_b32 v84, 16, v28
    v_and_b32 v85, 0xffff0000, v28
    v_lshlrev_b32 v86, 16, v29
    v_and_b32 v87, 0xffff0000, v29
    v_lshlrev_b32 v88, 16, v30
    v_and_b32 v89, 0xffff0000, v30
    v_lshlrev_b32 v90, 16, v31
    v_and_b32 v91, 0xffff0000, v31
    v_lshlrev_b32 v92, 16, v32
    v_and_b32 v93, 0xffff0000, v32
    v_lshlrev_b32 v94, 16, v33
    v_and_b32 v95, 0xffff0000, v33
    v_lshlrev_b32 v96, 16, v34
    v_and_b32 v97, 0xffff0000, v34
    v_lshlrev_b32 v98, 16, v35
    v_and_b32 v99, 0xffff0000, v35
    v_lshlrev_b32 v100, 16, v36
    v_and_b32 v101, 0xffff0000, v36
    v_lshlrev_b32 v102, 16, v37
    v_and_b32 v103, 0xffff0000, v37
    v_lshlrev_b32 v104, 16, v38
    v_and_b32 v105, 0xffff0000, v38
    v_lshlrev_b32 v106, 16, v39
    v_and_b32 v107, 0xffff0000, v39
    v_lshlrev_b32 v108, 16, v40
    v_and_b32 v109, 0xffff0000, v40
    v_lshlrev_b32 v110, 16, v41
    v_and_b32 v111, 0xffff0000, v41
    v_lshlrev_b32 v112, 16, v42
    v_and_b32 v113, 0xffff0000, v42
    v_lshlrev_b32 v114, 16, v43
    v_and_b32 v115, 0xffff0000, v43
    v_add_f32 v116, v44, v45
    v_add_f32 v116, v116, v46
    v_add_f32 v116, v116, v47
    v_add_f32 v116, v116, v48
    v_add_f32 v116, v116, v49
    v_add_f32 v116, v116, v50
    v_add_f32 v116, v116, v51
    v_add_f32 v116, v116, v52
    v_add_f32 v116, v116, v53
    v_add_f32 v116, v116, v54
    v_add_f32 v116, v116, v55
    v_add_f32 v116, v116, v56
    v_add_f32 v116, v116, v57
    v_add_f32 v116, v116, v58
    v_add_f32 v116, v116, v59
    v_add_f32 v116, v116, v60
    v_add_f32 v116, v116, v61
    v_add_f32 v116, v116, v62
    v_add_f32 v116, v116, v63
    v_add_f32 v116, v116, v64
    v_add_f32 v116, v116, v65
    v_add_f32 v116, v116, v66
    v_add_f32 v116, v116, v67
    v_add_f32 v116, v116, v68
    v_add_f32 v116, v116, v69
    v_add_f32 v116, v116, v70
    v_add_f32 v116, v116, v71
    v_add_f32 v116, v116, v72
    v_add_f32 v116, v116, v73
    v_add_f32 v116, v116, v74
    v_add_f32 v116, v116, v75
    v_add_f32 v116, v116, v76
    v_add_f32 v116, v116, v77
    v_add_f32 v116, v116, v78
    v_add_f32 v116, v116, v79
    v_add_f32 v116, v116, v80
    v_add_f32 v116, v116, v81
    v_add_f32 v116, v116, v82
    v_add_f32 v116, v116, v83
    v_add_f32 v116, v116, v84
    v_add_f32 v116, v116, v85
    v_add_f32 v116, v116, v86
    v_add_f32 v116, v116, v87
    v_add_f32 v116, v116, v88
    v_add_f32 v116, v116, v89
    v_add_f32 v116, v116, v90
    v_add_f32 v116, v116, v91
    v_add_f32 v116, v116, v92
    v_add_f32 v116, v116, v93
    v_add_f32 v116, v116, v94
    v_add_f32 v116, v116, v95
    v_add_f32 v116, v116, v96
    v_add_f32 v116, v116, v97
    v_add_f32 v116, v116, v98
    v_add_f32 v116, v116, v99
    v_add_f32 v116, v116, v100
    v_add_f32 v116, v116, v101
    v_add_f32 v116, v116, v102
    v_add_f32 v116, v116, v103
    v_add_f32 v116, v116, v104
    v_add_f32 v116, v116, v105
    v_add_f32 v116, v116, v106
    v_add_f32 v116, v116, v107
    v_add_f32 v116, v116, v108
    v_add_f32 v116, v116, v109
    v_add_f32 v116, v116, v110
    v_add_f32 v116, v116, v111
    v_add_f32 v116, v116, v112
    v_add_f32 v116, v116, v113
    v_add_f32 v116, v116, v114
    v_add_f32 v116, v116, v115
    s_nop 1
    v_add_f32_dpp v116, v116, v116 quad_perm:[1,0,3,2] row_mask:0xf bank_mask:0xf
    s_nop 1
    v_add_f32_dpp v116, v116, v116 quad_perm:[2,3,0,1] row_mask:0xf bank_mask:0xf
    s_nop 1
    v_add_f32_dpp v116, v116, v116 row_half_mirror row_mask:0xf bank_mask:0xf
    v_mul_f32 v118, 0x3ae38e39, v116
    v_sub_f32 v119, v44, v118
    v_mul_f32 v117, v119, v119
    v_sub_f32 v119, v45, v118
    v_fmac_f32 v117, v119, v119
    v_sub_f32 v119, v46, v118
    v_fmac_f32 v117, v119, v119
    v_sub_f32 v119, v47, v118
    v_fmac_f32 v117, v119, v119
    v_sub_f32 v119, v48, v118
    v_fmac_f32 v117, v119, v119
    v_sub_f32 v119, v49, v118
    v_fmac_f32 v117, v119, v119
    v_sub_f32 v119, v50, v118
    v_fmac_f32 v117, v119, v119
    v_sub_f32 v119, v51, v118
    v_fmac_f32 v117, v119, v119
    v_sub_f32 v119, v52, v118
    v_fmac_f32 v117, v119, v119
    v_sub_f32 v119, v53, v118
    v_fmac_f32 v117, v119, v119
    v_sub_f32 v119, v54, v118
    v_fmac_f32 v117, v119, v119
    v_sub_f32 v119, v55, v118
    v_fmac_f32 v117, v119, v119
    v_sub_f32 v119, v56, v118
    v_fmac_f32 v117, v119, v119
    v_sub_f32 v119, v57, v118
    v_fmac_f32 v117, v119, v119
    v_sub_f32 v119, v58, v118
    v_fmac_f32 v117, v119, v119
    v_sub_f32 v119, v59, v118
    v_fmac_f32 v117, v119, v119
    v_sub_f32 v119, v60, v118
    v_fmac_f32 v117, v119, v119
    v_sub_f32 v119, v61, v118
    v_fmac_f32 v117, v119, v119
    v_sub_f32 v119, v62, v118
    v_fmac_f32 v117, v119, v119
    v_sub_f32 v119, v63, v118
    v_fmac_f32 v117, v119, v119
    v_sub_f32 v119, v64, v118
    v_fmac_f32 v117, v119, v119
    v_sub_f32 v119, v65, v118
    v_fmac_f32 v117, v119, v119
    v_sub_f32 v119, v66, v118
    v_fmac_f32 v117, v119, v119
    v_sub_f32 v119, v67, v118
    v_fmac_f32 v117, v119, v119
    v_sub_f32 v119, v68, v118
    v_fmac_f32 v117, v119, v119
    v_sub_f32 v119, v69, v118
    v_fmac_f32 v117, v119, v119
    v_sub_f32 v119, v70, v118
    v_fmac_f32 v117, v119, v119
    v_sub_f32 v119, v71, v118
    v_fmac_f32 v117, v119, v119
    v_sub_f32 v119, v72, v118
    v_fmac_f32 v117, v119, v119
    v_sub_f32 v119, v73, v118
    v_fmac_f32 v117, v119, v119
    v_sub_f32 v119, v74, v118
    v_fmac_f32 v117, v119, v119
    v_sub_f32 v119, v75, v118
    v_fmac_f32 v117, v119, v119
    v_sub_f32 v119, v76, v118
    v_fmac_f32 v117, v119, v119
    v_sub_f32 v119, v77, v118
    v_fmac_f32 v117, v119, v119
    v_sub_f32 v119, v78, v118
    v_fmac_f32 v117, v119, v119
    v_sub_f32 v119, v79, v118
    v_fmac_f32 v117, v119, v119
    v_sub_f32 v119, v80, v118
    v_fmac_f32 v117, v119, v119
    v_sub_f32 v119, v81, v118
    v_fmac_f32 v117, v119, v119
    v_sub_f32 v119, v82, v118
    v_fmac_f32 v117, v119, v119
    v_sub_f32 v119, v83, v118
    v_fmac_f32 v117, v119, v119
    v_sub_f32 v119, v84, v118
    v_fmac_f32 v117, v119, v119
    v_sub_f32 v119, v85, v118
    v_fmac_f32 v117, v119, v119
    v_sub_f32 v119, v86, v118
    v_fmac_f32 v117, v119, v119
    v_sub_f32 v119, v87, v118
    v_fmac_f32 v117, v119, v119
    v_sub_f32 v119, v88, v118
    v_fmac_f32 v117, v119, v119
    v_sub_f32 v119, v89, v118
    v_fmac_f32 v117, v119, v119
    v_sub_f32 v119, v90, v118
    v_fmac_f32 v117, v119, v119
    v_sub_f32 v119, v91, v118
    v_fmac_f32 v117, v119, v119
    v_sub_f32 v119, v92, v118
    v_fmac_f32 v117, v119, v119
    v_sub_f32 v119, v93, v118
    v_fmac_f32 v117, v119, v119
    v_sub_f32 v119, v94, v118
    v_fmac_f32 v117, v119, v119
    v_sub_f32 v119, v95, v118
    v_fmac_f32 v117, v119, v119
    v_sub_f32 v119, v96, v118
    v_fmac_f32 v117, v119, v119
    v_sub_f32 v119, v97, v118
    v_fmac_f32 v117, v119, v119
    v_sub_f32 v119, v98, v118
    v_fmac_f32 v117, v119, v119
    v_sub_f32 v119, v99, v118
    v_fmac_f32 v117, v119, v119
    v_sub_f32 v119, v100, v118
    v_fmac_f32 v117, v119, v119
    v_sub_f32 v119, v101, v118
    v_fmac_f32 v117, v119, v119
    v_sub_f32 v119, v102, v118
    v_fmac_f32 v117, v119, v119
    v_sub_f32 v119, v103, v118
    v_fmac_f32 v117, v119, v119
    v_sub_f32 v119, v104, v118
    v_fmac_f32 v117, v119, v119
    v_sub_f32 v119, v105, v118
    v_fmac_f32 v117, v119, v119
    v_sub_f32 v119, v106, v118
    v_fmac_f32 v117, v119, v119
    v_sub_f32 v119, v107, v118
    v_fmac_f32 v117, v119, v119
    v_sub_f32 v119, v108, v118
    v_fmac_f32 v117, v119, v119
    v_sub_f32 v119, v109, v118
    v_fmac_f32 v117, v119, v119
    v_sub_f32 v119, v110, v118
    v_fmac_f32 v117, v119, v119
    v_sub_f32 v119, v111, v118
    v_fmac_f32 v117, v119, v119
    v_sub_f32 v119, v112, v118
    v_fmac_f32 v117, v119, v119
    v_sub_f32 v119, v113, v118
    v_fmac_f32 v117, v119, v119
    v_sub_f32 v119, v114, v118
    v_fmac_f32 v117, v119, v119
    v_sub_f32 v119, v115, v118
    v_fmac_f32 v117, v119, v119
    s_nop 1
    v_add_f32_dpp v117, v117, v117 quad_perm:[1,0,3,2] row_mask:0xf bank_mask:0xf
    s_nop 1
    v_add_f32_dpp v117, v117, v117 quad_perm:[2,3,0,1] row_mask:0xf bank_mask:0xf
    s_nop 1
    v_add_f32_dpp v117, v117, v117 row_half_mirror row_mask:0xf bank_mask:0xf
    v_mul_f32 v120, 0x3ae38e39, v117
    v_cvt_pk_bf16_f32 v121, v118, v120
    v_and_b32 v122, 0xffff0000, v121
    v_lshlrev_b32 v121, 16, v121
    v_add_f32 v122, 0x3727c5ac, v122
    v_cvt_pk_bf16_f32 v122, v122, v122
    v_lshlrev_b32 v122, 16, v122
    v_sqrt_f32 v122, v122
    s_nop 0
    v_cvt_pk_bf16_f32 v122, v122, v122
    v_lshlrev_b32 v122, 16, v122
    v_rcp_f32 v123, v122
    v_sub_f32 v44, v44, v121
    v_sub_f32 v45, v45, v121
    v_cvt_pk_bf16_f32 v8, v44, v45
    v_lshlrev_b32 v44, 16, v8
    v_and_b32 v45, 0xffff0000, v8
    v_mul_f32 v125, v44, v123
    v_fma_f32 v127, -v125, v122, v44
    v_fma_f32 v44, v127, v123, v125
    v_mul_f32 v126, v45, v123
    v_fma_f32 v128, -v126, v122, v45
    v_fma_f32 v45, v128, v123, v126
    v_cvt_pk_bf16_f32 v8, v44, v45
    v_sub_f32 v46, v46, v121
    v_sub_f32 v47, v47, v121
    v_cvt_pk_bf16_f32 v9, v46, v47
    v_lshlrev_b32 v46, 16, v9
    v_and_b32 v47, 0xffff0000, v9
    v_mul_f32 v125, v46, v123
    v_fma_f32 v127, -v125, v122, v46
    v_fma_f32 v46, v127, v123, v125
    v_mul_f32 v126, v47, v123
    v_fma_f32 v128, -v126, v122, v47
    v_fma_f32 v47, v128, v123, v126
    v_cvt_pk_bf16_f32 v9, v46, v47
    v_sub_f32 v48, v48, v121
    v_sub_f32 v49, v49, v121
    v_cvt_pk_bf16_f32 v10, v48, v49
    v_lshlrev_b32 v48, 16, v10
    v_and_b32 v49, 0xffff0000, v10
    v_mul_f32 v125, v48, v123
    v_fma_f32 v127, -v125, v122, v48
    v_fma_f32 v48, v127, v123, v125
    v_mul_f32 v126, v49, v123
    v_fma_f32 v128, -v126, v122, v49
    v_fma_f32 v49, v128, v123, v126
    v_cvt_pk_bf16_f32 v10, v48, v49
    v_sub_f32 v50, v50, v121
    v_sub_f32 v51, v51, v121
    v_cvt_pk_bf16_f32 v11, v50, v51
    v_lshlrev_b32 v50, 16, v11
    v_and_b32 v51, 0xffff0000, v11
    v_mul_f32 v125, v50, v123
    v_fma_f32 v127, -v125, v122, v50
    v_fma_f32 v50, v127, v123, v125
    v_mul_f32 v126, v51, v123
    v_fma_f32 v128, -v126, v122, v51
    v_fma_f32 v51, v128, v123, v126
    v_cvt_pk_bf16_f32 v11, v50, v51
    v_sub_f32 v52, v52, v121
    v_sub_f32 v53, v53, v121
    v_cvt_pk_bf16_f32 v12, v52, v53
    v_lshlrev_b32 v52, 16, v12
    v_and_b32 v53, 0xffff0000, v12
    v_mul_f32 v125, v52, v123
    v_fma_f32 v127, -v125, v122, v52
    v_fma_f32 v52, v127, v123, v125
    v_mul_f32 v126, v53, v123
    v_fma_f32 v128, -v126, v122, v53
    v_fma_f32 v53, v128, v123, v126
    v_cvt_pk_bf16_f32 v12, v52, v53
    v_sub_f32 v54, v54, v121
    v_sub_f32 v55, v55, v121
    v_cvt_pk_bf16_f32 v13, v54, v55
    v_lshlrev_b32 v54, 16, v13
    v_and_b32 v55, 0xffff0000, v13
    v_mul_f32 v125, v54, v123
    v_fma_f32 v127, -v125, v122, v54
    v_fma_f32 v54, v127, v123, v125
    v_mul_f32 v126, v55, v123
    v_fma_f32 v128, -v126, v122, v55
    v_fma_f32 v55, v128, v123, v126
    v_cvt_pk_bf16_f32 v13, v54, v55
    v_sub_f32 v56, v56, v121
    v_sub_f32 v57, v57, v121
    v_cvt_pk_bf16_f32 v14, v56, v57
    v_lshlrev_b32 v56, 16, v14
    v_and_b32 v57, 0xffff0000, v14
    v_mul_f32 v125, v56, v123
    v_fma_f32 v127, -v125, v122, v56
    v_fma_f32 v56, v127, v123, v125
    v_mul_f32 v126, v57, v123
    v_fma_f32 v128, -v126, v122, v57
    v_fma_f32 v57, v128, v123, v126
    v_cvt_pk_bf16_f32 v14, v56, v57
    v_sub_f32 v58, v58, v121
    v_sub_f32 v59, v59, v121
    v_cvt_pk_bf16_f32 v15, v58, v59
    v_lshlrev_b32 v58, 16, v15
    v_and_b32 v59, 0xffff0000, v15
    v_mul_f32 v125, v58, v123
    v_fma_f32 v127, -v125, v122, v58
    v_fma_f32 v58, v127, v123, v125
    v_mul_f32 v126, v59, v123
    v_fma_f32 v128, -v126, v122, v59
    v_fma_f32 v59, v128, v123, v126
    v_cvt_pk_bf16_f32 v15, v58, v59
    v_sub_f32 v60, v60, v121
    v_sub_f32 v61, v61, v121
    v_cvt_pk_bf16_f32 v16, v60, v61
    v_lshlrev_b32 v60, 16, v16
    v_and_b32 v61, 0xffff0000, v16
    v_mul_f32 v125, v60, v123
    v_fma_f32 v127, -v125, v122, v60
    v_fma_f32 v60, v127, v123, v125
    v_mul_f32 v126, v61, v123
    v_fma_f32 v128, -v126, v122, v61
    v_fma_f32 v61, v128, v123, v126
    v_cvt_pk_bf16_f32 v16, v60, v61
    v_sub_f32 v62, v62, v121
    v_sub_f32 v63, v63, v121
    v_cvt_pk_bf16_f32 v17, v62, v63
    v_lshlrev_b32 v62, 16, v17
    v_and_b32 v63, 0xffff0000, v17
    v_mul_f32 v125, v62, v123
    v_fma_f32 v127, -v125, v122, v62
    v_fma_f32 v62, v127, v123, v125
    v_mul_f32 v126, v63, v123
    v_fma_f32 v128, -v126, v122, v63
    v_fma_f32 v63, v128, v123, v126
    v_cvt_pk_bf16_f32 v17, v62, v63
    v_sub_f32 v64, v64, v121
    v_sub_f32 v65, v65, v121
    v_cvt_pk_bf16_f32 v18, v64, v65
    v_lshlrev_b32 v64, 16, v18
    v_and_b32 v65, 0xffff0000, v18
    v_mul_f32 v125, v64, v123
    v_fma_f32 v127, -v125, v122, v64
    v_fma_f32 v64, v127, v123, v125
    v_mul_f32 v126, v65, v123
    v_fma_f32 v128, -v126, v122, v65
    v_fma_f32 v65, v128, v123, v126
    v_cvt_pk_bf16_f32 v18, v64, v65
    v_sub_f32 v66, v66, v121
    v_sub_f32 v67, v67, v121
    v_cvt_pk_bf16_f32 v19, v66, v67
    v_lshlrev_b32 v66, 16, v19
    v_and_b32 v67, 0xffff0000, v19
    v_mul_f32 v125, v66, v123
    v_fma_f32 v127, -v125, v122, v66
    v_fma_f32 v66, v127, v123, v125
    v_mul_f32 v126, v67, v123
    v_fma_f32 v128, -v126, v122, v67
    v_fma_f32 v67, v128, v123, v126
    v_cvt_pk_bf16_f32 v19, v66, v67
    v_sub_f32 v68, v68, v121
    v_sub_f32 v69, v69, v121
    v_cvt_pk_bf16_f32 v20, v68, v69
    v_lshlrev_b32 v68, 16, v20
    v_and_b32 v69, 0xffff0000, v20
    v_mul_f32 v125, v68, v123
    v_fma_f32 v127, -v125, v122, v68
    v_fma_f32 v68, v127, v123, v125
    v_mul_f32 v126, v69, v123
    v_fma_f32 v128, -v126, v122, v69
    v_fma_f32 v69, v128, v123, v126
    v_cvt_pk_bf16_f32 v20, v68, v69
    v_sub_f32 v70, v70, v121
    v_sub_f32 v71, v71, v121
    v_cvt_pk_bf16_f32 v21, v70, v71
    v_lshlrev_b32 v70, 16, v21
    v_and_b32 v71, 0xffff0000, v21
    v_mul_f32 v125, v70, v123
    v_fma_f32 v127, -v125, v122, v70
    v_fma_f32 v70, v127, v123, v125
    v_mul_f32 v126, v71, v123
    v_fma_f32 v128, -v126, v122, v71
    v_fma_f32 v71, v128, v123, v126
    v_cvt_pk_bf16_f32 v21, v70, v71
    v_sub_f32 v72, v72, v121
    v_sub_f32 v73, v73, v121
    v_cvt_pk_bf16_f32 v22, v72, v73
    v_lshlrev_b32 v72, 16, v22
    v_and_b32 v73, 0xffff0000, v22
    v_mul_f32 v125, v72, v123
    v_fma_f32 v127, -v125, v122, v72
    v_fma_f32 v72, v127, v123, v125
    v_mul_f32 v126, v73, v123
    v_fma_f32 v128, -v126, v122, v73
    v_fma_f32 v73, v128, v123, v126
    v_cvt_pk_bf16_f32 v22, v72, v73
    v_sub_f32 v74, v74, v121
    v_sub_f32 v75, v75, v121
    v_cvt_pk_bf16_f32 v23, v74, v75
    v_lshlrev_b32 v74, 16, v23
    v_and_b32 v75, 0xffff0000, v23
    v_mul_f32 v125, v74, v123
    v_fma_f32 v127, -v125, v122, v74
    v_fma_f32 v74, v127, v123, v125
    v_mul_f32 v126, v75, v123
    v_fma_f32 v128, -v126, v122, v75
    v_fma_f32 v75, v128, v123, v126
    v_cvt_pk_bf16_f32 v23, v74, v75
    v_sub_f32 v76, v76, v121
    v_sub_f32 v77, v77, v121
    v_cvt_pk_bf16_f32 v24, v76, v77
    v_lshlrev_b32 v76, 16, v24
    v_and_b32 v77, 0xffff0000, v24
    v_mul_f32 v125, v76, v123
    v_fma_f32 v127, -v125, v122, v76
    v_fma_f32 v76, v127, v123, v125
    v_mul_f32 v126, v77, v123
    v_fma_f32 v128, -v126, v122, v77
    v_fma_f32 v77, v128, v123, v126
    v_cvt_pk_bf16_f32 v24, v76, v77
    v_sub_f32 v78, v78, v121
    v_sub_f32 v79, v79, v121
    v_cvt_pk_bf16_f32 v25, v78, v79
    v_lshlrev_b32 v78, 16, v25
    v_and_b32 v79, 0xffff0000, v25
    v_mul_f32 v125, v78, v123
    v_fma_f32 v127, -v125, v122, v78
    v_fma_f32 v78, v127, v123, v125
    v_mul_f32 v126, v79, v123
    v_fma_f32 v128, -v126, v122, v79
    v_fma_f32 v79, v128, v123, v126
    v_cvt_pk_bf16_f32 v25, v78, v79
    v_sub_f32 v80, v80, v121
    v_sub_f32 v81, v81, v121
    v_cvt_pk_bf16_f32 v26, v80, v81
    v_lshlrev_b32 v80, 16, v26
    v_and_b32 v81, 0xffff0000, v26
    v_mul_f32 v125, v80, v123
    v_fma_f32 v127, -v125, v122, v80
    v_fma_f32 v80, v127, v123, v125
    v_mul_f32 v126, v81, v123
    v_fma_f32 v128, -v126, v122, v81
    v_fma_f32 v81, v128, v123, v126
    v_cvt_pk_bf16_f32 v26, v80, v81
    v_sub_f32 v82, v82, v121
    v_sub_f32 v83, v83, v121
    v_cvt_pk_bf16_f32 v27, v82, v83
    v_lshlrev_b32 v82, 16, v27
    v_and_b32 v83, 0xffff0000, v27
    v_mul_f32 v125, v82, v123
    v_fma_f32 v127, -v125, v122, v82
    v_fma_f32 v82, v127, v123, v125
    v_mul_f32 v126, v83, v123
    v_fma_f32 v128, -v126, v122, v83
    v_fma_f32 v83, v128, v123, v126
    v_cvt_pk_bf16_f32 v27, v82, v83
    v_sub_f32 v84, v84, v121
    v_sub_f32 v85, v85, v121
    v_cvt_pk_bf16_f32 v28, v84, v85
    v_lshlrev_b32 v84, 16, v28
    v_and_b32 v85, 0xffff0000, v28
    v_mul_f32 v125, v84, v123
    v_fma_f32 v127, -v125, v122, v84
    v_fma_f32 v84, v127, v123, v125
    v_mul_f32 v126, v85, v123
    v_fma_f32 v128, -v126, v122, v85
    v_fma_f32 v85, v128, v123, v126
    v_cvt_pk_bf16_f32 v28, v84, v85
    v_sub_f32 v86, v86, v121
    v_sub_f32 v87, v87, v121
    v_cvt_pk_bf16_f32 v29, v86, v87
    v_lshlrev_b32 v86, 16, v29
    v_and_b32 v87, 0xffff0000, v29
    v_mul_f32 v125, v86, v123
    v_fma_f32 v127, -v125, v122, v86
    v_fma_f32 v86, v127, v123, v125
    v_mul_f32 v126, v87, v123
    v_fma_f32 v128, -v126, v122, v87
    v_fma_f32 v87, v128, v123, v126
    v_cvt_pk_bf16_f32 v29, v86, v87
    v_sub_f32 v88, v88, v121
    v_sub_f32 v89, v89, v121
    v_cvt_pk_bf16_f32 v30, v88, v89
    v_lshlrev_b32 v88, 16, v30
    v_and_b32 v89, 0xffff0000, v30
    v_mul_f32 v125, v88, v123
    v_fma_f32 v127, -v125, v122, v88
    v_fma_f32 v88, v127, v123, v125
    v_mul_f32 v126, v89, v123
    v_fma_f32 v128, -v126, v122, v89
    v_fma_f32 v89, v128, v123, v126
    v_cvt_pk_bf16_f32 v30, v88, v89
    v_sub_f32 v90, v90, v121
    v_sub_f32 v91, v91, v121
    v_cvt_pk_bf16_f32 v31, v90, v91
    v_lshlrev_b32 v90, 16, v31
    v_and_b32 v91, 0xffff0000, v31
    v_mul_f32 v125, v90, v123
    v_fma_f32 v127, -v125, v122, v90
    v_fma_f32 v90, v127, v123, v125
    v_mul_f32 v126, v91, v123
    v_fma_f32 v128, -v126, v122, v91
    v_fma_f32 v91, v128, v123, v126
    v_cvt_pk_bf16_f32 v31, v90, v91
    v_sub_f32 v92, v92, v121
    v_sub_f32 v93, v93, v121
    v_cvt_pk_bf16_f32 v32, v92, v93
    v_lshlrev_b32 v92, 16, v32
    v_and_b32 v93, 0xffff0000, v32
    v_mul_f32 v125, v92, v123
    v_fma_f32 v127, -v125, v122, v92
    v_fma_f32 v92, v127, v123, v125
    v_mul_f32 v126, v93, v123
    v_fma_f32 v128, -v126, v122, v93
    v_fma_f32 v93, v128, v123, v126
    v_cvt_pk_bf16_f32 v32, v92, v93
    v_sub_f32 v94, v94, v121
    v_sub_f32 v95, v95, v121
    v_cvt_pk_bf16_f32 v33, v94, v95
    v_lshlrev_b32 v94, 16, v33
    v_and_b32 v95, 0xffff0000, v33
    v_mul_f32 v125, v94, v123
    v_fma_f32 v127, -v125, v122, v94
    v_fma_f32 v94, v127, v123, v125
    v_mul_f32 v126, v95, v123
    v_fma_f32 v128, -v126, v122, v95
    v_fma_f32 v95, v128, v123, v126
    v_cvt_pk_bf16_f32 v33, v94, v95
    v_sub_f32 v96, v96, v121
    v_sub_f32 v97, v97, v121
    v_cvt_pk_bf16_f32 v34, v96, v97
    v_lshlrev_b32 v96, 16, v34
    v_and_b32 v97, 0xffff0000, v34
    v_mul_f32 v125, v96, v123
    v_fma_f32 v127, -v125, v122, v96
    v_fma_f32 v96, v127, v123, v125
    v_mul_f32 v126, v97, v123
    v_fma_f32 v128, -v126, v122, v97
    v_fma_f32 v97, v128, v123, v126
    v_cvt_pk_bf16_f32 v34, v96, v97
    v_sub_f32 v98, v98, v121
    v_sub_f32 v99, v99, v121
    v_cvt_pk_bf16_f32 v35, v98, v99
    v_lshlrev_b32 v98, 16, v35
    v_and_b32 v99, 0xffff0000, v35
    v_mul_f32 v125, v98, v123
    v_fma_f32 v127, -v125, v122, v98
    v_fma_f32 v98, v127, v123, v125
    v_mul_f32 v126, v99, v123
    v_fma_f32 v128, -v126, v122, v99
    v_fma_f32 v99, v128, v123, v126
    v_cvt_pk_bf16_f32 v35, v98, v99
    v_sub_f32 v100, v100, v121
    v_sub_f32 v101, v101, v121
    v_cvt_pk_bf16_f32 v36, v100, v101
    v_lshlrev_b32 v100, 16, v36
    v_and_b32 v101, 0xffff0000, v36
    v_mul_f32 v125, v100, v123
    v_fma_f32 v127, -v125, v122, v100
    v_fma_f32 v100, v127, v123, v125
    v_mul_f32 v126, v101, v123
    v_fma_f32 v128, -v126, v122, v101
    v_fma_f32 v101, v128, v123, v126
    v_cvt_pk_bf16_f32 v36, v100, v101
    v_sub_f32 v102, v102, v121
    v_sub_f32 v103, v103, v121
    v_cvt_pk_bf16_f32 v37, v102, v103
    v_lshlrev_b32 v102, 16, v37
    v_and_b32 v103, 0xffff0000, v37
    v_mul_f32 v125, v102, v123
    v_fma_f32 v127, -v125, v122, v102
    v_fma_f32 v102, v127, v123, v125
    v_mul_f32 v126, v103, v123
    v_fma_f32 v128, -v126, v122, v103
    v_fma_f32 v103, v128, v123, v126
    v_cvt_pk_bf16_f32 v37, v102, v103
    v_sub_f32 v104, v104, v121
    v_sub_f32 v105, v105, v121
    v_cvt_pk_bf16_f32 v38, v104, v105
    v_lshlrev_b32 v104, 16, v38
    v_and_b32 v105, 0xffff0000, v38
    v_mul_f32 v125, v104, v123
    v_fma_f32 v127, -v125, v122, v104
    v_fma_f32 v104, v127, v123, v125
    v_mul_f32 v126, v105, v123
    v_fma_f32 v128, -v126, v122, v105
    v_fma_f32 v105, v128, v123, v126
    v_cvt_pk_bf16_f32 v38, v104, v105
    v_sub_f32 v106, v106, v121
    v_sub_f32 v107, v107, v121
    v_cvt_pk_bf16_f32 v39, v106, v107
    v_lshlrev_b32 v106, 16, v39
    v_and_b32 v107, 0xffff0000, v39
    v_mul_f32 v125, v106, v123
    v_fma_f32 v127, -v125, v122, v106
    v_fma_f32 v106, v127, v123, v125
    v_mul_f32 v126, v107, v123
    v_fma_f32 v128, -v126, v122, v107
    v_fma_f32 v107, v128, v123, v126
    v_cvt_pk_bf16_f32 v39, v106, v107
    v_sub_f32 v108, v108, v121
    v_sub_f32 v109, v109, v121
    v_cvt_pk_bf16_f32 v40, v108, v109
    v_lshlrev_b32 v108, 16, v40
    v_and_b32 v109, 0xffff0000, v40
    v_mul_f32 v125, v108, v123
    v_fma_f32 v127, -v125, v122, v108
    v_fma_f32 v108, v127, v123, v125
    v_mul_f32 v126, v109, v123
    v_fma_f32 v128, -v126, v122, v109
    v_fma_f32 v109, v128, v123, v126
    v_cvt_pk_bf16_f32 v40, v108, v109
    v_sub_f32 v110, v110, v121
    v_sub_f32 v111, v111, v121
    v_cvt_pk_bf16_f32 v41, v110, v111
    v_lshlrev_b32 v110, 16, v41
    v_and_b32 v111, 0xffff0000, v41
    v_mul_f32 v125, v110, v123
    v_fma_f32 v127, -v125, v122, v110
    v_fma_f32 v110, v127, v123, v125
    v_mul_f32 v126, v111, v123
    v_fma_f32 v128, -v126, v122, v111
    v_fma_f32 v111, v128, v123, v126
    v_cvt_pk_bf16_f32 v41, v110, v111
    v_sub_f32 v112, v112, v121
    v_sub_f32 v113, v113, v121
    v_cvt_pk_bf16_f32 v42, v112, v113
    v_lshlrev_b32 v112, 16, v42
    v_and_b32 v113, 0xffff0000, v42
    v_mul_f32 v125, v112, v123
    v_fma_f32 v127, -v125, v122, v112
    v_fma_f32 v112, v127, v123, v125
    v_mul_f32 v126, v113, v123
    v_fma_f32 v128, -v126, v122, v113
    v_fma_f32 v113, v128, v123, v126
    v_cvt_pk_bf16_f32 v42, v112, v113
    v_sub_f32 v114, v114, v121
    v_sub_f32 v115, v115, v121
    v_cvt_pk_bf16_f32 v43, v114, v115
    v_lshlrev_b32 v114, 16, v43
    v_and_b32 v115, 0xffff0000, v43
    v_mul_f32 v125, v114, v123
    v_fma_f32 v127, -v125, v122, v114
    v_fma_f32 v114, v127, v123, v125
    v_mul_f32 v126, v115, v123
    v_fma_f32 v128, -v126, v122, v115
    v_fma_f32 v115, v128, v123, v126
    v_cvt_pk_bf16_f32 v43, v114, v115
    buffer_store_dwordx4 v[8:11], v3, s[36:39], 0 offen offset:0
    buffer_store_dwordx4 v[12:15], v3, s[36:39], 0 offen offset:128
    buffer_store_dwordx4 v[16:19], v3, s[36:39], 0 offen offset:256
    buffer_store_dwordx4 v[20:23], v3, s[36:39], 0 offen offset:384
    buffer_store_dwordx4 v[24:27], v3, s[36:39], 0 offen offset:512
    buffer_store_dwordx4 v[28:31], v3, s[36:39], 0 offen offset:640
    buffer_store_dwordx4 v[32:35], v3, s[36:39], 0 offen offset:768
    buffer_store_dwordx4 v[36:39], v3, s[36:39], 0 offen offset:896
    buffer_store_dwordx4 v[40:43], v3, s[36:39], 0 offen offset:1024
L_ln1_kernel_end:
    s_endpgm
.globl hid_kernel
.p2align 8
.type hid_kernel,@function
hid_kernel:
    s_cmp_ge_u32 s2, 192
    s_cbranch_scc1 L_hid_kernel_end
    s_load_dwordx16 s[4:19], s[0:1], 0
    s_load_dwordx8 s[20:27], s[0:1], 64
    v_lshrrev_b32 v1, 6, v0
    s_nop 0
    v_readfirstlane_b32 s36, v1
    v_and_b32 v1, 63, v0
    s_lshl_b32 s37, s36, 10
    v_and_b32 v124, 15, v1
    v_lshlrev_b32 v124, 7, v124
    v_lshrrev_b32 v125, 4, v1
    v_and_b32 v126, 7, v1
    v_xor_b32 v125, v125, v126
    v_lshl_add_u32 v127, v125, 4, v124
    v_xor_b32 v128, 64, v127
    s_lshr_b32 s38, s36, 1
    s_and_b32 s39, s36, 1
    s_mul_i32 s40, s38, 8192
    s_mul_i32 s41, s39, 6144
    s_add_u32 s41, s41, 16384
    v_add_u32 v9, s40, v127
    v_add_u32 v10, s40, v128
    v_add_u32 v11, s41, v127
    v_add_u32 v12, s41, v128
    s_mov_b32 s42, s38
    s_mov_b32 s43, s39
    s_mov_b32 s50, 0x15555556
    s_mul_hi_u32 s51, s2, s50
    s_mul_i32 s52, s51, 12
    s_sub_u32 s52, s2, s52
    s_lshl_b32 s53, s51, 7
    s_cmp_ge_u32 s52, 6
    s_cselect_b32 s55, 1, 0
    s_mul_i32 s56, s55, 6
    s_sub_u32 s54, s52, s56
    s_mul_i32 s54, s54, 96
    s_waitcnt lgkmcnt(0)
    s_add_u32 s28, s26, 0x298000
    s_addc_u32 s29, s27, 0
    s_and_b32 s29, s29, 0xffff
    s_mov_b32 s30, 0x240000
    s_mov_b32 s31, 0x00020000
    s_cmp_ge_u32 s52, 6
    s_cselect_b32 s32, s20, s18
    s_cselect_b32 s33, s21, s19
    s_and_b32 s33, s33, 0xffff
    s_mov_b32 s34, 663552
    s_mov_b32 s35, 0x00020000
    v_lshrrev_b32 v124, 3, v1
    v_and_b32 v125, 7, v1
    v_xor_b32 v125, v125, v124
    v_lshlrev_b32 v125, 4, v125
    s_lshl_b32 s44, s36, 3
    v_add_u32 v124, s44, v124
    s_mov_b32 s45, 1152
    s_mov_b32 s46, 1152
    v_add_u32 v126, 0, v124
    v_add_u32 v126, s53, v126
    v_mul_lo_u32 v126, v126, s45
    v_add_u32 v2, v126, v125
    v_add_u32 v126, 32, v124
    v_add_u32 v126, s53, v126
    v_mul_lo_u32 v126, v126, s45
    v_add_u32 v3, v126, v125
    v_add_u32 v126, 64, v124
    v_add_u32 v126, s53, v126
    v_mul_lo_u32 v126, v126, s45
    v_add_u32 v4, v126, v125
    v_add_u32 v126, 96, v124
    v_add_u32 v126, s53, v126
    v_mul_lo_u32 v126, v126, s45
    v_add_u32 v5, v126, v125
    v_add_u32 v126, 0, v124
    v_add_u32 v126, s54, v126
    v_mul_lo_u32 v126, v126, s46
    v_add_u32 v6, v126, v125
    v_add_u32 v126, 32, v124
    v_add_u32 v126, s54, v126
    v_mul_lo_u32 v126, v126, s46
    v_add_u32 v7, v126, v125
    v_add_u32 v126, 64, v124
    v_add_u32 v126, s54, v126
    v_mul_lo_u32 v126, v126, s46
    v_add_u32 v8, v126, v125
    v_mov_b32 v76, 0
    v_mov_b32 v77, 0
    v_mov_b32 v78, 0
    v_mov_b32 v79, 0
    v_mov_b32 v80, 0
    v_mov_b32 v81, 0
    v_mov_b32 v82, 0
    v_mov_b32 v83, 0
    v_mov_b32 v84, 0
    v_mov_b32 v85, 0
    v_mov_b32 v86, 0
    v_mov_b32 v87, 0
    v_mov_b32 v88, 0
    v_mov_b32 v89, 0
    v_mov_b32 v90, 0
    v_mov_b32 v91, 0
    v_mov_b32 v92, 0
    v_mov_b32 v93, 0
    v_mov_b32 v94, 0
    v_mov_b32 v95, 0
    v_mov_b32 v96, 0
    v_mov_b32 v97, 0
    v_mov_b32 v98, 0
    v_mov_b32 v99, 0
    v_mov_b32 v100, 0
    v_mov_b32 v101, 0
    v_mov_b32 v102, 0
    v_mov_b32 v103, 0
    v_mov_b32 v104, 0
    v_mov_b32 v105, 0
    v_mov_b32 v106, 0
    v_mov_b32 v107, 0
    v_mov_b32 v108, 0
    v_mov_b32 v109, 0
    v_mov_b32 v110, 0
    v_mov_b32 v111, 0
    v_mov_b32 v112, 0
    v_mov_b32 v113, 0
    v_mov_b32 v114, 0
    v_mov_b32 v115, 0
    v_mov_b32 v116, 0
    v_mov_b32 v117, 0
    v_mov_b32 v118, 0
    v_mov_b32 v119, 0
    v_mov_b32 v120, 0
    v_mov_b32 v121, 0
    v_mov_b32 v122, 0
    v_mov_b32 v123, 0
    s_mov_b32 s47, 0
    s_mov_b32 s48, 0
    s_add_u32 m0, s37, 0
    s_nop 0
    buffer_load_dwordx4 v2, s[28:31], s47 offen lds
    s_add_u32 m0, s37, 4096
    s_nop 0
    buffer_load_dwordx4 v3, s[28:31], s47 offen lds
    s_add_u32 m0, s37, 8192
    s_nop 0
    buffer_load_dwordx4 v4, s[28:31], s47 offen lds
    s_add_u32 m0, s37, 12288
    s_nop 0
    buffer_load_dwordx4 v5, s[28:31], s47 offen lds
    s_add_u32 m0, s37, 16384
    s_nop 0
    buffer_load_dwordx4 v6, s[32:35], s48 offen lds
    s_add_u32 m0, s37, 20480
    s_nop 0
    buffer_load_dwordx4 v7, s[32:35], s48 offen lds
    s_add_u32 m0, s37, 24576
    s_nop 0
    buffer_load_dwordx4 v8, s[32:35], s48 offen lds
    s_add_u32 s47, s47, 128
    s_add_u32 s48, s48, 128
    s_add_u32 m0, s37, 28672
    s_nop 0
    buffer_load_dwordx4 v2, s[28:31], s47 offen lds
    s_add_u32 m0, s37, 32768
    s_nop 0
    buffer_load_dwordx4 v3, s[28:31], s47 offen lds
    s_add_u32 m0, s37, 36864
    s_nop 0
    buffer_load_dwordx4 v4, s[28:31], s47 offen lds
    s_add_u32 m0, s37, 40960
    s_nop 0
    buffer_load_dwordx4 v5, s[28:31], s47 offen lds
    s_add_u32 m0, s37, 45056
    s_nop 0
    buffer_load_dwordx4 v6, s[32:35], s48 offen lds
    s_add_u32 m0, s37, 49152
    s_nop 0
    buffer_load_dwordx4 v7, s[32:35], s48 offen lds
    s_add_u32 m0, s37, 53248
    s_nop 0
    buffer_load_dwordx4 v8, s[32:35], s48 offen lds
    s_add_u32 s47, s47, 128
    s_add_u32 s48, s48, 128
    s_mov_b32 s49, 2
L_hid_kernel_loop:
    s_waitcnt vmcnt(7)
    s_barrier
    s_add_u32 m0, s37, 57344
    s_nop 0
    buffer_load_dwordx4 v2, s[28:31], s47 offen lds
    s_add_u32 m0, s37, 61440
    s_nop 0
    buffer_load_dwordx4 v3, s[28:31], s47 offen lds
    s_add_u32 m0, s37, 65536
    s_nop 0
    buffer_load_dwordx4 v4, s[28:31], s47 offen lds
    s_add_u32 m0, s37, 69632
    s_nop 0
    buffer_load_dwordx4 v5, s[28:31], s47 offen lds
    s_add_u32 m0, s37, 73728
    s_nop 0
    buffer_load_dwordx4 v6, s[32:35], s48 offen lds
    s_add_u32 m0, s37, 77824
    s_nop 0
    buffer_load_dwordx4 v7, s[32:35], s48 offen lds
    s_add_u32 m0, s37, 81920
    s_nop 0
    buffer_load_dwordx4 v8, s[32:35], s48 offen lds
    s_add_u32 s47, s47, 128
    s_add_u32 s48, s48, 128
    ds_read_b128 v[20:23], v9 offset:0
    ds_read_b128 v[28:31], v9 offset:2048
    ds_read_b128 v[36:39], v9 offset:4096
    ds_read_b128 v[44:47], v9 offset:6144
    ds_read_b128 v[52:55], v11 offset:0
    ds_read_b128 v[60:63], v11 offset:2048
    ds_read_b128 v[68:71], v11 offset:4096
    ds_read_b128 v[24:27], v10 offset:0
    ds_read_b128 v[32:35], v10 offset:2048
    ds_read_b128 v[40:43], v10 offset:4096
    ds_read_b128 v[48:51], v10 offset:6144
    ds_read_b128 v[56:59], v12 offset:0
    ds_read_b128 v[64:67], v12 offset:2048
    ds_read_b128 v[72:75], v12 offset:4096
    s_waitcnt lgkmcnt(7)
    v_mfma_f32_16x16x32_bf16 v[76:79], v[20:23], v[52:55], v[76:79]
    v_mfma_f32_16x16x32_bf16 v[80:83], v[20:23], v[60:63], v[80:83]
    v_mfma_f32_16x16x32_bf16 v[84:87], v[20:23], v[68:71], v[84:87]
    v_mfma_f32_16x16x32_bf16 v[88:91], v[28:31], v[52:55], v[88:91]
    v_mfma_f32_16x16x32_bf16 v[92:95], v[28:31], v[60:63], v[92:95]
    v_mfma_f32_16x16x32_bf16 v[96:99], v[28:31], v[68:71], v[96:99]
    v_mfma_f32_16x16x32_bf16 v[100:103], v[36:39], v[52:55], v[100:103]
    v_mfma_f32_16x16x32_bf16 v[104:107], v[36:39], v[60:63], v[104:107]
    v_mfma_f32_16x16x32_bf16 v[108:111], v[36:39], v[68:71], v[108:111]
    v_mfma_f32_16x16x32_bf16 v[112:115], v[44:47], v[52:55], v[112:115]
    v_mfma_f32_16x16x32_bf16 v[116:119], v[44:47], v[60:63], v[116:119]
    v_mfma_f32_16x16x32_bf16 v[120:123], v[44:47], v[68:71], v[120:123]
    s_waitcnt lgkmcnt(0)
    v_mfma_f32_16x16x32_bf16 v[76:79], v[24:27], v[56:59], v[76:79]
    v_mfma_f32_16x16x32_bf16 v[80:83], v[24:27], v[64:67], v[80:83]
    v_mfma_f32_16x16x32_bf16 v[84:87], v[24:27], v[72:75], v[84:87]
    v_mfma_f32_16x16x32_bf16 v[88:91], v[32:35], v[56:59], v[88:91]
    v_mfma_f32_16x16x32_bf16 v[92:95], v[32:35], v[64:67], v[92:95]
    v_mfma_f32_16x16x32_bf16 v[96:99], v[32:35], v[72:75], v[96:99]
    v_mfma_f32_16x16x32_bf16 v[100:103], v[40:43], v[56:59], v[100:103]
    v_mfma_f32_16x16x32_bf16 v[104:107], v[40:43], v[64:67], v[104:107]
    v_mfma_f32_16x16x32_bf16 v[108:111], v[40:43], v[72:75], v[108:111]
    v_mfma_f32_16x16x32_bf16 v[112:115], v[48:51], v[56:59], v[112:115]
    v_mfma_f32_16x16x32_bf16 v[116:119], v[48:51], v[64:67], v[116:119]
    v_mfma_f32_16x16x32_bf16 v[120:123], v[48:51], v[72:75], v[120:123]
    s_waitcnt vmcnt(7)
    s_barrier
    s_add_u32 m0, s37, 0
    s_nop 0
    buffer_load_dwordx4 v2, s[28:31], s47 offen lds
    s_add_u32 m0, s37, 4096
    s_nop 0
    buffer_load_dwordx4 v3, s[28:31], s47 offen lds
    s_add_u32 m0, s37, 8192
    s_nop 0
    buffer_load_dwordx4 v4, s[28:31], s47 offen lds
    s_add_u32 m0, s37, 12288
    s_nop 0
    buffer_load_dwordx4 v5, s[28:31], s47 offen lds
    s_add_u32 m0, s37, 16384
    s_nop 0
    buffer_load_dwordx4 v6, s[32:35], s48 offen lds
    s_add_u32 m0, s37, 20480
    s_nop 0
    buffer_load_dwordx4 v7, s[32:35], s48 offen lds
    s_add_u32 m0, s37, 24576
    s_nop 0
    buffer_load_dwordx4 v8, s[32:35], s48 offen lds
    s_add_u32 s47, s47, 128
    s_add_u32 s48, s48, 128
    v_add_u32 v13, 28672, v9
    v_add_u32 v14, 28672, v10
    v_add_u32 v15, 28672, v11
    v_add_u32 v16, 28672, v12
    ds_read_b128 v[20:23], v13 offset:0
    ds_read_b128 v[28:31], v13 offset:2048
    ds_read_b128 v[36:39], v13 offset:4096
    ds_read_b128 v[44:47], v13 offset:6144
    ds_read_b128 v[52:55], v15 offset:0
    ds_read_b128 v[60:63], v15 offset:2048
    ds_read_b128 v[68:71], v15 offset:4096
    ds_read_b128 v[24:27], v14 offset:0
    ds_read_b128 v[32:35], v14 offset:2048
    ds_read_b128 v[40:43], v14 offset:4096
    ds_read_b128 v[48:51], v14 offset:6144
    ds_read_b128 v[56:59], v16 offset:0
    ds_read_b128 v[64:67], v16 offset:2048
    ds_read_b128 v[72:75], v16 offset:4096
    s_waitcnt lgkmcnt(7)
    v_mfma_f32_16x16x32_bf16 v[76:79], v[20:23], v[52:55], v[76:79]
    v_mfma_f32_16x16x32_bf16 v[80:83], v[20:23], v[60:63], v[80:83]
    v_mfma_f32_16x16x32_bf16 v[84:87], v[20:23], v[68:71], v[84:87]
    v_mfma_f32_16x16x32_bf16 v[88:91], v[28:31], v[52:55], v[88:91]
    v_mfma_f32_16x16x32_bf16 v[92:95], v[28:31], v[60:63], v[92:95]
    v_mfma_f32_16x16x32_bf16 v[96:99], v[28:31], v[68:71], v[96:99]
    v_mfma_f32_16x16x32_bf16 v[100:103], v[36:39], v[52:55], v[100:103]
    v_mfma_f32_16x16x32_bf16 v[104:107], v[36:39], v[60:63], v[104:107]
    v_mfma_f32_16x16x32_bf16 v[108:111], v[36:39], v[68:71], v[108:111]
    v_mfma_f32_16x16x32_bf16 v[112:115], v[44:47], v[52:55], v[112:115]
    v_mfma_f32_16x16x32_bf16 v[116:119], v[44:47], v[60:63], v[116:119]
    v_mfma_f32_16x16x32_bf16 v[120:123], v[44:47], v[68:71], v[120:123]
    s_waitcnt lgkmcnt(0)
    v_mfma_f32_16x16x32_bf16 v[76:79], v[24:27], v[56:59], v[76:79]
    v_mfma_f32_16x16x32_bf16 v[80:83], v[24:27], v[64:67], v[80:83]
    v_mfma_f32_16x16x32_bf16 v[84:87], v[24:27], v[72:75], v[84:87]
    v_mfma_f32_16x16x32_bf16 v[88:91], v[32:35], v[56:59], v[88:91]
    v_mfma_f32_16x16x32_bf16 v[92:95], v[32:35], v[64:67], v[92:95]
    v_mfma_f32_16x16x32_bf16 v[96:99], v[32:35], v[72:75], v[96:99]
    v_mfma_f32_16x16x32_bf16 v[100:103], v[40:43], v[56:59], v[100:103]
    v_mfma_f32_16x16x32_bf16 v[104:107], v[40:43], v[64:67], v[104:107]
    v_mfma_f32_16x16x32_bf16 v[108:111], v[40:43], v[72:75], v[108:111]
    v_mfma_f32_16x16x32_bf16 v[112:115], v[48:51], v[56:59], v[112:115]
    v_mfma_f32_16x16x32_bf16 v[116:119], v[48:51], v[64:67], v[116:119]
    v_mfma_f32_16x16x32_bf16 v[120:123], v[48:51], v[72:75], v[120:123]
    s_waitcnt vmcnt(7)
    s_barrier
    s_add_u32 m0, s37, 28672
    s_nop 0
    buffer_load_dwordx4 v2, s[28:31], s47 offen lds
    s_add_u32 m0, s37, 32768
    s_nop 0
    buffer_load_dwordx4 v3, s[28:31], s47 offen lds
    s_add_u32 m0, s37, 36864
    s_nop 0
    buffer_load_dwordx4 v4, s[28:31], s47 offen lds
    s_add_u32 m0, s37, 40960
    s_nop 0
    buffer_load_dwordx4 v5, s[28:31], s47 offen lds
    s_add_u32 m0, s37, 45056
    s_nop 0
    buffer_load_dwordx4 v6, s[32:35], s48 offen lds
    s_add_u32 m0, s37, 49152
    s_nop 0
    buffer_load_dwordx4 v7, s[32:35], s48 offen lds
    s_add_u32 m0, s37, 53248
    s_nop 0
    buffer_load_dwordx4 v8, s[32:35], s48 offen lds
    s_add_u32 s47, s47, 128
    s_add_u32 s48, s48, 128
    v_add_u32 v13, 57344, v9
    v_add_u32 v14, 57344, v10
    v_add_u32 v15, 57344, v11
    v_add_u32 v16, 57344, v12
    ds_read_b128 v[20:23], v13 offset:0
    ds_read_b128 v[28:31], v13 offset:2048
    ds_read_b128 v[36:39], v13 offset:4096
    ds_read_b128 v[44:47], v13 offset:6144
    ds_read_b128 v[52:55], v15 offset:0
    ds_read_b128 v[60:63], v15 offset:2048
    ds_read_b128 v[68:71], v15 offset:4096
    ds_read_b128 v[24:27], v14 offset:0
    ds_read_b128 v[32:35], v14 offset:2048
    ds_read_b128 v[40:43], v14 offset:4096
    ds_read_b128 v[48:51], v14 offset:6144
    ds_read_b128 v[56:59], v16 offset:0
    ds_read_b128 v[64:67], v16 offset:2048
    ds_read_b128 v[72:75], v16 offset:4096
    s_waitcnt lgkmcnt(7)
    v_mfma_f32_16x16x32_bf16 v[76:79], v[20:23], v[52:55], v[76:79]
    v_mfma_f32_16x16x32_bf16 v[80:83], v[20:23], v[60:63], v[80:83]
    v_mfma_f32_16x16x32_bf16 v[84:87], v[20:23], v[68:71], v[84:87]
    v_mfma_f32_16x16x32_bf16 v[88:91], v[28:31], v[52:55], v[88:91]
    v_mfma_f32_16x16x32_bf16 v[92:95], v[28:31], v[60:63], v[92:95]
    v_mfma_f32_16x16x32_bf16 v[96:99], v[28:31], v[68:71], v[96:99]
    v_mfma_f32_16x16x32_bf16 v[100:103], v[36:39], v[52:55], v[100:103]
    v_mfma_f32_16x16x32_bf16 v[104:107], v[36:39], v[60:63], v[104:107]
    v_mfma_f32_16x16x32_bf16 v[108:111], v[36:39], v[68:71], v[108:111]
    v_mfma_f32_16x16x32_bf16 v[112:115], v[44:47], v[52:55], v[112:115]
    v_mfma_f32_16x16x32_bf16 v[116:119], v[44:47], v[60:63], v[116:119]
    v_mfma_f32_16x16x32_bf16 v[120:123], v[44:47], v[68:71], v[120:123]
    s_waitcnt lgkmcnt(0)
    v_mfma_f32_16x16x32_bf16 v[76:79], v[24:27], v[56:59], v[76:79]
    v_mfma_f32_16x16x32_bf16 v[80:83], v[24:27], v[64:67], v[80:83]
    v_mfma_f32_16x16x32_bf16 v[84:87], v[24:27], v[72:75], v[84:87]
    v_mfma_f32_16x16x32_bf16 v[88:91], v[32:35], v[56:59], v[88:91]
    v_mfma_f32_16x16x32_bf16 v[92:95], v[32:35], v[64:67], v[92:95]
    v_mfma_f32_16x16x32_bf16 v[96:99], v[32:35], v[72:75], v[96:99]
    v_mfma_f32_16x16x32_bf16 v[100:103], v[40:43], v[56:59], v[100:103]
    v_mfma_f32_16x16x32_bf16 v[104:107], v[40:43], v[64:67], v[104:107]
    v_mfma_f32_16x16x32_bf16 v[108:111], v[40:43], v[72:75], v[108:111]
    v_mfma_f32_16x16x32_bf16 v[112:115], v[48:51], v[56:59], v[112:115]
    v_mfma_f32_16x16x32_bf16 v[116:119], v[48:51], v[64:67], v[116:119]
    v_mfma_f32_16x16x32_bf16 v[120:123], v[48:51], v[72:75], v[120:123]
    s_sub_u32 s49, s49, 1
    s_cmp_lg_u32 s49, 0
    s_cbranch_scc1 L_hid_kernel_loop
    s_waitcnt vmcnt(7)
    s_barrier
    s_add_u32 m0, s37, 57344
    s_nop 0
    buffer_load_dwordx4 v2, s[28:31], s47 offen lds
    s_add_u32 m0, s37, 61440
    s_nop 0
    buffer_load_dwordx4 v3, s[28:31], s47 offen lds
    s_add_u32 m0, s37, 65536
    s_nop 0
    buffer_load_dwordx4 v4, s[28:31], s47 offen lds
    s_add_u32 m0, s37, 69632
    s_nop 0
    buffer_load_dwordx4 v5, s[28:31], s47 offen lds
    s_add_u32 m0, s37, 73728
    s_nop 0
    buffer_load_dwordx4 v6, s[32:35], s48 offen lds
    s_add_u32 m0, s37, 77824
    s_nop 0
    buffer_load_dwordx4 v7, s[32:35], s48 offen lds
    s_add_u32 m0, s37, 81920
    s_nop 0
    buffer_load_dwordx4 v8, s[32:35], s48 offen lds
    s_add_u32 s47, s47, 128
    s_add_u32 s48, s48, 128
    ds_read_b128 v[20:23], v9 offset:0
    ds_read_b128 v[28:31], v9 offset:2048
    ds_read_b128 v[36:39], v9 offset:4096
    ds_read_b128 v[44:47], v9 offset:6144
    ds_read_b128 v[52:55], v11 offset:0
    ds_read_b128 v[60:63], v11 offset:2048
    ds_read_b128 v[68:71], v11 offset:4096
    ds_read_b128 v[24:27], v10 offset:0
    ds_read_b128 v[32:35], v10 offset:2048
    ds_read_b128 v[40:43], v10 offset:4096
    ds_read_b128 v[48:51], v10 offset:6144
    ds_read_b128 v[56:59], v12 offset:0
    ds_read_b128 v[64:67], v12 offset:2048
    ds_read_b128 v[72:75], v12 offset:4096
    s_waitcnt lgkmcnt(7)
    v_mfma_f32_16x16x32_bf16 v[76:79], v[20:23], v[52:55], v[76:79]
    v_mfma_f32_16x16x32_bf16 v[80:83], v[20:23], v[60:63], v[80:83]
    v_mfma_f32_16x16x32_bf16 v[84:87], v[20:23], v[68:71], v[84:87]
    v_mfma_f32_16x16x32_bf16 v[88:91], v[28:31], v[52:55], v[88:91]
    v_mfma_f32_16x16x32_bf16 v[92:95], v[28:31], v[60:63], v[92:95]
    v_mfma_f32_16x16x32_bf16 v[96:99], v[28:31], v[68:71], v[96:99]
    v_mfma_f32_16x16x32_bf16 v[100:103], v[36:39], v[52:55], v[100:103]
    v_mfma_f32_16x16x32_bf16 v[104:107], v[36:39], v[60:63], v[104:107]
    v_mfma_f32_16x16x32_bf16 v[108:111], v[36:39], v[68:71], v[108:111]
    v_mfma_f32_16x16x32_bf16 v[112:115], v[44:47], v[52:55], v[112:115]
    v_mfma_f32_16x16x32_bf16 v[116:119], v[44:47], v[60:63], v[116:119]
    v_mfma_f32_16x16x32_bf16 v[120:123], v[44:47], v[68:71], v[120:123]
    s_waitcnt lgkmcnt(0)
    v_mfma_f32_16x16x32_bf16 v[76:79], v[24:27], v[56:59], v[76:79]
    v_mfma_f32_16x16x32_bf16 v[80:83], v[24:27], v[64:67], v[80:83]
    v_mfma_f32_16x16x32_bf16 v[84:87], v[24:27], v[72:75], v[84:87]
    v_mfma_f32_16x16x32_bf16 v[88:91], v[32:35], v[56:59], v[88:91]
    v_mfma_f32_16x16x32_bf16 v[92:95], v[32:35], v[64:67], v[92:95]
    v_mfma_f32_16x16x32_bf16 v[96:99], v[32:35], v[72:75], v[96:99]
    v_mfma_f32_16x16x32_bf16 v[100:103], v[40:43], v[56:59], v[100:103]
    v_mfma_f32_16x16x32_bf16 v[104:107], v[40:43], v[64:67], v[104:107]
    v_mfma_f32_16x16x32_bf16 v[108:111], v[40:43], v[72:75], v[108:111]
    v_mfma_f32_16x16x32_bf16 v[112:115], v[48:51], v[56:59], v[112:115]
    v_mfma_f32_16x16x32_bf16 v[116:119], v[48:51], v[64:67], v[116:119]
    v_mfma_f32_16x16x32_bf16 v[120:123], v[48:51], v[72:75], v[120:123]
    s_waitcnt vmcnt(7)
    s_barrier
    v_add_u32 v13, 28672, v9
    v_add_u32 v14, 28672, v10
    v_add_u32 v15, 28672, v11
    v_add_u32 v16, 28672, v12
    ds_read_b128 v[20:23], v13 offset:0
    ds_read_b128 v[28:31], v13 offset:2048
    ds_read_b128 v[36:39], v13 offset:4096
    ds_read_b128 v[44:47], v13 offset:6144
    ds_read_b128 v[52:55], v15 offset:0
    ds_read_b128 v[60:63], v15 offset:2048
    ds_read_b128 v[68:71], v15 offset:4096
    ds_read_b128 v[24:27], v14 offset:0
    ds_read_b128 v[32:35], v14 offset:2048
    ds_read_b128 v[40:43], v14 offset:4096
    ds_read_b128 v[48:51], v14 offset:6144
    ds_read_b128 v[56:59], v16 offset:0
    ds_read_b128 v[64:67], v16 offset:2048
    ds_read_b128 v[72:75], v16 offset:4096
    s_waitcnt lgkmcnt(7)
    v_mfma_f32_16x16x32_bf16 v[76:79], v[20:23], v[52:55], v[76:79]
    v_mfma_f32_16x16x32_bf16 v[80:83], v[20:23], v[60:63], v[80:83]
    v_mfma_f32_16x16x32_bf16 v[84:87], v[20:23], v[68:71], v[84:87]
    v_mfma_f32_16x16x32_bf16 v[88:91], v[28:31], v[52:55], v[88:91]
    v_mfma_f32_16x16x32_bf16 v[92:95], v[28:31], v[60:63], v[92:95]
    v_mfma_f32_16x16x32_bf16 v[96:99], v[28:31], v[68:71], v[96:99]
    v_mfma_f32_16x16x32_bf16 v[100:103], v[36:39], v[52:55], v[100:103]
    v_mfma_f32_16x16x32_bf16 v[104:107], v[36:39], v[60:63], v[104:107]
    v_mfma_f32_16x16x32_bf16 v[108:111], v[36:39], v[68:71], v[108:111]
    v_mfma_f32_16x16x32_bf16 v[112:115], v[44:47], v[52:55], v[112:115]
    v_mfma_f32_16x16x32_bf16 v[116:119], v[44:47], v[60:63], v[116:119]
    v_mfma_f32_16x16x32_bf16 v[120:123], v[44:47], v[68:71], v[120:123]
    s_waitcnt lgkmcnt(0)
    v_mfma_f32_16x16x32_bf16 v[76:79], v[24:27], v[56:59], v[76:79]
    v_mfma_f32_16x16x32_bf16 v[80:83], v[24:27], v[64:67], v[80:83]
    v_mfma_f32_16x16x32_bf16 v[84:87], v[24:27], v[72:75], v[84:87]
    v_mfma_f32_16x16x32_bf16 v[88:91], v[32:35], v[56:59], v[88:91]
    v_mfma_f32_16x16x32_bf16 v[92:95], v[32:35], v[64:67], v[92:95]
    v_mfma_f32_16x16x32_bf16 v[96:99], v[32:35], v[72:75], v[96:99]
    v_mfma_f32_16x16x32_bf16 v[100:103], v[40:43], v[56:59], v[100:103]
    v_mfma_f32_16x16x32_bf16 v[104:107], v[40:43], v[64:67], v[104:107]
    v_mfma_f32_16x16x32_bf16 v[108:111], v[40:43], v[72:75], v[108:111]
    v_mfma_f32_16x16x32_bf16 v[112:115], v[48:51], v[56:59], v[112:115]
    v_mfma_f32_16x16x32_bf16 v[116:119], v[48:51], v[64:67], v[116:119]
    v_mfma_f32_16x16x32_bf16 v[120:123], v[48:51], v[72:75], v[120:123]
    s_waitcnt vmcnt(0)
    s_barrier
    v_add_u32 v13, 57344, v9
    v_add_u32 v14, 57344, v10
    v_add_u32 v15, 57344, v11
    v_add_u32 v16, 57344, v12
    ds_read_b128 v[20:23], v13 offset:0
    ds_read_b128 v[28:31], v13 offset:2048
    ds_read_b128 v[36:39], v13 offset:4096
    ds_read_b128 v[44:47], v13 offset:6144
    ds_read_b128 v[52:55], v15 offset:0
    ds_read_b128 v[60:63], v15 offset:2048
    ds_read_b128 v[68:71], v15 offset:4096
    ds_read_b128 v[24:27], v14 offset:0
    ds_read_b128 v[32:35], v14 offset:2048
    ds_read_b128 v[40:43], v14 offset:4096
    ds_read_b128 v[48:51], v14 offset:6144
    ds_read_b128 v[56:59], v16 offset:0
    ds_read_b128 v[64:67], v16 offset:2048
    ds_read_b128 v[72:75], v16 offset:4096
    s_waitcnt lgkmcnt(7)
    v_mfma_f32_16x16x32_bf16 v[76:79], v[20:23], v[52:55], v[76:79]
    v_mfma_f32_16x16x32_bf16 v[80:83], v[20:23], v[60:63], v[80:83]
    v_mfma_f32_16x16x32_bf16 v[84:87], v[20:23], v[68:71], v[84:87]
    v_mfma_f32_16x16x32_bf16 v[88:91], v[28:31], v[52:55], v[88:91]
    v_mfma_f32_16x16x32_bf16 v[92:95], v[28:31], v[60:63], v[92:95]
    v_mfma_f32_16x16x32_bf16 v[96:99], v[28:31], v[68:71], v[96:99]
    v_mfma_f32_16x16x32_bf16 v[100:103], v[36:39], v[52:55], v[100:103]
    v_mfma_f32_16x16x32_bf16 v[104:107], v[36:39], v[60:63], v[104:107]
    v_mfma_f32_16x16x32_bf16 v[108:111], v[36:39], v[68:71], v[108:111]
    v_mfma_f32_16x16x32_bf16 v[112:115], v[44:47], v[52:55], v[112:115]
    v_mfma_f32_16x16x32_bf16 v[116:119], v[44:47], v[60:63], v[116:119]
    v_mfma_f32_16x16x32_bf16 v[120:123], v[44:47], v[68:71], v[120:123]
    s_waitcnt lgkmcnt(0)
    v_mfma_f32_16x16x32_bf16 v[76:79], v[24:27], v[56:59], v[76:79]
    v_mfma_f32_16x16x32_bf16 v[80:83], v[24:27], v[64:67], v[80:83]
    v_mfma_f32_16x16x32_bf16 v[84:87], v[24:27], v[72:75], v[84:87]
    v_mfma_f32_16x16x32_bf16 v[88:91], v[32:35], v[56:59], v[88:91]
    v_mfma_f32_16x16x32_bf16 v[92:95], v[32:35], v[64:67], v[92:95]
    v_mfma_f32_16x16x32_bf16 v[96:99], v[32:35], v[72:75], v[96:99]
    v_mfma_f32_16x16x32_bf16 v[100:103], v[40:43], v[56:59], v[100:103]
    v_mfma_f32_16x16x32_bf16 v[104:107], v[40:43], v[64:67], v[104:107]
    v_mfma_f32_16x16x32_bf16 v[108:111], v[40:43], v[72:75], v[108:111]
    v_mfma_f32_16x16x32_bf16 v[112:115], v[48:51], v[56:59], v[112:115]
    v_mfma_f32_16x16x32_bf16 v[116:119], v[48:51], v[64:67], v[116:119]
    v_mfma_f32_16x16x32_bf16 v[120:123], v[48:51], v[72:75], v[120:123]
    s_add_u32 s28, s26, 0x1bf8000
    s_addc_u32 s29, s27, 0
    s_and_b32 s29, s29, 0xffff
    s_mov_b32 s30, 0x480000
    s_mov_b32 s31, 0x00020000
    s_mul_i32 s56, s52, 96
    s_mul_i32 s57, s43, 48
    s_add_u32 s56, s56, s57
    s_mul_i32 s57, s42, 64
    s_add_u32 s57, s57, s53
    v_and_b32 v124, 15, v1
    v_add_u32 v124, s56, v124
    v_lshlrev_b32 v124, 12, v124
    v_lshrrev_b32 v125, 4, v1
    v_lshlrev_b32 v125, 2, v125
    v_add_u32 v125, s57, v125
    v_lshl_add_u32 v124, v125, 1, v124
    v_cvt_pk_bf16_f32 v126, v76, v77
    v_cvt_pk_bf16_f32 v127, v78, v79
    s_mov_b32 s58, 0
    buffer_store_dwordx2 v[126:127], v124, s[28:31], s58 offen offset:0
    v_cvt_pk_bf16_f32 v126, v80, v81
    v_cvt_pk_bf16_f32 v127, v82, v83
    s_mov_b32 s58, 65536
    buffer_store_dwordx2 v[126:127], v124, s[28:31], s58 offen offset:0
    v_cvt_pk_bf16_f32 v126, v84, v85
    v_cvt_pk_bf16_f32 v127, v86, v87
    s_mov_b32 s58, 131072
    buffer_store_dwordx2 v[126:127], v124, s[28:31], s58 offen offset:0
    v_cvt_pk_bf16_f32 v126, v88, v89
    v_cvt_pk_bf16_f32 v127, v90, v91
    s_mov_b32 s58, 0
    buffer_store_dwordx2 v[126:127], v124, s[28:31], s58 offen offset:32
    v_cvt_pk_bf16_f32 v126, v92, v93
    v_cvt_pk_bf16_f32 v127, v94, v95
    s_mov_b32 s58, 65536
    buffer_store_dwordx2 v[126:127], v124, s[28:31], s58 offen offset:32
    v_cvt_pk_bf16_f32 v126, v96, v97
    v_cvt_pk_bf16_f32 v127, v98, v99
    s_mov_b32 s58, 131072
    buffer_store_dwordx2 v[126:127], v124, s[28:31], s58 offen offset:32
    v_cvt_pk_bf16_f32 v126, v100, v101
    v_cvt_pk_bf16_f32 v127, v102, v103
    s_mov_b32 s58, 0
    buffer_store_dwordx2 v[126:127], v124, s[28:31], s58 offen offset:64
    v_cvt_pk_bf16_f32 v126, v104, v105
    v_cvt_pk_bf16_f32 v127, v106, v107
    s_mov_b32 s58, 65536
    buffer_store_dwordx2 v[126:127], v124, s[28:31], s58 offen offset:64
    v_cvt_pk_bf16_f32 v126, v108, v109
    v_cvt_pk_bf16_f32 v127, v110, v111
    s_mov_b32 s58, 131072
    buffer_store_dwordx2 v[126:127], v124, s[28:31], s58 offen offset:64
    v_cvt_pk_bf16_f32 v126, v112, v113
    v_cvt_pk_bf16_f32 v127, v114, v115
    s_mov_b32 s58, 0
    buffer_store_dwordx2 v[126:127], v124, s[28:31], s58 offen offset:96
    v_cvt_pk_bf16_f32 v126, v116, v117
    v_cvt_pk_bf16_f32 v127, v118, v119
    s_mov_b32 s58, 65536
    buffer_store_dwordx2 v[126:127], v124, s[28:31], s58 offen offset:96
    v_cvt_pk_bf16_f32 v126, v120, v121
    v_cvt_pk_bf16_f32 v127, v122, v123
    s_mov_b32 s58, 131072
    buffer_store_dwordx2 v[126:127], v124, s[28:31], s58 offen offset:96
L_hid_kernel_end:
    s_endpgm
.globl seq_kernel
.p2align 8
.type seq_kernel,@function
seq_kernel:
    s_cmp_ge_u32 s2, 256
    s_cbranch_scc1 L_seq_kernel_end
    s_load_dwordx16 s[4:19], s[0:1], 0
    s_load_dwordx8 s[20:27], s[0:1], 64
    v_lshrrev_b32 v1, 6, v0
    s_nop 0
    v_readfirstlane_b32 s36, v1
    v_and_b32 v1, 63, v0
    s_and_b32 s39, s36, 3
    s_lshl_b32 s37, s39, 10
    s_mov_b32 s42, s39
    s_mov_b32 s43, 0
    s_and_b32 s50, s2, 7
    s_lshr_b32 s51, s2, 3
    s_and_b32 s52, s51, 1
    s_lshl_b32 s50, s50, 1
    s_add_u32 s50, s50, s52
    s_lshr_b32 s52, s51, 1
    s_and_b32 s52, s52, 3
    s_lshr_b32 s55, s51, 3
    s_lshl_b32 s53, s50, 7
    s_mul_i32 s54, s52, 144
    s_waitcnt lgkmcnt(0)
    s_cmp_ge_u32 s36, 4
    s_cbranch_scc1 L_seq_kernel_loader
    v_and_b32 v180, 15, v1
    v_lshlrev_b32 v180, 7, v180
    v_lshrrev_b32 v181, 4, v1
    v_and_b32 v182, 7, v1
    v_xor_b32 v181, v181, v182
    v_lshl_add_u32 v183, v181, 4, v180
    v_xor_b32 v184, 64, v183
    s_mul_i32 s40, s42, 4096
    s_mul_i32 s41, s43, 18432
    s_add_u32 s41, s41, 16384
    v_add_u32 v11, s40, v183
    v_add_u32 v12, s40, v184
    v_add_u32 v13, s41, v183
    v_add_u32 v14, s41, v184
    v_mov_b32 v108, 0
    v_mov_b32 v109, 0
    v_mov_b32 v110, 0
    v_mov_b32 v111, 0
    v_mov_b32 v112, 0
    v_mov_b32 v113, 0
    v_mov_b32 v114, 0
    v_mov_b32 v115, 0
    v_mov_b32 v116, 0
    v_mov_b32 v117, 0
    v_mov_b32 v118, 0
    v_mov_b32 v119, 0
    v_mov_b32 v120, 0
    v_mov_b32 v121, 0
    v_mov_b32 v122, 0
    v_mov_b32 v123, 0
    v_mov_b32 v124, 0
    v_mov_b32 v125, 0
    v_mov_b32 v126, 0
    v_mov_b32 v127, 0
    v_mov_b32 v128, 0
    v_mov_b32 v129, 0
    v_mov_b32 v130, 0
    v_mov_b32 v131, 0
    v_mov_b32 v132, 0
    v_mov_b32 v133, 0
    v_mov_b32 v134, 0
    v_mov_b32 v135, 0
    v_mov_b32 v136, 0
    v_mov_b32 v137, 0
    v_mov_b32 v138, 0
    v_mov_b32 v139, 0
    v_mov_b32 v140, 0
    v_mov_b32 v141, 0
    v_mov_b32 v142, 0
    v_mov_b32 v143, 0
    v_mov_b32 v144, 0
    v_mov_b32 v145, 0
    v_mov_b32 v146, 0
    v_mov_b32 v147, 0
    v_mov_b32 v148, 0
    v_mov_b32 v149, 0
    v_mov_b32 v150, 0
    v_mov_b32 v151, 0
    v_mov_b32 v152, 0
    v_mov_b32 v153, 0
    v_mov_b32 v154, 0
    v_mov_b32 v155, 0
    v_mov_b32 v156, 0
    v_mov_b32 v157, 0
    v_mov_b32 v158, 0
    v_mov_b32 v159, 0
    v_mov_b32 v160, 0
    v_mov_b32 v161, 0
    v_mov_b32 v162, 0
    v_mov_b32 v163, 0
    v_mov_b32 v164, 0
    v_mov_b32 v165, 0
    v_mov_b32 v166, 0
    v_mov_b32 v167, 0
    v_mov_b32 v168, 0
    v_mov_b32 v169, 0
    v_mov_b32 v170, 0
    v_mov_b32 v171, 0
    v_mov_b32 v172, 0
    v_mov_b32 v173, 0
    v_mov_b32 v174, 0
    v_mov_b32 v175, 0
    v_mov_b32 v176, 0
    v_mov_b32 v177, 0
    v_mov_b32 v178, 0
    v_mov_b32 v179, 0
    s_mov_b32 s49, 4
L_seq_kernel_cp_loop:
    s_barrier
    ds_read_b128 v[20:23], v11 offset:0
    ds_read_b128 v[28:31], v11 offset:2048
    ds_read_b128 v[36:39], v13 offset:0
    ds_read_b128 v[44:47], v13 offset:2048
    ds_read_b128 v[52:55], v13 offset:4096
    ds_read_b128 v[60:63], v13 offset:6144
    ds_read_b128 v[68:71], v13 offset:8192
    ds_read_b128 v[76:79], v13 offset:10240
    ds_read_b128 v[84:87], v13 offset:12288
    ds_read_b128 v[92:95], v13 offset:14336
    ds_read_b128 v[100:103], v13 offset:16384
    ds_read_b128 v[24:27], v12 offset:0
    ds_read_b128 v[32:35], v12 offset:2048
    ds_read_b128 v[40:43], v14 offset:0
    ds_read_b128 v[48:51], v14 offset:2048
    ds_read_b128 v[56:59], v14 offset:4096
    ds_read_b128 v[64:67], v14 offset:6144
    ds_read_b128 v[72:75], v14 offset:8192
    ds_read_b128 v[80:83], v14 offset:10240
    ds_read_b128 v[88:91], v14 offset:12288
    ds_read_b128 v[96:99], v14 offset:14336
    ds_read_b128 v[104:107], v14 offset:16384
    s_waitcnt lgkmcnt(11)
    v_mfma_f32_16x16x32_bf16 v[108:111], v[20:23], v[36:39], v[108:111]
    v_mfma_f32_16x16x32_bf16 v[112:115], v[20:23], v[44:47], v[112:115]
    v_mfma_f32_16x16x32_bf16 v[116:119], v[20:23], v[52:55], v[116:119]
    v_mfma_f32_16x16x32_bf16 v[120:123], v[20:23], v[60:63], v[120:123]
    v_mfma_f32_16x16x32_bf16 v[124:127], v[20:23], v[68:71], v[124:127]
    v_mfma_f32_16x16x32_bf16 v[128:131], v[20:23], v[76:79], v[128:131]
    v_mfma_f32_16x16x32_bf16 v[132:135], v[20:23], v[84:87], v[132:135]
    v_mfma_f32_16x16x32_bf16 v[136:139], v[20:23], v[92:95], v[136:139]
    v_mfma_f32_16x16x32_bf16 v[140:143], v[20:23], v[100:103], v[140:143]
    v_mfma_f32_16x16x32_bf16 v[144:147], v[28:31], v[36:39], v[144:147]
    v_mfma_f32_16x16x32_bf16 v[148:151], v[28:31], v[44:47], v[148:151]
    v_mfma_f32_16x16x32_bf16 v[152:155], v[28:31], v[52:55], v[152:155]
    v_mfma_f32_16x16x32_bf16 v[156:159], v[28:31], v[60:63], v[156:159]
    v_mfma_f32_16x16x32_bf16 v[160:163], v[28:31], v[68:71], v[160:163]
    v_mfma_f32_16x16x32_bf16 v[164:167], v[28:31], v[76:79], v[164:167]
    v_mfma_f32_16x16x32_bf16 v[168:171], v[28:31], v[84:87], v[168:171]
    v_mfma_f32_16x16x32_bf16 v[172:175], v[28:31], v[92:95], v[172:175]
    v_mfma_f32_16x16x32_bf16 v[176:179], v[28:31], v[100:103], v[176:179]
    s_waitcnt lgkmcnt(0)
    v_mfma_f32_16x16x32_bf16 v[108:111], v[24:27], v[40:43], v[108:111]
    v_mfma_f32_16x16x32_bf16 v[112:115], v[24:27], v[48:51], v[112:115]
    v_mfma_f32_16x16x32_bf16 v[116:119], v[24:27], v[56:59], v[116:119]
    v_mfma_f32_16x16x32_bf16 v[120:123], v[24:27], v[64:67], v[120:123]
    v_mfma_f32_16x16x32_bf16 v[124:127], v[24:27], v[72:75], v[124:127]
    v_mfma_f32_16x16x32_bf16 v[128:131], v[24:27], v[80:83], v[128:131]
    v_mfma_f32_16x16x32_bf16 v[132:135], v[24:27], v[88:91], v[132:135]
    v_mfma_f32_16x16x32_bf16 v[136:139], v[24:27], v[96:99], v[136:139]
    v_mfma_f32_16x16x32_bf16 v[140:143], v[24:27], v[104:107], v[140:143]
    v_mfma_f32_16x16x32_bf16 v[144:147], v[32:35], v[40:43], v[144:147]
    v_mfma_f32_16x16x32_bf16 v[148:151], v[32:35], v[48:51], v[148:151]
    v_mfma_f32_16x16x32_bf16 v[152:155], v[32:35], v[56:59], v[152:155]
    v_mfma_f32_16x16x32_bf16 v[156:159], v[32:35], v[64:67], v[156:159]
    v_mfma_f32_16x16x32_bf16 v[160:163], v[32:35], v[72:75], v[160:163]
    v_mfma_f32_16x16x32_bf16 v[164:167], v[32:35], v[80:83], v[164:167]
    v_mfma_f32_16x16x32_bf16 v[168:171], v[32:35], v[88:91], v[168:171]
    v_mfma_f32_16x16x32_bf16 v[172:175], v[32:35], v[96:99], v[172:175]
    v_mfma_f32_16x16x32_bf16 v[176:179], v[32:35], v[104:107], v[176:179]
    s_barrier
    v_add_u32 v15, 36864, v11
    v_add_u32 v16, 36864, v12
    v_add_u32 v17, 36864, v13
    v_add_u32 v18, 36864, v14
    ds_read_b128 v[20:23], v15 offset:0
    ds_read_b128 v[28:31], v15 offset:2048
    ds_read_b128 v[36:39], v17 offset:0
    ds_read_b128 v[44:47], v17 offset:2048
    ds_read_b128 v[52:55], v17 offset:4096
    ds_read_b128 v[60:63], v17 offset:6144
    ds_read_b128 v[68:71], v17 offset:8192
    ds_read_b128 v[76:79], v17 offset:10240
    ds_read_b128 v[84:87], v17 offset:12288
    ds_read_b128 v[92:95], v17 offset:14336
    ds_read_b128 v[100:103], v17 offset:16384
    ds_read_b128 v[24:27], v16 offset:0
    ds_read_b128 v[32:35], v16 offset:2048
    ds_read_b128 v[40:43], v18 offset:0
    ds_read_b128 v[48:51], v18 offset:2048
    ds_read_b128 v[56:59], v18 offset:4096
    ds_read_b128 v[64:67], v18 offset:6144
    ds_read_b128 v[72:75], v18 offset:8192
    ds_read_b128 v[80:83], v18 offset:10240
    ds_read_b128 v[88:91], v18 offset:12288
    ds_read_b128 v[96:99], v18 offset:14336
    ds_read_b128 v[104:107], v18 offset:16384
    s_waitcnt lgkmcnt(11)
    v_mfma_f32_16x16x32_bf16 v[108:111], v[20:23], v[36:39], v[108:111]
    v_mfma_f32_16x16x32_bf16 v[112:115], v[20:23], v[44:47], v[112:115]
    v_mfma_f32_16x16x32_bf16 v[116:119], v[20:23], v[52:55], v[116:119]
    v_mfma_f32_16x16x32_bf16 v[120:123], v[20:23], v[60:63], v[120:123]
    v_mfma_f32_16x16x32_bf16 v[124:127], v[20:23], v[68:71], v[124:127]
    v_mfma_f32_16x16x32_bf16 v[128:131], v[20:23], v[76:79], v[128:131]
    v_mfma_f32_16x16x32_bf16 v[132:135], v[20:23], v[84:87], v[132:135]
    v_mfma_f32_16x16x32_bf16 v[136:139], v[20:23], v[92:95], v[136:139]
    v_mfma_f32_16x16x32_bf16 v[140:143], v[20:23], v[100:103], v[140:143]
    v_mfma_f32_16x16x32_bf16 v[144:147], v[28:31], v[36:39], v[144:147]
    v_mfma_f32_16x16x32_bf16 v[148:151], v[28:31], v[44:47], v[148:151]
    v_mfma_f32_16x16x32_bf16 v[152:155], v[28:31], v[52:55], v[152:155]
    v_mfma_f32_16x16x32_bf16 v[156:159], v[28:31], v[60:63], v[156:159]
    v_mfma_f32_16x16x32_bf16 v[160:163], v[28:31], v[68:71], v[160:163]
    v_mfma_f32_16x16x32_bf16 v[164:167], v[28:31], v[76:79], v[164:167]
    v_mfma_f32_16x16x32_bf16 v[168:171], v[28:31], v[84:87], v[168:171]
    v_mfma_f32_16x16x32_bf16 v[172:175], v[28:31], v[92:95], v[172:175]
    v_mfma_f32_16x16x32_bf16 v[176:179], v[28:31], v[100:103], v[176:179]
    s_waitcnt lgkmcnt(0)
    v_mfma_f32_16x16x32_bf16 v[108:111], v[24:27], v[40:43], v[108:111]
    v_mfma_f32_16x16x32_bf16 v[112:115], v[24:27], v[48:51], v[112:115]
    v_mfma_f32_16x16x32_bf16 v[116:119], v[24:27], v[56:59], v[116:119]
    v_mfma_f32_16x16x32_bf16 v[120:123], v[24:27], v[64:67], v[120:123]
    v_mfma_f32_16x16x32_bf16 v[124:127], v[24:27], v[72:75], v[124:127]
    v_mfma_f32_16x16x32_bf16 v[128:131], v[24:27], v[80:83], v[128:131]
    v_mfma_f32_16x16x32_bf16 v[132:135], v[24:27], v[88:91], v[132:135]
    v_mfma_f32_16x16x32_bf16 v[136:139], v[24:27], v[96:99], v[136:139]
    v_mfma_f32_16x16x32_bf16 v[140:143], v[24:27], v[104:107], v[140:143]
    v_mfma_f32_16x16x32_bf16 v[144:147], v[32:35], v[40:43], v[144:147]
    v_mfma_f32_16x16x32_bf16 v[148:151], v[32:35], v[48:51], v[148:151]
    v_mfma_f32_16x16x32_bf16 v[152:155], v[32:35], v[56:59], v[152:155]
    v_mfma_f32_16x16x32_bf16 v[156:159], v[32:35], v[64:67], v[156:159]
    v_mfma_f32_16x16x32_bf16 v[160:163], v[32:35], v[72:75], v[160:163]
    v_mfma_f32_16x16x32_bf16 v[164:167], v[32:35], v[80:83], v[164:167]
    v_mfma_f32_16x16x32_bf16 v[168:171], v[32:35], v[88:91], v[168:171]
    v_mfma_f32_16x16x32_bf16 v[172:175], v[32:35], v[96:99], v[172:175]
    v_mfma_f32_16x16x32_bf16 v[176:179], v[32:35], v[104:107], v[176:179]
    s_barrier
    v_add_u32 v15, 73728, v11
    v_add_u32 v16, 73728, v12
    v_add_u32 v17, 73728, v13
    v_add_u32 v18, 73728, v14
    ds_read_b128 v[20:23], v15 offset:0
    ds_read_b128 v[28:31], v15 offset:2048
    ds_read_b128 v[36:39], v17 offset:0
    ds_read_b128 v[44:47], v17 offset:2048
    ds_read_b128 v[52:55], v17 offset:4096
    ds_read_b128 v[60:63], v17 offset:6144
    ds_read_b128 v[68:71], v17 offset:8192
    ds_read_b128 v[76:79], v17 offset:10240
    ds_read_b128 v[84:87], v17 offset:12288
    ds_read_b128 v[92:95], v17 offset:14336
    ds_read_b128 v[100:103], v17 offset:16384
    ds_read_b128 v[24:27], v16 offset:0
    ds_read_b128 v[32:35], v16 offset:2048
    ds_read_b128 v[40:43], v18 offset:0
    ds_read_b128 v[48:51], v18 offset:2048
    ds_read_b128 v[56:59], v18 offset:4096
    ds_read_b128 v[64:67], v18 offset:6144
    ds_read_b128 v[72:75], v18 offset:8192
    ds_read_b128 v[80:83], v18 offset:10240
    ds_read_b128 v[88:91], v18 offset:12288
    ds_read_b128 v[96:99], v18 offset:14336
    ds_read_b128 v[104:107], v18 offset:16384
    s_waitcnt lgkmcnt(11)
    v_mfma_f32_16x16x32_bf16 v[108:111], v[20:23], v[36:39], v[108:111]
    v_mfma_f32_16x16x32_bf16 v[112:115], v[20:23], v[44:47], v[112:115]
    v_mfma_f32_16x16x32_bf16 v[116:119], v[20:23], v[52:55], v[116:119]
    v_mfma_f32_16x16x32_bf16 v[120:123], v[20:23], v[60:63], v[120:123]
    v_mfma_f32_16x16x32_bf16 v[124:127], v[20:23], v[68:71], v[124:127]
    v_mfma_f32_16x16x32_bf16 v[128:131], v[20:23], v[76:79], v[128:131]
    v_mfma_f32_16x16x32_bf16 v[132:135], v[20:23], v[84:87], v[132:135]
    v_mfma_f32_16x16x32_bf16 v[136:139], v[20:23], v[92:95], v[136:139]
    v_mfma_f32_16x16x32_bf16 v[140:143], v[20:23], v[100:103], v[140:143]
    v_mfma_f32_16x16x32_bf16 v[144:147], v[28:31], v[36:39], v[144:147]
    v_mfma_f32_16x16x32_bf16 v[148:151], v[28:31], v[44:47], v[148:151]
    v_mfma_f32_16x16x32_bf16 v[152:155], v[28:31], v[52:55], v[152:155]
    v_mfma_f32_16x16x32_bf16 v[156:159], v[28:31], v[60:63], v[156:159]
    v_mfma_f32_16x16x32_bf16 v[160:163], v[28:31], v[68:71], v[160:163]
    v_mfma_f32_16x16x32_bf16 v[164:167], v[28:31], v[76:79], v[164:167]
    v_mfma_f32_16x16x32_bf16 v[168:171], v[28:31], v[84:87], v[168:171]
    v_mfma_f32_16x16x32_bf16 v[172:175], v[28:31], v[92:95], v[172:175]
    v_mfma_f32_16x16x32_bf16 v[176:179], v[28:31], v[100:103], v[176:179]
    s_waitcnt lgkmcnt(0)
    v_mfma_f32_16x16x32_bf16 v[108:111], v[24:27], v[40:43], v[108:111]
    v_mfma_f32_16x16x32_bf16 v[112:115], v[24:27], v[48:51], v[112:115]
    v_mfma_f32_16x16x32_bf16 v[116:119], v[24:27], v[56:59], v[116:119]
    v_mfma_f32_16x16x32_bf16 v[120:123], v[24:27], v[64:67], v[120:123]
    v_mfma_f32_16x16x32_bf16 v[124:127], v[24:27], v[72:75], v[124:127]
    v_mfma_f32_16x16x32_bf16 v[128:131], v[24:27], v[80:83], v[128:131]
    v_mfma_f32_16x16x32_bf16 v[132:135], v[24:27], v[88:91], v[132:135]
    v_mfma_f32_16x16x32_bf16 v[136:139], v[24:27], v[96:99], v[136:139]
    v_mfma_f32_16x16x32_bf16 v[140:143], v[24:27], v[104:107], v[140:143]
    v_mfma_f32_16x16x32_bf16 v[144:147], v[32:35], v[40:43], v[144:147]
    v_mfma_f32_16x16x32_bf16 v[148:151], v[32:35], v[48:51], v[148:151]
    v_mfma_f32_16x16x32_bf16 v[152:155], v[32:35], v[56:59], v[152:155]
    v_mfma_f32_16x16x32_bf16 v[156:159], v[32:35], v[64:67], v[156:159]
    v_mfma_f32_16x16x32_bf16 v[160:163], v[32:35], v[72:75], v[160:163]
    v_mfma_f32_16x16x32_bf16 v[164:167], v[32:35], v[80:83], v[164:167]
    v_mfma_f32_16x16x32_bf16 v[168:171], v[32:35], v[88:91], v[168:171]
    v_mfma_f32_16x16x32_bf16 v[172:175], v[32:35], v[96:99], v[172:175]
    v_mfma_f32_16x16x32_bf16 v[176:179], v[32:35], v[104:107], v[176:179]
    s_sub_u32 s49, s49, 1
    s_cmp_lg_u32 s49, 0
    s_cbranch_scc1 L_seq_kernel_cp_loop
    s_barrier
    ds_read_b128 v[20:23], v11 offset:0
    ds_read_b128 v[28:31], v11 offset:2048
    ds_read_b128 v[36:39], v13 offset:0
    ds_read_b128 v[44:47], v13 offset:2048
    ds_read_b128 v[52:55], v13 offset:4096
    ds_read_b128 v[60:63], v13 offset:6144
    ds_read_b128 v[68:71], v13 offset:8192
    ds_read_b128 v[76:79], v13 offset:10240
    ds_read_b128 v[84:87], v13 offset:12288
    ds_read_b128 v[92:95], v13 offset:14336
    ds_read_b128 v[100:103], v13 offset:16384
    ds_read_b128 v[24:27], v12 offset:0
    ds_read_b128 v[32:35], v12 offset:2048
    ds_read_b128 v[40:43], v14 offset:0
    ds_read_b128 v[48:51], v14 offset:2048
    ds_read_b128 v[56:59], v14 offset:4096
    ds_read_b128 v[64:67], v14 offset:6144
    ds_read_b128 v[72:75], v14 offset:8192
    ds_read_b128 v[80:83], v14 offset:10240
    ds_read_b128 v[88:91], v14 offset:12288
    ds_read_b128 v[96:99], v14 offset:14336
    ds_read_b128 v[104:107], v14 offset:16384
    s_waitcnt lgkmcnt(11)
    v_mfma_f32_16x16x32_bf16 v[108:111], v[20:23], v[36:39], v[108:111]
    v_mfma_f32_16x16x32_bf16 v[112:115], v[20:23], v[44:47], v[112:115]
    v_mfma_f32_16x16x32_bf16 v[116:119], v[20:23], v[52:55], v[116:119]
    v_mfma_f32_16x16x32_bf16 v[120:123], v[20:23], v[60:63], v[120:123]
    v_mfma_f32_16x16x32_bf16 v[124:127], v[20:23], v[68:71], v[124:127]
    v_mfma_f32_16x16x32_bf16 v[128:131], v[20:23], v[76:79], v[128:131]
    v_mfma_f32_16x16x32_bf16 v[132:135], v[20:23], v[84:87], v[132:135]
    v_mfma_f32_16x16x32_bf16 v[136:139], v[20:23], v[92:95], v[136:139]
    v_mfma_f32_16x16x32_bf16 v[140:143], v[20:23], v[100:103], v[140:143]
    v_mfma_f32_16x16x32_bf16 v[144:147], v[28:31], v[36:39], v[144:147]
    v_mfma_f32_16x16x32_bf16 v[148:151], v[28:31], v[44:47], v[148:151]
    v_mfma_f32_16x16x32_bf16 v[152:155], v[28:31], v[52:55], v[152:155]
    v_mfma_f32_16x16x32_bf16 v[156:159], v[28:31], v[60:63], v[156:159]
    v_mfma_f32_16x16x32_bf16 v[160:163], v[28:31], v[68:71], v[160:163]
    v_mfma_f32_16x16x32_bf16 v[164:167], v[28:31], v[76:79], v[164:167]
    v_mfma_f32_16x16x32_bf16 v[168:171], v[28:31], v[84:87], v[168:171]
    v_mfma_f32_16x16x32_bf16 v[172:175], v[28:31], v[92:95], v[172:175]
    v_mfma_f32_16x16x32_bf16 v[176:179], v[28:31], v[100:103], v[176:179]
    s_waitcnt lgkmcnt(0)
    v_mfma_f32_16x16x32_bf16 v[108:111], v[24:27], v[40:43], v[108:111]
    v_mfma_f32_16x16x32_bf16 v[112:115], v[24:27], v[48:51], v[112:115]
    v_mfma_f32_16x16x32_bf16 v[116:119], v[24:27], v[56:59], v[116:119]
    v_mfma_f32_16x16x32_bf16 v[120:123], v[24:27], v[64:67], v[120:123]
    v_mfma_f32_16x16x32_bf16 v[124:127], v[24:27], v[72:75], v[124:127]
    v_mfma_f32_16x16x32_bf16 v[128:131], v[24:27], v[80:83], v[128:131]
    v_mfma_f32_16x16x32_bf16 v[132:135], v[24:27], v[88:91], v[132:135]
    v_mfma_f32_16x16x32_bf16 v[136:139], v[24:27], v[96:99], v[136:139]
    v_mfma_f32_16x16x32_bf16 v[140:143], v[24:27], v[104:107], v[140:143]
    v_mfma_f32_16x16x32_bf16 v[144:147], v[32:35], v[40:43], v[144:147]
    v_mfma_f32_16x16x32_bf16 v[148:151], v[32:35], v[48:51], v[148:151]
    v_mfma_f32_16x16x32_bf16 v[152:155], v[32:35], v[56:59], v[152:155]
    v_mfma_f32_16x16x32_bf16 v[156:159], v[32:35], v[64:67], v[156:159]
    v_mfma_f32_16x16x32_bf16 v[160:163], v[32:35], v[72:75], v[160:163]
    v_mfma_f32_16x16x32_bf16 v[164:167], v[32:35], v[80:83], v[164:167]
    v_mfma_f32_16x16x32_bf16 v[168:171], v[32:35], v[88:91], v[168:171]
    v_mfma_f32_16x16x32_bf16 v[172:175], v[32:35], v[96:99], v[172:175]
    v_mfma_f32_16x16x32_bf16 v[176:179], v[32:35], v[104:107], v[176:179]
    s_barrier
    v_add_u32 v15, 36864, v11
    v_add_u32 v16, 36864, v12
    v_add_u32 v17, 36864, v13
    v_add_u32 v18, 36864, v14
    ds_read_b128 v[20:23], v15 offset:0
    ds_read_b128 v[28:31], v15 offset:2048
    ds_read_b128 v[36:39], v17 offset:0
    ds_read_b128 v[44:47], v17 offset:2048
    ds_read_b128 v[52:55], v17 offset:4096
    ds_read_b128 v[60:63], v17 offset:6144
    ds_read_b128 v[68:71], v17 offset:8192
    ds_read_b128 v[76:79], v17 offset:10240
    ds_read_b128 v[84:87], v17 offset:12288
    ds_read_b128 v[92:95], v17 offset:14336
    ds_read_b128 v[100:103], v17 offset:16384
    ds_read_b128 v[24:27], v16 offset:0
    ds_read_b128 v[32:35], v16 offset:2048
    ds_read_b128 v[40:43], v18 offset:0
    ds_read_b128 v[48:51], v18 offset:2048
    ds_read_b128 v[56:59], v18 offset:4096
    ds_read_b128 v[64:67], v18 offset:6144
    ds_read_b128 v[72:75], v18 offset:8192
    ds_read_b128 v[80:83], v18 offset:10240
    ds_read_b128 v[88:91], v18 offset:12288
    ds_read_b128 v[96:99], v18 offset:14336
    ds_read_b128 v[104:107], v18 offset:16384
    s_waitcnt lgkmcnt(11)
    v_mfma_f32_16x16x32_bf16 v[108:111], v[20:23], v[36:39], v[108:111]
    v_mfma_f32_16x16x32_bf16 v[112:115], v[20:23], v[44:47], v[112:115]
    v_mfma_f32_16x16x32_bf16 v[116:119], v[20:23], v[52:55], v[116:119]
    v_mfma_f32_16x16x32_bf16 v[120:123], v[20:23], v[60:63], v[120:123]
    v_mfma_f32_16x16x32_bf16 v[124:127], v[20:23], v[68:71], v[124:127]
    v_mfma_f32_16x16x32_bf16 v[128:131], v[20:23], v[76:79], v[128:131]
    v_mfma_f32_16x16x32_bf16 v[132:135], v[20:23], v[84:87], v[132:135]
    v_mfma_f32_16x16x32_bf16 v[136:139], v[20:23], v[92:95], v[136:139]
    v_mfma_f32_16x16x32_bf16 v[140:143], v[20:23], v[100:103], v[140:143]
    v_mfma_f32_16x16x32_bf16 v[144:147], v[28:31], v[36:39], v[144:147]
    v_mfma_f32_16x16x32_bf16 v[148:151], v[28:31], v[44:47], v[148:151]
    v_mfma_f32_16x16x32_bf16 v[152:155], v[28:31], v[52:55], v[152:155]
    v_mfma_f32_16x16x32_bf16 v[156:159], v[28:31], v[60:63], v[156:159]
    v_mfma_f32_16x16x32_bf16 v[160:163], v[28:31], v[68:71], v[160:163]
    v_mfma_f32_16x16x32_bf16 v[164:167], v[28:31], v[76:79], v[164:167]
    v_mfma_f32_16x16x32_bf16 v[168:171], v[28:31], v[84:87], v[168:171]
    v_mfma_f32_16x16x32_bf16 v[172:175], v[28:31], v[92:95], v[172:175]
    v_mfma_f32_16x16x32_bf16 v[176:179], v[28:31], v[100:103], v[176:179]
    s_waitcnt lgkmcnt(0)
    v_mfma_f32_16x16x32_bf16 v[108:111], v[24:27], v[40:43], v[108:111]
    v_mfma_f32_16x16x32_bf16 v[112:115], v[24:27], v[48:51], v[112:115]
    v_mfma_f32_16x16x32_bf16 v[116:119], v[24:27], v[56:59], v[116:119]
    v_mfma_f32_16x16x32_bf16 v[120:123], v[24:27], v[64:67], v[120:123]
    v_mfma_f32_16x16x32_bf16 v[124:127], v[24:27], v[72:75], v[124:127]
    v_mfma_f32_16x16x32_bf16 v[128:131], v[24:27], v[80:83], v[128:131]
    v_mfma_f32_16x16x32_bf16 v[132:135], v[24:27], v[88:91], v[132:135]
    v_mfma_f32_16x16x32_bf16 v[136:139], v[24:27], v[96:99], v[136:139]
    v_mfma_f32_16x16x32_bf16 v[140:143], v[24:27], v[104:107], v[140:143]
    v_mfma_f32_16x16x32_bf16 v[144:147], v[32:35], v[40:43], v[144:147]
    v_mfma_f32_16x16x32_bf16 v[148:151], v[32:35], v[48:51], v[148:151]
    v_mfma_f32_16x16x32_bf16 v[152:155], v[32:35], v[56:59], v[152:155]
    v_mfma_f32_16x16x32_bf16 v[156:159], v[32:35], v[64:67], v[156:159]
    v_mfma_f32_16x16x32_bf16 v[160:163], v[32:35], v[72:75], v[160:163]
    v_mfma_f32_16x16x32_bf16 v[164:167], v[32:35], v[80:83], v[164:167]
    v_mfma_f32_16x16x32_bf16 v[168:171], v[32:35], v[88:91], v[168:171]
    v_mfma_f32_16x16x32_bf16 v[172:175], v[32:35], v[96:99], v[172:175]
    v_mfma_f32_16x16x32_bf16 v[176:179], v[32:35], v[104:107], v[176:179]
    s_barrier
    v_add_u32 v15, 73728, v11
    v_add_u32 v16, 73728, v12
    v_add_u32 v17, 73728, v13
    v_add_u32 v18, 73728, v14
    ds_read_b128 v[20:23], v15 offset:0
    ds_read_b128 v[28:31], v15 offset:2048
    ds_read_b128 v[36:39], v17 offset:0
    ds_read_b128 v[44:47], v17 offset:2048
    ds_read_b128 v[52:55], v17 offset:4096
    ds_read_b128 v[60:63], v17 offset:6144
    ds_read_b128 v[68:71], v17 offset:8192
    ds_read_b128 v[76:79], v17 offset:10240
    ds_read_b128 v[84:87], v17 offset:12288
    ds_read_b128 v[92:95], v17 offset:14336
    ds_read_b128 v[100:103], v17 offset:16384
    ds_read_b128 v[24:27], v16 offset:0
    ds_read_b128 v[32:35], v16 offset:2048
    ds_read_b128 v[40:43], v18 offset:0
    ds_read_b128 v[48:51], v18 offset:2048
    ds_read_b128 v[56:59], v18 offset:4096
    ds_read_b128 v[64:67], v18 offset:6144
    ds_read_b128 v[72:75], v18 offset:8192
    ds_read_b128 v[80:83], v18 offset:10240
    ds_read_b128 v[88:91], v18 offset:12288
    ds_read_b128 v[96:99], v18 offset:14336
    ds_read_b128 v[104:107], v18 offset:16384
    s_waitcnt lgkmcnt(11)
    v_mfma_f32_16x16x32_bf16 v[108:111], v[20:23], v[36:39], v[108:111]
    v_mfma_f32_16x16x32_bf16 v[112:115], v[20:23], v[44:47], v[112:115]
    v_mfma_f32_16x16x32_bf16 v[116:119], v[20:23], v[52:55], v[116:119]
    v_mfma_f32_16x16x32_bf16 v[120:123], v[20:23], v[60:63], v[120:123]
    v_mfma_f32_16x16x32_bf16 v[124:127], v[20:23], v[68:71], v[124:127]
    v_mfma_f32_16x16x32_bf16 v[128:131], v[20:23], v[76:79], v[128:131]
    v_mfma_f32_16x16x32_bf16 v[132:135], v[20:23], v[84:87], v[132:135]
    v_mfma_f32_16x16x32_bf16 v[136:139], v[20:23], v[92:95], v[136:139]
    v_mfma_f32_16x16x32_bf16 v[140:143], v[20:23], v[100:103], v[140:143]
    v_mfma_f32_16x16x32_bf16 v[144:147], v[28:31], v[36:39], v[144:147]
    v_mfma_f32_16x16x32_bf16 v[148:151], v[28:31], v[44:47], v[148:151]
    v_mfma_f32_16x16x32_bf16 v[152:155], v[28:31], v[52:55], v[152:155]
    v_mfma_f32_16x16x32_bf16 v[156:159], v[28:31], v[60:63], v[156:159]
    v_mfma_f32_16x16x32_bf16 v[160:163], v[28:31], v[68:71], v[160:163]
    v_mfma_f32_16x16x32_bf16 v[164:167], v[28:31], v[76:79], v[164:167]
    v_mfma_f32_16x16x32_bf16 v[168:171], v[28:31], v[84:87], v[168:171]
    v_mfma_f32_16x16x32_bf16 v[172:175], v[28:31], v[92:95], v[172:175]
    v_mfma_f32_16x16x32_bf16 v[176:179], v[28:31], v[100:103], v[176:179]
    s_waitcnt lgkmcnt(0)
    v_mfma_f32_16x16x32_bf16 v[108:111], v[24:27], v[40:43], v[108:111]
    v_mfma_f32_16x16x32_bf16 v[112:115], v[24:27], v[48:51], v[112:115]
    v_mfma_f32_16x16x32_bf16 v[116:119], v[24:27], v[56:59], v[116:119]
    v_mfma_f32_16x16x32_bf16 v[120:123], v[24:27], v[64:67], v[120:123]
    v_mfma_f32_16x16x32_bf16 v[124:127], v[24:27], v[72:75], v[124:127]
    v_mfma_f32_16x16x32_bf16 v[128:131], v[24:27], v[80:83], v[128:131]
    v_mfma_f32_16x16x32_bf16 v[132:135], v[24:27], v[88:91], v[132:135]
    v_mfma_f32_16x16x32_bf16 v[136:139], v[24:27], v[96:99], v[136:139]
    v_mfma_f32_16x16x32_bf16 v[140:143], v[24:27], v[104:107], v[140:143]
    v_mfma_f32_16x16x32_bf16 v[144:147], v[32:35], v[40:43], v[144:147]
    v_mfma_f32_16x16x32_bf16 v[148:151], v[32:35], v[48:51], v[148:151]
    v_mfma_f32_16x16x32_bf16 v[152:155], v[32:35], v[56:59], v[152:155]
    v_mfma_f32_16x16x32_bf16 v[156:159], v[32:35], v[64:67], v[156:159]
    v_mfma_f32_16x16x32_bf16 v[160:163], v[32:35], v[72:75], v[160:163]
    v_mfma_f32_16x16x32_bf16 v[164:167], v[32:35], v[80:83], v[164:167]
    v_mfma_f32_16x16x32_bf16 v[168:171], v[32:35], v[88:91], v[168:171]
    v_mfma_f32_16x16x32_bf16 v[172:175], v[32:35], v[96:99], v[172:175]
    v_mfma_f32_16x16x32_bf16 v[176:179], v[32:35], v[104:107], v[176:179]
    s_barrier
    ds_read_b128 v[20:23], v11 offset:0
    ds_read_b128 v[28:31], v11 offset:2048
    ds_read_b128 v[36:39], v13 offset:0
    ds_read_b128 v[44:47], v13 offset:2048
    ds_read_b128 v[52:55], v13 offset:4096
    ds_read_b128 v[60:63], v13 offset:6144
    ds_read_b128 v[68:71], v13 offset:8192
    ds_read_b128 v[76:79], v13 offset:10240
    ds_read_b128 v[84:87], v13 offset:12288
    ds_read_b128 v[92:95], v13 offset:14336
    ds_read_b128 v[100:103], v13 offset:16384
    ds_read_b128 v[24:27], v12 offset:0
    ds_read_b128 v[32:35], v12 offset:2048
    ds_read_b128 v[40:43], v14 offset:0
    ds_read_b128 v[48:51], v14 offset:2048
    ds_read_b128 v[56:59], v14 offset:4096
    ds_read_b128 v[64:67], v14 offset:6144
    ds_read_b128 v[72:75], v14 offset:8192
    ds_read_b128 v[80:83], v14 offset:10240
    ds_read_b128 v[88:91], v14 offset:12288
    ds_read_b128 v[96:99], v14 offset:14336
    ds_read_b128 v[104:107], v14 offset:16384
    s_waitcnt lgkmcnt(11)
    v_mfma_f32_16x16x32_bf16 v[108:111], v[20:23], v[36:39], v[108:111]
    v_mfma_f32_16x16x32_bf16 v[112:115], v[20:23], v[44:47], v[112:115]
    v_mfma_f32_16x16x32_bf16 v[116:119], v[20:23], v[52:55], v[116:119]
    v_mfma_f32_16x16x32_bf16 v[120:123], v[20:23], v[60:63], v[120:123]
    v_mfma_f32_16x16x32_bf16 v[124:127], v[20:23], v[68:71], v[124:127]
    v_mfma_f32_16x16x32_bf16 v[128:131], v[20:23], v[76:79], v[128:131]
    v_mfma_f32_16x16x32_bf16 v[132:135], v[20:23], v[84:87], v[132:135]
    v_mfma_f32_16x16x32_bf16 v[136:139], v[20:23], v[92:95], v[136:139]
    v_mfma_f32_16x16x32_bf16 v[140:143], v[20:23], v[100:103], v[140:143]
    v_mfma_f32_16x16x32_bf16 v[144:147], v[28:31], v[36:39], v[144:147]
    v_mfma_f32_16x16x32_bf16 v[148:151], v[28:31], v[44:47], v[148:151]
    v_mfma_f32_16x16x32_bf16 v[152:155], v[28:31], v[52:55], v[152:155]
    v_mfma_f32_16x16x32_bf16 v[156:159], v[28:31], v[60:63], v[156:159]
    v_mfma_f32_16x16x32_bf16 v[160:163], v[28:31], v[68:71], v[160:163]
    v_mfma_f32_16x16x32_bf16 v[164:167], v[28:31], v[76:79], v[164:167]
    v_mfma_f32_16x16x32_bf16 v[168:171], v[28:31], v[84:87], v[168:171]
    v_mfma_f32_16x16x32_bf16 v[172:175], v[28:31], v[92:95], v[172:175]
    v_mfma_f32_16x16x32_bf16 v[176:179], v[28:31], v[100:103], v[176:179]
    s_waitcnt lgkmcnt(0)
    v_mfma_f32_16x16x32_bf16 v[108:111], v[24:27], v[40:43], v[108:111]
    v_mfma_f32_16x16x32_bf16 v[112:115], v[24:27], v[48:51], v[112:115]
    v_mfma_f32_16x16x32_bf16 v[116:119], v[24:27], v[56:59], v[116:119]
    v_mfma_f32_16x16x32_bf16 v[120:123], v[24:27], v[64:67], v[120:123]
    v_mfma_f32_16x16x32_bf16 v[124:127], v[24:27], v[72:75], v[124:127]
    v_mfma_f32_16x16x32_bf16 v[128:131], v[24:27], v[80:83], v[128:131]
    v_mfma_f32_16x16x32_bf16 v[132:135], v[24:27], v[88:91], v[132:135]
    v_mfma_f32_16x16x32_bf16 v[136:139], v[24:27], v[96:99], v[136:139]
    v_mfma_f32_16x16x32_bf16 v[140:143], v[24:27], v[104:107], v[140:143]
    v_mfma_f32_16x16x32_bf16 v[144:147], v[32:35], v[40:43], v[144:147]
    v_mfma_f32_16x16x32_bf16 v[148:151], v[32:35], v[48:51], v[148:151]
    v_mfma_f32_16x16x32_bf16 v[152:155], v[32:35], v[56:59], v[152:155]
    v_mfma_f32_16x16x32_bf16 v[156:159], v[32:35], v[64:67], v[156:159]
    v_mfma_f32_16x16x32_bf16 v[160:163], v[32:35], v[72:75], v[160:163]
    v_mfma_f32_16x16x32_bf16 v[164:167], v[32:35], v[80:83], v[164:167]
    v_mfma_f32_16x16x32_bf16 v[168:171], v[32:35], v[88:91], v[168:171]
    v_mfma_f32_16x16x32_bf16 v[172:175], v[32:35], v[96:99], v[172:175]
    v_mfma_f32_16x16x32_bf16 v[176:179], v[32:35], v[104:107], v[176:179]
    s_add_u32 s28, s26, 0x2078000
    s_addc_u32 s29, s27, 0
    s_and_b32 s29, s29, 0xffff
    s_mov_b32 s30, 0x1200000
    s_mov_b32 s31, 0x00020000
    s_mul_i32 s56, s42, 32
    s_add_u32 s56, s56, s53
    v_lshrrev_b32 v180, 4, v1
    v_lshlrev_b32 v180, 2, v180
    v_add_u32 v180, s56, v180
    s_movk_i32 s58, 576
    v_mul_lo_u32 v180, v180, s58
    v_and_b32 v181, 15, v1
    v_add_u32 v180, v180, v181
    v_add_u32 v180, s54, v180
    v_lshlrev_b32 v180, 2, v180
    s_mul_i32 s57, s55, 4718592
    s_add_u32 s58, s57, 0
    buffer_store_dword v108, v180, s[28:31], s58 offen offset:0
    buffer_store_dword v112, v180, s[28:31], s58 offen offset:64
    buffer_store_dword v116, v180, s[28:31], s58 offen offset:128
    buffer_store_dword v120, v180, s[28:31], s58 offen offset:192
    buffer_store_dword v124, v180, s[28:31], s58 offen offset:256
    buffer_store_dword v128, v180, s[28:31], s58 offen offset:320
    buffer_store_dword v132, v180, s[28:31], s58 offen offset:384
    buffer_store_dword v136, v180, s[28:31], s58 offen offset:448
    buffer_store_dword v140, v180, s[28:31], s58 offen offset:512
    s_add_u32 s58, s57, 2304
    buffer_store_dword v109, v180, s[28:31], s58 offen offset:0
    buffer_store_dword v113, v180, s[28:31], s58 offen offset:64
    buffer_store_dword v117, v180, s[28:31], s58 offen offset:128
    buffer_store_dword v121, v180, s[28:31], s58 offen offset:192
    buffer_store_dword v125, v180, s[28:31], s58 offen offset:256
    buffer_store_dword v129, v180, s[28:31], s58 offen offset:320
    buffer_store_dword v133, v180, s[28:31], s58 offen offset:384
    buffer_store_dword v137, v180, s[28:31], s58 offen offset:448
    buffer_store_dword v141, v180, s[28:31], s58 offen offset:512
    s_add_u32 s58, s57, 4608
    buffer_store_dword v110, v180, s[28:31], s58 offen offset:0
    buffer_store_dword v114, v180, s[28:31], s58 offen offset:64
    buffer_store_dword v118, v180, s[28:31], s58 offen offset:128
    buffer_store_dword v122, v180, s[28:31], s58 offen offset:192
    buffer_store_dword v126, v180, s[28:31], s58 offen offset:256
    buffer_store_dword v130, v180, s[28:31], s58 offen offset:320
    buffer_store_dword v134, v180, s[28:31], s58 offen offset:384
    buffer_store_dword v138, v180, s[28:31], s58 offen offset:448
    buffer_store_dword v142, v180, s[28:31], s58 offen offset:512
    s_add_u32 s58, s57, 6912
    buffer_store_dword v111, v180, s[28:31], s58 offen offset:0
    buffer_store_dword v115, v180, s[28:31], s58 offen offset:64
    buffer_store_dword v119, v180, s[28:31], s58 offen offset:128
    buffer_store_dword v123, v180, s[28:31], s58 offen offset:192
    buffer_store_dword v127, v180, s[28:31], s58 offen offset:256
    buffer_store_dword v131, v180, s[28:31], s58 offen offset:320
    buffer_store_dword v135, v180, s[28:31], s58 offen offset:384
    buffer_store_dword v139, v180, s[28:31], s58 offen offset:448
    buffer_store_dword v143, v180, s[28:31], s58 offen offset:512
    s_add_u32 s58, s57, 36864
    buffer_store_dword v144, v180, s[28:31], s58 offen offset:0
    buffer_store_dword v148, v180, s[28:31], s58 offen offset:64
    buffer_store_dword v152, v180, s[28:31], s58 offen offset:128
    buffer_store_dword v156, v180, s[28:31], s58 offen offset:192
    buffer_store_dword v160, v180, s[28:31], s58 offen offset:256
    buffer_store_dword v164, v180, s[28:31], s58 offen offset:320
    buffer_store_dword v168, v180, s[28:31], s58 offen offset:384
    buffer_store_dword v172, v180, s[28:31], s58 offen offset:448
    buffer_store_dword v176, v180, s[28:31], s58 offen offset:512
    s_add_u32 s58, s57, 39168
    buffer_store_dword v145, v180, s[28:31], s58 offen offset:0
    buffer_store_dword v149, v180, s[28:31], s58 offen offset:64
    buffer_store_dword v153, v180, s[28:31], s58 offen offset:128
    buffer_store_dword v157, v180, s[28:31], s58 offen offset:192
    buffer_store_dword v161, v180, s[28:31], s58 offen offset:256
    buffer_store_dword v165, v180, s[28:31], s58 offen offset:320
    buffer_store_dword v169, v180, s[28:31], s58 offen offset:384
    buffer_store_dword v173, v180, s[28:31], s58 offen offset:448
    buffer_store_dword v177, v180, s[28:31], s58 offen offset:512
    s_add_u32 s58, s57, 41472
    buffer_store_dword v146, v180, s[28:31], s58 offen offset:0
    buffer_store_dword v150, v180, s[28:31], s58 offen offset:64
    buffer_store_dword v154, v180, s[28:31], s58 offen offset:128
    buffer_store_dword v158, v180, s[28:31], s58 offen offset:192
    buffer_store_dword v162, v180, s[28:31], s58 offen offset:256
    buffer_store_dword v166, v180, s[28:31], s58 offen offset:320
    buffer_store_dword v170, v180, s[28:31], s58 offen offset:384
    buffer_store_dword v174, v180, s[28:31], s58 offen offset:448
    buffer_store_dword v178, v180, s[28:31], s58 offen offset:512
    s_add_u32 s58, s57, 43776
    buffer_store_dword v147, v180, s[28:31], s58 offen offset:0
    buffer_store_dword v151, v180, s[28:31], s58 offen offset:64
    buffer_store_dword v155, v180, s[28:31], s58 offen offset:128
    buffer_store_dword v159, v180, s[28:31], s58 offen offset:192
    buffer_store_dword v163, v180, s[28:31], s58 offen offset:256
    buffer_store_dword v167, v180, s[28:31], s58 offen offset:320
    buffer_store_dword v171, v180, s[28:31], s58 offen offset:384
    buffer_store_dword v175, v180, s[28:31], s58 offen offset:448
    buffer_store_dword v179, v180, s[28:31], s58 offen offset:512
    s_branch L_seq_kernel_end
L_seq_kernel_loader:
    s_cmp_ge_u32 s55, 2
    s_cselect_b32 s28, s16, s14
    s_cselect_b32 s29, s17, s15
    s_and_b32 s29, s29, 0xffff
    s_mov_b32 s30, 8388608
    s_mov_b32 s31, 0x00020000
    s_add_u32 s32, s26, 0x1bf8000
    s_addc_u32 s33, s27, 0
    s_and_b32 s33, s33, 0xffff
    s_mov_b32 s34, 0x480000
    s_mov_b32 s35, 0x00020000
    v_lshrrev_b32 v180, 3, v1
    v_and_b32 v181, 7, v1
    v_xor_b32 v181, v181, v180
    v_lshlrev_b32 v181, 4, v181
    s_lshl_b32 s44, s39, 3
    v_add_u32 v180, s44, v180
    s_mov_b32 s45, 4096
    s_mov_b32 s46, 4096
    v_add_u32 v182, 0, v180
    v_add_u32 v182, s53, v182
    v_mul_lo_u32 v182, v182, s45
    v_add_u32 v2, v182, v181
    v_add_u32 v182, 32, v180
    v_add_u32 v182, s53, v182
    v_mul_lo_u32 v182, v182, s45
    v_add_u32 v3, v182, v181
    v_add_u32 v182, 64, v180
    v_add_u32 v182, s53, v182
    v_mul_lo_u32 v182, v182, s45
    v_add_u32 v4, v182, v181
    v_add_u32 v182, 96, v180
    v_add_u32 v182, s53, v182
    v_mul_lo_u32 v182, v182, s45
    v_add_u32 v5, v182, v181
    v_add_u32 v182, 0, v180
    v_min_u32 v182, 143, v182
    v_add_u32 v182, s54, v182
    v_mul_lo_u32 v182, v182, s46
    v_add_u32 v6, v182, v181
    v_add_u32 v182, 32, v180
    v_min_u32 v182, 143, v182
    v_add_u32 v182, s54, v182
    v_mul_lo_u32 v182, v182, s46
    v_add_u32 v7, v182, v181
    v_add_u32 v182, 64, v180
    v_min_u32 v182, 143, v182
    v_add_u32 v182, s54, v182
    v_mul_lo_u32 v182, v182, s46
    v_add_u32 v8, v182, v181
    v_add_u32 v182, 96, v180
    v_min_u32 v182, 143, v182
    v_add_u32 v182, s54, v182
    v_mul_lo_u32 v182, v182, s46
    v_add_u32 v9, v182, v181
    v_add_u32 v182, 128, v180
    v_min_u32 v182, 143, v182
    v_add_u32 v182, s54, v182
    v_mul_lo_u32 v182, v182, s46
    v_add_u32 v10, v182, v181
    s_and_b32 s56, s55, 1
    s_lshl_b32 s47, s56, 11
    s_lshr_b32 s57, s55, 1
    s_mul_i32 s48, s57, 2359296
    s_add_u32 s48, s48, s47
    s_add_u32 m0, s37, 0
    s_nop 0
    buffer_load_dwordx4 v2, s[28:31], s47 offen lds
    s_add_u32 m0, s37, 4096
    s_nop 0
    buffer_load_dwordx4 v3, s[28:31], s47 offen lds
    s_add_u32 m0, s37, 8192
    s_nop 0
    buffer_load_dwordx4 v4, s[28:31], s47 offen lds
    s_add_u32 m0, s37, 12288
    s_nop 0
    buffer_load_dwordx4 v5, s[28:31], s47 offen lds
    s_add_u32 m0, s37, 16384
    s_nop 0
    buffer_load_dwordx4 v6, s[32:35], s48 offen lds
    s_add_u32 m0, s37, 20480
    s_nop 0
    buffer_load_dwordx4 v7, s[32:35], s48 offen lds
    s_add_u32 m0, s37, 24576
    s_nop 0
    buffer_load_dwordx4 v8, s[32:35], s48 offen lds
    s_add_u32 m0, s37, 28672
    s_nop 0
    buffer_load_dwordx4 v9, s[32:35], s48 offen lds
    s_add_u32 m0, s37, 32768
    s_nop 0
    buffer_load_dwordx4 v10, s[32:35], s48 offen lds
    s_add_u32 s47, s47, 128
    s_add_u32 s48, s48, 128
    s_add_u32 m0, s37, 36864
    s_nop 0
    buffer_load_dwordx4 v2, s[28:31], s47 offen lds
    s_add_u32 m0, s37, 40960
    s_nop 0
    buffer_load_dwordx4 v3, s[28:31], s47 offen lds
    s_add_u32 m0, s37, 45056
    s_nop 0
    buffer_load_dwordx4 v4, s[28:31], s47 offen lds
    s_add_u32 m0, s37, 49152
    s_nop 0
    buffer_load_dwordx4 v5, s[28:31], s47 offen lds
    s_add_u32 m0, s37, 53248
    s_nop 0
    buffer_load_dwordx4 v6, s[32:35], s48 offen lds
    s_add_u32 m0, s37, 57344
    s_nop 0
    buffer_load_dwordx4 v7, s[32:35], s48 offen lds
    s_add_u32 m0, s37, 61440
    s_nop 0
    buffer_load_dwordx4 v8, s[32:35], s48 offen lds
    s_add_u32 m0, s37, 65536
    s_nop 0
    buffer_load_dwordx4 v9, s[32:35], s48 offen lds
    s_add_u32 m0, s37, 69632
    s_nop 0
    buffer_load_dwordx4 v10, s[32:35], s48 offen lds
    s_add_u32 s47, s47, 128
    s_add_u32 s48, s48, 128
    s_mov_b32 s49, 4
L_seq_kernel_ld_loop:
    s_waitcnt vmcnt(9)
    s_barrier
    s_add_u32 m0, s37, 73728
    s_nop 0
    buffer_load_dwordx4 v2, s[28:31], s47 offen lds
    s_add_u32 m0, s37, 77824
    s_nop 0
    buffer_load_dwordx4 v3, s[28:31], s47 offen lds
    s_add_u32 m0, s37, 81920
    s_nop 0
    buffer_load_dwordx4 v4, s[28:31], s47 offen lds
    s_add_u32 m0, s37, 86016
    s_nop 0
    buffer_load_dwordx4 v5, s[28:31], s47 offen lds
    s_add_u32 m0, s37, 90112
    s_nop 0
    buffer_load_dwordx4 v6, s[32:35], s48 offen lds
    s_add_u32 m0, s37, 94208
    s_nop 0
    buffer_load_dwordx4 v7, s[32:35], s48 offen lds
    s_add_u32 m0, s37, 98304
    s_nop 0
    buffer_load_dwordx4 v8, s[32:35], s48 offen lds
    s_add_u32 m0, s37, 102400
    s_nop 0
    buffer_load_dwordx4 v9, s[32:35], s48 offen lds
    s_add_u32 m0, s37, 106496
    s_nop 0
    buffer_load_dwordx4 v10, s[32:35], s48 offen lds
    s_add_u32 s47, s47, 128
    s_add_u32 s48, s48, 128
    s_waitcnt vmcnt(9)
    s_barrier
    s_add_u32 m0, s37, 0
    s_nop 0
    buffer_load_dwordx4 v2, s[28:31], s47 offen lds
    s_add_u32 m0, s37, 4096
    s_nop 0
    buffer_load_dwordx4 v3, s[28:31], s47 offen lds
    s_add_u32 m0, s37, 8192
    s_nop 0
    buffer_load_dwordx4 v4, s[28:31], s47 offen lds
    s_add_u32 m0, s37, 12288
    s_nop 0
    buffer_load_dwordx4 v5, s[28:31], s47 offen lds
    s_add_u32 m0, s37, 16384
    s_nop 0
    buffer_load_dwordx4 v6, s[32:35], s48 offen lds
    s_add_u32 m0, s37, 20480
    s_nop 0
    buffer_load_dwordx4 v7, s[32:35], s48 offen lds
    s_add_u32 m0, s37, 24576
    s_nop 0
    buffer_load_dwordx4 v8, s[32:35], s48 offen lds
    s_add_u32 m0, s37, 28672
    s_nop 0
    buffer_load_dwordx4 v9, s[32:35], s48 offen lds
    s_add_u32 m0, s37, 32768
    s_nop 0
    buffer_load_dwordx4 v10, s[32:35], s48 offen lds
    s_add_u32 s47, s47, 128
    s_add_u32 s48, s48, 128
    s_waitcnt vmcnt(9)
    s_barrier
    s_add_u32 m0, s37, 36864
    s_nop 0
    buffer_load_dwordx4 v2, s[28:31], s47 offen lds
    s_add_u32 m0, s37, 40960
    s_nop 0
    buffer_load_dwordx4 v3, s[28:31], s47 offen lds
    s_add_u32 m0, s37, 45056
    s_nop 0
    buffer_load_dwordx4 v4, s[28:31], s47 offen lds
    s_add_u32 m0, s37, 49152
    s_nop 0
    buffer_load_dwordx4 v5, s[28:31], s47 offen lds
    s_add_u32 m0, s37, 53248
    s_nop 0
    buffer_load_dwordx4 v6, s[32:35], s48 offen lds
    s_add_u32 m0, s37, 57344
    s_nop 0
    buffer_load_dwordx4 v7, s[32:35], s48 offen lds
    s_add_u32 m0, s37, 61440
    s_nop 0
    buffer_load_dwordx4 v8, s[32:35], s48 offen lds
    s_add_u32 m0, s37, 65536
    s_nop 0
    buffer_load_dwordx4 v9, s[32:35], s48 offen lds
    s_add_u32 m0, s37, 69632
    s_nop 0
    buffer_load_dwordx4 v10, s[32:35], s48 offen lds
    s_add_u32 s47, s47, 128
    s_add_u32 s48, s48, 128
    s_sub_u32 s49, s49, 1
    s_cmp_lg_u32 s49, 0
    s_cbranch_scc1 L_seq_kernel_ld_loop
    s_waitcnt vmcnt(9)
    s_barrier
    s_add_u32 m0, s37, 73728
    s_nop 0
    buffer_load_dwordx4 v2, s[28:31], s47 offen lds
    s_add_u32 m0, s37, 77824
    s_nop 0
    buffer_load_dwordx4 v3, s[28:31], s47 offen lds
    s_add_u32 m0, s37, 81920
    s_nop 0
    buffer_load_dwordx4 v4, s[28:31], s47 offen lds
    s_add_u32 m0, s37, 86016
    s_nop 0
    buffer_load_dwordx4 v5, s[28:31], s47 offen lds
    s_add_u32 m0, s37, 90112
    s_nop 0
    buffer_load_dwordx4 v6, s[32:35], s48 offen lds
    s_add_u32 m0, s37, 94208
    s_nop 0
    buffer_load_dwordx4 v7, s[32:35], s48 offen lds
    s_add_u32 m0, s37, 98304
    s_nop 0
    buffer_load_dwordx4 v8, s[32:35], s48 offen lds
    s_add_u32 m0, s37, 102400
    s_nop 0
    buffer_load_dwordx4 v9, s[32:35], s48 offen lds
    s_add_u32 m0, s37, 106496
    s_nop 0
    buffer_load_dwordx4 v10, s[32:35], s48 offen lds
    s_add_u32 s47, s47, 128
    s_add_u32 s48, s48, 128
    s_waitcnt vmcnt(9)
    s_barrier
    s_add_u32 m0, s37, 0
    s_nop 0
    buffer_load_dwordx4 v2, s[28:31], s47 offen lds
    s_add_u32 m0, s37, 4096
    s_nop 0
    buffer_load_dwordx4 v3, s[28:31], s47 offen lds
    s_add_u32 m0, s37, 8192
    s_nop 0
    buffer_load_dwordx4 v4, s[28:31], s47 offen lds
    s_add_u32 m0, s37, 12288
    s_nop 0
    buffer_load_dwordx4 v5, s[28:31], s47 offen lds
    s_add_u32 m0, s37, 16384
    s_nop 0
    buffer_load_dwordx4 v6, s[32:35], s48 offen lds
    s_add_u32 m0, s37, 20480
    s_nop 0
    buffer_load_dwordx4 v7, s[32:35], s48 offen lds
    s_add_u32 m0, s37, 24576
    s_nop 0
    buffer_load_dwordx4 v8, s[32:35], s48 offen lds
    s_add_u32 m0, s37, 28672
    s_nop 0
    buffer_load_dwordx4 v9, s[32:35], s48 offen lds
    s_add_u32 m0, s37, 32768
    s_nop 0
    buffer_load_dwordx4 v10, s[32:35], s48 offen lds
    s_add_u32 s47, s47, 128
    s_add_u32 s48, s48, 128
    s_waitcnt vmcnt(9)
    s_barrier
    s_waitcnt vmcnt(0)
    s_barrier
L_seq_kernel_end:
    s_endpgm
.globl post1_kernel
.p2align 8
.type post1_kernel,@function
post1_kernel:
    s_cmp_ge_u32 s2, 256
    s_cbranch_scc1 L_post1_kernel_end
    s_load_dwordx16 s[4:19], s[0:1], 0
    s_load_dwordx8 s[20:27], s[0:1], 64
    s_lshl_b32 s28, s2, 3
    v_lshrrev_b32 v3, 3, v0
    v_add_u32 v3, s28, v3
    v_and_b32 v4, 7, v0
    s_movk_i32 s29, 1152
    v_mul_lo_u32 v5, v3, s29
    v_lshl_add_u32 v5, v4, 4, v5
    v_lshlrev_b32 v6, 1, v5
    s_waitcnt lgkmcnt(0)
    s_add_u32 s32, s26, 0x1538000
    s_addc_u32 s33, s27, 0
    s_and_b32 s33, s33, 0xffff
    s_mov_b32 s34, 0x240000
    s_mov_b32 s35, 0x00020000
    s_add_u32 s36, s26, 0x1778000
    s_addc_u32 s37, s27, 0
    s_and_b32 s37, s37, 0xffff
    s_mov_b32 s38, 0x240000
    s_mov_b32 s39, 0x00020000
    s_add_u32 s40, s26, 0x2078000
    s_addc_u32 s41, s27, 0
    s_and_b32 s41, s41, 0xffff
    s_mov_b32 s42, 0x1200000
    s_mov_b32 s43, 0x00020000
    s_add_u32 s44, s26, 0x298000
    s_addc_u32 s45, s27, 0
    s_and_b32 s45, s45, 0xffff
    s_mov_b32 s46, 0x240000
    s_mov_b32 s47, 0x00020000
    buffer_load_dwordx4 v[8:11], v5, s[32:35], 0 offen offset:0
    buffer_load_dwordx4 v[12:15], v5, s[32:35], 0 offen offset:128
    buffer_load_dwordx4 v[16:19], v5, s[32:35], 0 offen offset:256
    buffer_load_dwordx4 v[20:23], v5, s[32:35], 0 offen offset:384
    buffer_load_dwordx4 v[24:27], v5, s[32:35], 0 offen offset:512
    buffer_load_dwordx4 v[28:31], v5, s[32:35], 0 offen offset:640
    buffer_load_dwordx4 v[32:35], v5, s[32:35], 0 offen offset:768
    buffer_load_dwordx4 v[36:39], v5, s[32:35], 0 offen offset:896
    buffer_load_dwordx4 v[40:43], v5, s[32:35], 0 offen offset:1024
    s_mov_b32 s48, 0
    buffer_load_dwordx4 v[48:51], v6, s[40:43], s48 offen offset:0
    buffer_load_dwordx4 v[52:55], v6, s[40:43], s48 offen offset:16
    s_mov_b32 s48, 4718592
    buffer_load_dwordx4 v[56:59], v6, s[40:43], s48 offen offset:0
    buffer_load_dwordx4 v[60:63], v6, s[40:43], s48 offen offset:16
    s_mov_b32 s48, 9437184
    buffer_load_dwordx4 v[64:67], v6, s[40:43], s48 offen offset:0
    buffer_load_dwordx4 v[68:71], v6, s[40:43], s48 offen offset:16
    s_mov_b32 s48, 14155776
    buffer_load_dwordx4 v[72:75], v6, s[40:43], s48 offen offset:0
    buffer_load_dwordx4 v[76:79], v6, s[40:43], s48 offen offset:16
    s_mov_b32 s48, 0
    buffer_load_dwordx4 v[80:83], v6, s[40:43], s48 offen offset:256
    buffer_load_dwordx4 v[84:87], v6, s[40:43], s48 offen offset:272
    s_mov_b32 s48, 4718592
    buffer_load_dwordx4 v[88:91], v6, s[40:43], s48 offen offset:256
    buffer_load_dwordx4 v[92:95], v6, s[40:43], s48 offen offset:272
    s_mov_b32 s48, 9437184
    buffer_load_dwordx4 v[96:99], v6, s[40:43], s48 offen offset:256
    buffer_load_dwordx4 v[100:103], v6, s[40:43], s48 offen offset:272
    s_mov_b32 s48, 14155776
    buffer_load_dwordx4 v[104:107], v6, s[40:43], s48 offen offset:256
    buffer_load_dwordx4 v[108:111], v6, s[40:43], s48 offen offset:272
    s_mov_b32 s48, 0
    buffer_load_dwordx4 v[112:115], v6, s[40:43], s48 offen offset:512
    buffer_load_dwordx4 v[116:119], v6, s[40:43], s48 offen offset:528
    s_mov_b32 s48, 4718592
    buffer_load_dwordx4 v[120:123], v6, s[40:43], s48 offen offset:512
    buffer_load_dwordx4 v[124:127], v6, s[40:43], s48 offen offset:528
    s_mov_b32 s48, 9437184
    buffer_load_dwordx4 v[128:131], v6, s[40:43], s48 offen offset:512
    buffer_load_dwordx4 v[132:135], v6, s[40:43], s48 offen offset:528
    s_mov_b32 s48, 14155776
    buffer_load_dwordx4 v[136:139], v6, s[40:43], s48 offen offset:512
    buffer_load_dwordx4 v[140:143], v6, s[40:43], s48 offen offset:528
    s_waitcnt vmcnt(16)
    v_add_f32 v48, v48, v56
    v_add_f32 v64, v64, v72
    v_cvt_pk_bf16_f32 v48, v48, v64
    v_lshlrev_b32 v56, 16, v48
    v_and_b32 v64, 0xffff0000, v48
    v_sub_f32 v48, v56, v64
    v_cvt_pk_bf16_f32 v48, v48, v48
    v_lshlrev_b32 v48, 16, v48
    v_lshlrev_b32 v56, 16, v8
    v_add_f32 v48, v48, v56
    v_add_f32 v49, v49, v57
    v_add_f32 v65, v65, v73
    v_cvt_pk_bf16_f32 v49, v49, v65
    v_lshlrev_b32 v57, 16, v49
    v_and_b32 v65, 0xffff0000, v49
    v_sub_f32 v49, v57, v65
    v_cvt_pk_bf16_f32 v49, v49, v49
    v_lshlrev_b32 v49, 16, v49
    v_and_b32 v57, 0xffff0000, v8
    v_add_f32 v49, v49, v57
    v_add_f32 v50, v50, v58
    v_add_f32 v66, v66, v74
    v_cvt_pk_bf16_f32 v50, v50, v66
    v_lshlrev_b32 v58, 16, v50
    v_and_b32 v66, 0xffff0000, v50
    v_sub_f32 v50, v58, v66
    v_cvt_pk_bf16_f32 v50, v50, v50
    v_lshlrev_b32 v50, 16, v50
    v_lshlrev_b32 v58, 16, v9
    v_add_f32 v50, v50, v58
    v_add_f32 v51, v51, v59
    v_add_f32 v67, v67, v75
    v_cvt_pk_bf16_f32 v51, v51, v67
    v_lshlrev_b32 v59, 16, v51
    v_and_b32 v67, 0xffff0000, v51
    v_sub_f32 v51, v59, v67
    v_cvt_pk_bf16_f32 v51, v51, v51
    v_lshlrev_b32 v51, 16, v51
    v_and_b32 v59, 0xffff0000, v9
    v_add_f32 v51, v51, v59
    v_add_f32 v52, v52, v60
    v_add_f32 v68, v68, v76
    v_cvt_pk_bf16_f32 v52, v52, v68
    v_lshlrev_b32 v60, 16, v52
    v_and_b32 v68, 0xffff0000, v52
    v_sub_f32 v52, v60, v68
    v_cvt_pk_bf16_f32 v52, v52, v52
    v_lshlrev_b32 v52, 16, v52
    v_lshlrev_b32 v60, 16, v10
    v_add_f32 v52, v52, v60
    v_add_f32 v53, v53, v61
    v_add_f32 v69, v69, v77
    v_cvt_pk_bf16_f32 v53, v53, v69
    v_lshlrev_b32 v61, 16, v53
    v_and_b32 v69, 0xffff0000, v53
    v_sub_f32 v53, v61, v69
    v_cvt_pk_bf16_f32 v53, v53, v53
    v_lshlrev_b32 v53, 16, v53
    v_and_b32 v61, 0xffff0000, v10
    v_add_f32 v53, v53, v61
    v_add_f32 v54, v54, v62
    v_add_f32 v70, v70, v78
    v_cvt_pk_bf16_f32 v54, v54, v70
    v_lshlrev_b32 v62, 16, v54
    v_and_b32 v70, 0xffff0000, v54
    v_sub_f32 v54, v62, v70
    v_cvt_pk_bf16_f32 v54, v54, v54
    v_lshlrev_b32 v54, 16, v54
    v_lshlrev_b32 v62, 16, v11
    v_add_f32 v54, v54, v62
    v_add_f32 v55, v55, v63
    v_add_f32 v71, v71, v79
    v_cvt_pk_bf16_f32 v55, v55, v71
    v_lshlrev_b32 v63, 16, v55
    v_and_b32 v71, 0xffff0000, v55
    v_sub_f32 v55, v63, v71
    v_cvt_pk_bf16_f32 v55, v55, v55
    v_lshlrev_b32 v55, 16, v55
    v_and_b32 v63, 0xffff0000, v11
    v_add_f32 v55, v55, v63
    v_cvt_pk_bf16_f32 v8, v48, v49
    v_cvt_pk_bf16_f32 v9, v50, v51
    v_cvt_pk_bf16_f32 v10, v52, v53
    v_cvt_pk_bf16_f32 v11, v54, v55
    s_waitcnt vmcnt(8)
    v_add_f32 v80, v80, v88
    v_add_f32 v96, v96, v104
    v_cvt_pk_bf16_f32 v80, v80, v96
    v_lshlrev_b32 v88, 16, v80
    v_and_b32 v96, 0xffff0000, v80
    v_sub_f32 v80, v88, v96
    v_cvt_pk_bf16_f32 v80, v80, v80
    v_lshlrev_b32 v80, 16, v80
    v_lshlrev_b32 v88, 16, v12
    v_add_f32 v80, v80, v88
    v_add_f32 v81, v81, v89
    v_add_f32 v97, v97, v105
    v_cvt_pk_bf16_f32 v81, v81, v97
    v_lshlrev_b32 v89, 16, v81
    v_and_b32 v97, 0xffff0000, v81
    v_sub_f32 v81, v89, v97
    v_cvt_pk_bf16_f32 v81, v81, v81
    v_lshlrev_b32 v81, 16, v81
    v_and_b32 v89, 0xffff0000, v12
    v_add_f32 v81, v81, v89
    v_add_f32 v82, v82, v90
    v_add_f32 v98, v98, v106
    v_cvt_pk_bf16_f32 v82, v82, v98
    v_lshlrev_b32 v90, 16, v82
    v_and_b32 v98, 0xffff0000, v82
    v_sub_f32 v82, v90, v98
    v_cvt_pk_bf16_f32 v82, v82, v82
    v_lshlrev_b32 v82, 16, v82
    v_lshlrev_b32 v90, 16, v13
    v_add_f32 v82, v82, v90
    v_add_f32 v83, v83, v91
    v_add_f32 v99, v99, v107
    v_cvt_pk_bf16_f32 v83, v83, v99
    v_lshlrev_b32 v91, 16, v83
    v_and_b32 v99, 0xffff0000, v83
    v_sub_f32 v83, v91, v99
    v_cvt_pk_bf16_f32 v83, v83, v83
    v_lshlrev_b32 v83, 16, v83
    v_and_b32 v91, 0xffff0000, v13
    v_add_f32 v83, v83, v91
    v_add_f32 v84, v84, v92
    v_add_f32 v100, v100, v108
    v_cvt_pk_bf16_f32 v84, v84, v100
    v_lshlrev_b32 v92, 16, v84
    v_and_b32 v100, 0xffff0000, v84
    v_sub_f32 v84, v92, v100
    v_cvt_pk_bf16_f32 v84, v84, v84
    v_lshlrev_b32 v84, 16, v84
    v_lshlrev_b32 v92, 16, v14
    v_add_f32 v84, v84, v92
    v_add_f32 v85, v85, v93
    v_add_f32 v101, v101, v109
    v_cvt_pk_bf16_f32 v85, v85, v101
    v_lshlrev_b32 v93, 16, v85
    v_and_b32 v101, 0xffff0000, v85
    v_sub_f32 v85, v93, v101
    v_cvt_pk_bf16_f32 v85, v85, v85
    v_lshlrev_b32 v85, 16, v85
    v_and_b32 v93, 0xffff0000, v14
    v_add_f32 v85, v85, v93
    v_add_f32 v86, v86, v94
    v_add_f32 v102, v102, v110
    v_cvt_pk_bf16_f32 v86, v86, v102
    v_lshlrev_b32 v94, 16, v86
    v_and_b32 v102, 0xffff0000, v86
    v_sub_f32 v86, v94, v102
    v_cvt_pk_bf16_f32 v86, v86, v86
    v_lshlrev_b32 v86, 16, v86
    v_lshlrev_b32 v94, 16, v15
    v_add_f32 v86, v86, v94
    v_add_f32 v87, v87, v95
    v_add_f32 v103, v103, v111
    v_cvt_pk_bf16_f32 v87, v87, v103
    v_lshlrev_b32 v95, 16, v87
    v_and_b32 v103, 0xffff0000, v87
    v_sub_f32 v87, v95, v103
    v_cvt_pk_bf16_f32 v87, v87, v87
    v_lshlrev_b32 v87, 16, v87
    v_and_b32 v95, 0xffff0000, v15
    v_add_f32 v87, v87, v95
    v_cvt_pk_bf16_f32 v12, v80, v81
    v_cvt_pk_bf16_f32 v13, v82, v83
    v_cvt_pk_bf16_f32 v14, v84, v85
    v_cvt_pk_bf16_f32 v15, v86, v87
    s_waitcnt vmcnt(0)
    v_add_f32 v112, v112, v120
    v_add_f32 v128, v128, v136
    v_cvt_pk_bf16_f32 v112, v112, v128
    v_lshlrev_b32 v120, 16, v112
    v_and_b32 v128, 0xffff0000, v112
    v_sub_f32 v112, v120, v128
    v_cvt_pk_bf16_f32 v112, v112, v112
    v_lshlrev_b32 v112, 16, v112
    v_lshlrev_b32 v120, 16, v16
    v_add_f32 v112, v112, v120
    v_add_f32 v113, v113, v121
    v_add_f32 v129, v129, v137
    v_cvt_pk_bf16_f32 v113, v113, v129
    v_lshlrev_b32 v121, 16, v113
    v_and_b32 v129, 0xffff0000, v113
    v_sub_f32 v113, v121, v129
    v_cvt_pk_bf16_f32 v113, v113, v113
    v_lshlrev_b32 v113, 16, v113
    v_and_b32 v121, 0xffff0000, v16
    v_add_f32 v113, v113, v121
    v_add_f32 v114, v114, v122
    v_add_f32 v130, v130, v138
    v_cvt_pk_bf16_f32 v114, v114, v130
    v_lshlrev_b32 v122, 16, v114
    v_and_b32 v130, 0xffff0000, v114
    v_sub_f32 v114, v122, v130
    v_cvt_pk_bf16_f32 v114, v114, v114
    v_lshlrev_b32 v114, 16, v114
    v_lshlrev_b32 v122, 16, v17
    v_add_f32 v114, v114, v122
    v_add_f32 v115, v115, v123
    v_add_f32 v131, v131, v139
    v_cvt_pk_bf16_f32 v115, v115, v131
    v_lshlrev_b32 v123, 16, v115
    v_and_b32 v131, 0xffff0000, v115
    v_sub_f32 v115, v123, v131
    v_cvt_pk_bf16_f32 v115, v115, v115
    v_lshlrev_b32 v115, 16, v115
    v_and_b32 v123, 0xffff0000, v17
    v_add_f32 v115, v115, v123
    v_add_f32 v116, v116, v124
    v_add_f32 v132, v132, v140
    v_cvt_pk_bf16_f32 v116, v116, v132
    v_lshlrev_b32 v124, 16, v116
    v_and_b32 v132, 0xffff0000, v116
    v_sub_f32 v116, v124, v132
    v_cvt_pk_bf16_f32 v116, v116, v116
    v_lshlrev_b32 v116, 16, v116
    v_lshlrev_b32 v124, 16, v18
    v_add_f32 v116, v116, v124
    v_add_f32 v117, v117, v125
    v_add_f32 v133, v133, v141
    v_cvt_pk_bf16_f32 v117, v117, v133
    v_lshlrev_b32 v125, 16, v117
    v_and_b32 v133, 0xffff0000, v117
    v_sub_f32 v117, v125, v133
    v_cvt_pk_bf16_f32 v117, v117, v117
    v_lshlrev_b32 v117, 16, v117
    v_and_b32 v125, 0xffff0000, v18
    v_add_f32 v117, v117, v125
    v_add_f32 v118, v118, v126
    v_add_f32 v134, v134, v142
    v_cvt_pk_bf16_f32 v118, v118, v134
    v_lshlrev_b32 v126, 16, v118
    v_and_b32 v134, 0xffff0000, v118
    v_sub_f32 v118, v126, v134
    v_cvt_pk_bf16_f32 v118, v118, v118
    v_lshlrev_b32 v118, 16, v118
    v_lshlrev_b32 v126, 16, v19
    v_add_f32 v118, v118, v126
    v_add_f32 v119, v119, v127
    v_add_f32 v135, v135, v143
    v_cvt_pk_bf16_f32 v119, v119, v135
    v_lshlrev_b32 v127, 16, v119
    v_and_b32 v135, 0xffff0000, v119
    v_sub_f32 v119, v127, v135
    v_cvt_pk_bf16_f32 v119, v119, v119
    v_lshlrev_b32 v119, 16, v119
    v_and_b32 v127, 0xffff0000, v19
    v_add_f32 v119, v119, v127
    v_cvt_pk_bf16_f32 v16, v112, v113
    v_cvt_pk_bf16_f32 v17, v114, v115
    v_cvt_pk_bf16_f32 v18, v116, v117
    v_cvt_pk_bf16_f32 v19, v118, v119
    s_mov_b32 s48, 0
    buffer_load_dwordx4 v[48:51], v6, s[40:43], s48 offen offset:768
    buffer_load_dwordx4 v[52:55], v6, s[40:43], s48 offen offset:784
    s_mov_b32 s48, 4718592
    buffer_load_dwordx4 v[56:59], v6, s[40:43], s48 offen offset:768
    buffer_load_dwordx4 v[60:63], v6, s[40:43], s48 offen offset:784
    s_mov_b32 s48, 9437184
    buffer_load_dwordx4 v[64:67], v6, s[40:43], s48 offen offset:768
    buffer_load_dwordx4 v[68:71], v6, s[40:43], s48 offen offset:784
    s_mov_b32 s48, 14155776
    buffer_load_dwordx4 v[72:75], v6, s[40:43], s48 offen offset:768
    buffer_load_dwordx4 v[76:79], v6, s[40:43], s48 offen offset:784
    s_mov_b32 s48, 0
    buffer_load_dwordx4 v[80:83], v6, s[40:43], s48 offen offset:1024
    buffer_load_dwordx4 v[84:87], v6, s[40:43], s48 offen offset:1040
    s_mov_b32 s48, 4718592
    buffer_load_dwordx4 v[88:91], v6, s[40:43], s48 offen offset:1024
    buffer_load_dwordx4 v[92:95], v6, s[40:43], s48 offen offset:1040
    s_mov_b32 s48, 9437184
    buffer_load_dwordx4 v[96:99], v6, s[40:43], s48 offen offset:1024
    buffer_load_dwordx4 v[100:103], v6, s[40:43], s48 offen offset:1040
    s_mov_b32 s48, 14155776
    buffer_load_dwordx4 v[104:107], v6, s[40:43], s48 offen offset:1024
    buffer_load_dwordx4 v[108:111], v6, s[40:43], s48 offen offset:1040
    s_mov_b32 s48, 0
    buffer_load_dwordx4 v[112:115], v6, s[40:43], s48 offen offset:1280
    buffer_load_dwordx4 v[116:119], v6, s[40:43], s48 offen offset:1296
    s_mov_b32 s48, 4718592
    buffer_load_dwordx4 v[120:123], v6, s[40:43], s48 offen offset:1280
    buffer_load_dwordx4 v[124:127], v6, s[40:43], s48 offen offset:1296
    s_mov_b32 s48, 9437184
    buffer_load_dwordx4 v[128:131], v6, s[40:43], s48 offen offset:1280
    buffer_load_dwordx4 v[132:135], v6, s[40:43], s48 offen offset:1296
    s_mov_b32 s48, 14155776
    buffer_load_dwordx4 v[136:139], v6, s[40:43], s48 offen offset:1280
    buffer_load_dwordx4 v[140:143], v6, s[40:43], s48 offen offset:1296
    s_waitcnt vmcnt(16)
    v_add_f32 v48, v48, v56
    v_add_f32 v64, v64, v72
    v_cvt_pk_bf16_f32 v48, v48, v64
    v_lshlrev_b32 v56, 16, v48
    v_and_b32 v64, 0xffff0000, v48
    v_sub_f32 v48, v56, v64
    v_cvt_pk_bf16_f32 v48, v48, v48
    v_lshlrev_b32 v48, 16, v48
    v_lshlrev_b32 v56, 16, v20
    v_add_f32 v48, v48, v56
    v_add_f32 v49, v49, v57
    v_add_f32 v65, v65, v73
    v_cvt_pk_bf16_f32 v49, v49, v65
    v_lshlrev_b32 v57, 16, v49
    v_and_b32 v65, 0xffff0000, v49
    v_sub_f32 v49, v57, v65
    v_cvt_pk_bf16_f32 v49, v49, v49
    v_lshlrev_b32 v49, 16, v49
    v_and_b32 v57, 0xffff0000, v20
    v_add_f32 v49, v49, v57
    v_add_f32 v50, v50, v58
    v_add_f32 v66, v66, v74
    v_cvt_pk_bf16_f32 v50, v50, v66
    v_lshlrev_b32 v58, 16, v50
    v_and_b32 v66, 0xffff0000, v50
    v_sub_f32 v50, v58, v66
    v_cvt_pk_bf16_f32 v50, v50, v50
    v_lshlrev_b32 v50, 16, v50
    v_lshlrev_b32 v58, 16, v21
    v_add_f32 v50, v50, v58
    v_add_f32 v51, v51, v59
    v_add_f32 v67, v67, v75
    v_cvt_pk_bf16_f32 v51, v51, v67
    v_lshlrev_b32 v59, 16, v51
    v_and_b32 v67, 0xffff0000, v51
    v_sub_f32 v51, v59, v67
    v_cvt_pk_bf16_f32 v51, v51, v51
    v_lshlrev_b32 v51, 16, v51
    v_and_b32 v59, 0xffff0000, v21
    v_add_f32 v51, v51, v59
    v_add_f32 v52, v52, v60
    v_add_f32 v68, v68, v76
    v_cvt_pk_bf16_f32 v52, v52, v68
    v_lshlrev_b32 v60, 16, v52
    v_and_b32 v68, 0xffff0000, v52
    v_sub_f32 v52, v60, v68
    v_cvt_pk_bf16_f32 v52, v52, v52
    v_lshlrev_b32 v52, 16, v52
    v_lshlrev_b32 v60, 16, v22
    v_add_f32 v52, v52, v60
    v_add_f32 v53, v53, v61
    v_add_f32 v69, v69, v77
    v_cvt_pk_bf16_f32 v53, v53, v69
    v_lshlrev_b32 v61, 16, v53
    v_and_b32 v69, 0xffff0000, v53
    v_sub_f32 v53, v61, v69
    v_cvt_pk_bf16_f32 v53, v53, v53
    v_lshlrev_b32 v53, 16, v53
    v_and_b32 v61, 0xffff0000, v22
    v_add_f32 v53, v53, v61
    v_add_f32 v54, v54, v62
    v_add_f32 v70, v70, v78
    v_cvt_pk_bf16_f32 v54, v54, v70
    v_lshlrev_b32 v62, 16, v54
    v_and_b32 v70, 0xffff0000, v54
    v_sub_f32 v54, v62, v70
    v_cvt_pk_bf16_f32 v54, v54, v54
    v_lshlrev_b32 v54, 16, v54
    v_lshlrev_b32 v62, 16, v23
    v_add_f32 v54, v54, v62
    v_add_f32 v55, v55, v63
    v_add_f32 v71, v71, v79
    v_cvt_pk_bf16_f32 v55, v55, v71
    v_lshlrev_b32 v63, 16, v55
    v_and_b32 v71, 0xffff0000, v55
    v_sub_f32 v55, v63, v71
    v_cvt_pk_bf16_f32 v55, v55, v55
    v_lshlrev_b32 v55, 16, v55
    v_and_b32 v63, 0xffff0000, v23
    v_add_f32 v55, v55, v63
    v_cvt_pk_bf16_f32 v20, v48, v49
    v_cvt_pk_bf16_f32 v21, v50, v51
    v_cvt_pk_bf16_f32 v22, v52, v53
    v_cvt_pk_bf16_f32 v23, v54, v55
    s_waitcnt vmcnt(8)
    v_add_f32 v80, v80, v88
    v_add_f32 v96, v96, v104
    v_cvt_pk_bf16_f32 v80, v80, v96
    v_lshlrev_b32 v88, 16, v80
    v_and_b32 v96, 0xffff0000, v80
    v_sub_f32 v80, v88, v96
    v_cvt_pk_bf16_f32 v80, v80, v80
    v_lshlrev_b32 v80, 16, v80
    v_lshlrev_b32 v88, 16, v24
    v_add_f32 v80, v80, v88
    v_add_f32 v81, v81, v89
    v_add_f32 v97, v97, v105
    v_cvt_pk_bf16_f32 v81, v81, v97
    v_lshlrev_b32 v89, 16, v81
    v_and_b32 v97, 0xffff0000, v81
    v_sub_f32 v81, v89, v97
    v_cvt_pk_bf16_f32 v81, v81, v81
    v_lshlrev_b32 v81, 16, v81
    v_and_b32 v89, 0xffff0000, v24
    v_add_f32 v81, v81, v89
    v_add_f32 v82, v82, v90
    v_add_f32 v98, v98, v106
    v_cvt_pk_bf16_f32 v82, v82, v98
    v_lshlrev_b32 v90, 16, v82
    v_and_b32 v98, 0xffff0000, v82
    v_sub_f32 v82, v90, v98
    v_cvt_pk_bf16_f32 v82, v82, v82
    v_lshlrev_b32 v82, 16, v82
    v_lshlrev_b32 v90, 16, v25
    v_add_f32 v82, v82, v90
    v_add_f32 v83, v83, v91
    v_add_f32 v99, v99, v107
    v_cvt_pk_bf16_f32 v83, v83, v99
    v_lshlrev_b32 v91, 16, v83
    v_and_b32 v99, 0xffff0000, v83
    v_sub_f32 v83, v91, v99
    v_cvt_pk_bf16_f32 v83, v83, v83
    v_lshlrev_b32 v83, 16, v83
    v_and_b32 v91, 0xffff0000, v25
    v_add_f32 v83, v83, v91
    v_add_f32 v84, v84, v92
    v_add_f32 v100, v100, v108
    v_cvt_pk_bf16_f32 v84, v84, v100
    v_lshlrev_b32 v92, 16, v84
    v_and_b32 v100, 0xffff0000, v84
    v_sub_f32 v84, v92, v100
    v_cvt_pk_bf16_f32 v84, v84, v84
    v_lshlrev_b32 v84, 16, v84
    v_lshlrev_b32 v92, 16, v26
    v_add_f32 v84, v84, v92
    v_add_f32 v85, v85, v93
    v_add_f32 v101, v101, v109
    v_cvt_pk_bf16_f32 v85, v85, v101
    v_lshlrev_b32 v93, 16, v85
    v_and_b32 v101, 0xffff0000, v85
    v_sub_f32 v85, v93, v101
    v_cvt_pk_bf16_f32 v85, v85, v85
    v_lshlrev_b32 v85, 16, v85
    v_and_b32 v93, 0xffff0000, v26
    v_add_f32 v85, v85, v93
    v_add_f32 v86, v86, v94
    v_add_f32 v102, v102, v110
    v_cvt_pk_bf16_f32 v86, v86, v102
    v_lshlrev_b32 v94, 16, v86
    v_and_b32 v102, 0xffff0000, v86
    v_sub_f32 v86, v94, v102
    v_cvt_pk_bf16_f32 v86, v86, v86
    v_lshlrev_b32 v86, 16, v86
    v_lshlrev_b32 v94, 16, v27
    v_add_f32 v86, v86, v94
    v_add_f32 v87, v87, v95
    v_add_f32 v103, v103, v111
    v_cvt_pk_bf16_f32 v87, v87, v103
    v_lshlrev_b32 v95, 16, v87
    v_and_b32 v103, 0xffff0000, v87
    v_sub_f32 v87, v95, v103
    v_cvt_pk_bf16_f32 v87, v87, v87
    v_lshlrev_b32 v87, 16, v87
    v_and_b32 v95, 0xffff0000, v27
    v_add_f32 v87, v87, v95
    v_cvt_pk_bf16_f32 v24, v80, v81
    v_cvt_pk_bf16_f32 v25, v82, v83
    v_cvt_pk_bf16_f32 v26, v84, v85
    v_cvt_pk_bf16_f32 v27, v86, v87
    s_waitcnt vmcnt(0)
    v_add_f32 v112, v112, v120
    v_add_f32 v128, v128, v136
    v_cvt_pk_bf16_f32 v112, v112, v128
    v_lshlrev_b32 v120, 16, v112
    v_and_b32 v128, 0xffff0000, v112
    v_sub_f32 v112, v120, v128
    v_cvt_pk_bf16_f32 v112, v112, v112
    v_lshlrev_b32 v112, 16, v112
    v_lshlrev_b32 v120, 16, v28
    v_add_f32 v112, v112, v120
    v_add_f32 v113, v113, v121
    v_add_f32 v129, v129, v137
    v_cvt_pk_bf16_f32 v113, v113, v129
    v_lshlrev_b32 v121, 16, v113
    v_and_b32 v129, 0xffff0000, v113
    v_sub_f32 v113, v121, v129
    v_cvt_pk_bf16_f32 v113, v113, v113
    v_lshlrev_b32 v113, 16, v113
    v_and_b32 v121, 0xffff0000, v28
    v_add_f32 v113, v113, v121
    v_add_f32 v114, v114, v122
    v_add_f32 v130, v130, v138
    v_cvt_pk_bf16_f32 v114, v114, v130
    v_lshlrev_b32 v122, 16, v114
    v_and_b32 v130, 0xffff0000, v114
    v_sub_f32 v114, v122, v130
    v_cvt_pk_bf16_f32 v114, v114, v114
    v_lshlrev_b32 v114, 16, v114
    v_lshlrev_b32 v122, 16, v29
    v_add_f32 v114, v114, v122
    v_add_f32 v115, v115, v123
    v_add_f32 v131, v131, v139
    v_cvt_pk_bf16_f32 v115, v115, v131
    v_lshlrev_b32 v123, 16, v115
    v_and_b32 v131, 0xffff0000, v115
    v_sub_f32 v115, v123, v131
    v_cvt_pk_bf16_f32 v115, v115, v115
    v_lshlrev_b32 v115, 16, v115
    v_and_b32 v123, 0xffff0000, v29
    v_add_f32 v115, v115, v123
    v_add_f32 v116, v116, v124
    v_add_f32 v132, v132, v140
    v_cvt_pk_bf16_f32 v116, v116, v132
    v_lshlrev_b32 v124, 16, v116
    v_and_b32 v132, 0xffff0000, v116
    v_sub_f32 v116, v124, v132
    v_cvt_pk_bf16_f32 v116, v116, v116
    v_lshlrev_b32 v116, 16, v116
    v_lshlrev_b32 v124, 16, v30
    v_add_f32 v116, v116, v124
    v_add_f32 v117, v117, v125
    v_add_f32 v133, v133, v141
    v_cvt_pk_bf16_f32 v117, v117, v133
    v_lshlrev_b32 v125, 16, v117
    v_and_b32 v133, 0xffff0000, v117
    v_sub_f32 v117, v125, v133
    v_cvt_pk_bf16_f32 v117, v117, v117
    v_lshlrev_b32 v117, 16, v117
    v_and_b32 v125, 0xffff0000, v30
    v_add_f32 v117, v117, v125
    v_add_f32 v118, v118, v126
    v_add_f32 v134, v134, v142
    v_cvt_pk_bf16_f32 v118, v118, v134
    v_lshlrev_b32 v126, 16, v118
    v_and_b32 v134, 0xffff0000, v118
    v_sub_f32 v118, v126, v134
    v_cvt_pk_bf16_f32 v118, v118, v118
    v_lshlrev_b32 v118, 16, v118
    v_lshlrev_b32 v126, 16, v31
    v_add_f32 v118, v118, v126
    v_add_f32 v119, v119, v127
    v_add_f32 v135, v135, v143
    v_cvt_pk_bf16_f32 v119, v119, v135
    v_lshlrev_b32 v127, 16, v119
    v_and_b32 v135, 0xffff0000, v119
    v_sub_f32 v119, v127, v135
    v_cvt_pk_bf16_f32 v119, v119, v119
    v_lshlrev_b32 v119, 16, v119
    v_and_b32 v127, 0xffff0000, v31
    v_add_f32 v119, v119, v127
    v_cvt_pk_bf16_f32 v28, v112, v113
    v_cvt_pk_bf16_f32 v29, v114, v115
    v_cvt_pk_bf16_f32 v30, v116, v117
    v_cvt_pk_bf16_f32 v31, v118, v119
    s_mov_b32 s48, 0
    buffer_load_dwordx4 v[48:51], v6, s[40:43], s48 offen offset:1536
    buffer_load_dwordx4 v[52:55], v6, s[40:43], s48 offen offset:1552
    s_mov_b32 s48, 4718592
    buffer_load_dwordx4 v[56:59], v6, s[40:43], s48 offen offset:1536
    buffer_load_dwordx4 v[60:63], v6, s[40:43], s48 offen offset:1552
    s_mov_b32 s48, 9437184
    buffer_load_dwordx4 v[64:67], v6, s[40:43], s48 offen offset:1536
    buffer_load_dwordx4 v[68:71], v6, s[40:43], s48 offen offset:1552
    s_mov_b32 s48, 14155776
    buffer_load_dwordx4 v[72:75], v6, s[40:43], s48 offen offset:1536
    buffer_load_dwordx4 v[76:79], v6, s[40:43], s48 offen offset:1552
    s_mov_b32 s48, 0
    buffer_load_dwordx4 v[80:83], v6, s[40:43], s48 offen offset:1792
    buffer_load_dwordx4 v[84:87], v6, s[40:43], s48 offen offset:1808
    s_mov_b32 s48, 4718592
    buffer_load_dwordx4 v[88:91], v6, s[40:43], s48 offen offset:1792
    buffer_load_dwordx4 v[92:95], v6, s[40:43], s48 offen offset:1808
    s_mov_b32 s48, 9437184
    buffer_load_dwordx4 v[96:99], v6, s[40:43], s48 offen offset:1792
    buffer_load_dwordx4 v[100:103], v6, s[40:43], s48 offen offset:1808
    s_mov_b32 s48, 14155776
    buffer_load_dwordx4 v[104:107], v6, s[40:43], s48 offen offset:1792
    buffer_load_dwordx4 v[108:111], v6, s[40:43], s48 offen offset:1808
    s_mov_b32 s48, 0
    buffer_load_dwordx4 v[112:115], v6, s[40:43], s48 offen offset:2048
    buffer_load_dwordx4 v[116:119], v6, s[40:43], s48 offen offset:2064
    s_mov_b32 s48, 4718592
    buffer_load_dwordx4 v[120:123], v6, s[40:43], s48 offen offset:2048
    buffer_load_dwordx4 v[124:127], v6, s[40:43], s48 offen offset:2064
    s_mov_b32 s48, 9437184
    buffer_load_dwordx4 v[128:131], v6, s[40:43], s48 offen offset:2048
    buffer_load_dwordx4 v[132:135], v6, s[40:43], s48 offen offset:2064
    s_mov_b32 s48, 14155776
    buffer_load_dwordx4 v[136:139], v6, s[40:43], s48 offen offset:2048
    buffer_load_dwordx4 v[140:143], v6, s[40:43], s48 offen offset:2064
    s_waitcnt vmcnt(16)
    v_add_f32 v48, v48, v56
    v_add_f32 v64, v64, v72
    v_cvt_pk_bf16_f32 v48, v48, v64
    v_lshlrev_b32 v56, 16, v48
    v_and_b32 v64, 0xffff0000, v48
    v_sub_f32 v48, v56, v64
    v_cvt_pk_bf16_f32 v48, v48, v48
    v_lshlrev_b32 v48, 16, v48
    v_lshlrev_b32 v56, 16, v32
    v_add_f32 v48, v48, v56
    v_add_f32 v49, v49, v57
    v_add_f32 v65, v65, v73
    v_cvt_pk_bf16_f32 v49, v49, v65
    v_lshlrev_b32 v57, 16, v49
    v_and_b32 v65, 0xffff0000, v49
    v_sub_f32 v49, v57, v65
    v_cvt_pk_bf16_f32 v49, v49, v49
    v_lshlrev_b32 v49, 16, v49
    v_and_b32 v57, 0xffff0000, v32
    v_add_f32 v49, v49, v57
    v_add_f32 v50, v50, v58
    v_add_f32 v66, v66, v74
    v_cvt_pk_bf16_f32 v50, v50, v66
    v_lshlrev_b32 v58, 16, v50
    v_and_b32 v66, 0xffff0000, v50
    v_sub_f32 v50, v58, v66
    v_cvt_pk_bf16_f32 v50, v50, v50
    v_lshlrev_b32 v50, 16, v50
    v_lshlrev_b32 v58, 16, v33
    v_add_f32 v50, v50, v58
    v_add_f32 v51, v51, v59
    v_add_f32 v67, v67, v75
    v_cvt_pk_bf16_f32 v51, v51, v67
    v_lshlrev_b32 v59, 16, v51
    v_and_b32 v67, 0xffff0000, v51
    v_sub_f32 v51, v59, v67
    v_cvt_pk_bf16_f32 v51, v51, v51
    v_lshlrev_b32 v51, 16, v51
    v_and_b32 v59, 0xffff0000, v33
    v_add_f32 v51, v51, v59
    v_add_f32 v52, v52, v60
    v_add_f32 v68, v68, v76
    v_cvt_pk_bf16_f32 v52, v52, v68
    v_lshlrev_b32 v60, 16, v52
    v_and_b32 v68, 0xffff0000, v52
    v_sub_f32 v52, v60, v68
    v_cvt_pk_bf16_f32 v52, v52, v52
    v_lshlrev_b32 v52, 16, v52
    v_lshlrev_b32 v60, 16, v34
    v_add_f32 v52, v52, v60
    v_add_f32 v53, v53, v61
    v_add_f32 v69, v69, v77
    v_cvt_pk_bf16_f32 v53, v53, v69
    v_lshlrev_b32 v61, 16, v53
    v_and_b32 v69, 0xffff0000, v53
    v_sub_f32 v53, v61, v69
    v_cvt_pk_bf16_f32 v53, v53, v53
    v_lshlrev_b32 v53, 16, v53
    v_and_b32 v61, 0xffff0000, v34
    v_add_f32 v53, v53, v61
    v_add_f32 v54, v54, v62
    v_add_f32 v70, v70, v78
    v_cvt_pk_bf16_f32 v54, v54, v70
    v_lshlrev_b32 v62, 16, v54
    v_and_b32 v70, 0xffff0000, v54
    v_sub_f32 v54, v62, v70
    v_cvt_pk_bf16_f32 v54, v54, v54
    v_lshlrev_b32 v54, 16, v54
    v_lshlrev_b32 v62, 16, v35
    v_add_f32 v54, v54, v62
    v_add_f32 v55, v55, v63
    v_add_f32 v71, v71, v79
    v_cvt_pk_bf16_f32 v55, v55, v71
    v_lshlrev_b32 v63, 16, v55
    v_and_b32 v71, 0xffff0000, v55
    v_sub_f32 v55, v63, v71
    v_cvt_pk_bf16_f32 v55, v55, v55
    v_lshlrev_b32 v55, 16, v55
    v_and_b32 v63, 0xffff0000, v35
    v_add_f32 v55, v55, v63
    v_cvt_pk_bf16_f32 v32, v48, v49
    v_cvt_pk_bf16_f32 v33, v50, v51
    v_cvt_pk_bf16_f32 v34, v52, v53
    v_cvt_pk_bf16_f32 v35, v54, v55
    s_waitcnt vmcnt(8)
    v_add_f32 v80, v80, v88
    v_add_f32 v96, v96, v104
    v_cvt_pk_bf16_f32 v80, v80, v96
    v_lshlrev_b32 v88, 16, v80
    v_and_b32 v96, 0xffff0000, v80
    v_sub_f32 v80, v88, v96
    v_cvt_pk_bf16_f32 v80, v80, v80
    v_lshlrev_b32 v80, 16, v80
    v_lshlrev_b32 v88, 16, v36
    v_add_f32 v80, v80, v88
    v_add_f32 v81, v81, v89
    v_add_f32 v97, v97, v105
    v_cvt_pk_bf16_f32 v81, v81, v97
    v_lshlrev_b32 v89, 16, v81
    v_and_b32 v97, 0xffff0000, v81
    v_sub_f32 v81, v89, v97
    v_cvt_pk_bf16_f32 v81, v81, v81
    v_lshlrev_b32 v81, 16, v81
    v_and_b32 v89, 0xffff0000, v36
    v_add_f32 v81, v81, v89
    v_add_f32 v82, v82, v90
    v_add_f32 v98, v98, v106
    v_cvt_pk_bf16_f32 v82, v82, v98
    v_lshlrev_b32 v90, 16, v82
    v_and_b32 v98, 0xffff0000, v82
    v_sub_f32 v82, v90, v98
    v_cvt_pk_bf16_f32 v82, v82, v82
    v_lshlrev_b32 v82, 16, v82
    v_lshlrev_b32 v90, 16, v37
    v_add_f32 v82, v82, v90
    v_add_f32 v83, v83, v91
    v_add_f32 v99, v99, v107
    v_cvt_pk_bf16_f32 v83, v83, v99
    v_lshlrev_b32 v91, 16, v83
    v_and_b32 v99, 0xffff0000, v83
    v_sub_f32 v83, v91, v99
    v_cvt_pk_bf16_f32 v83, v83, v83
    v_lshlrev_b32 v83, 16, v83
    v_and_b32 v91, 0xffff0000, v37
    v_add_f32 v83, v83, v91
    v_add_f32 v84, v84, v92
    v_add_f32 v100, v100, v108
    v_cvt_pk_bf16_f32 v84, v84, v100
    v_lshlrev_b32 v92, 16, v84
    v_and_b32 v100, 0xffff0000, v84
    v_sub_f32 v84, v92, v100
    v_cvt_pk_bf16_f32 v84, v84, v84
    v_lshlrev_b32 v84, 16, v84
    v_lshlrev_b32 v92, 16, v38
    v_add_f32 v84, v84, v92
    v_add_f32 v85, v85, v93
    v_add_f32 v101, v101, v109
    v_cvt_pk_bf16_f32 v85, v85, v101
    v_lshlrev_b32 v93, 16, v85
    v_and_b32 v101, 0xffff0000, v85
    v_sub_f32 v85, v93, v101
    v_cvt_pk_bf16_f32 v85, v85, v85
    v_lshlrev_b32 v85, 16, v85
    v_and_b32 v93, 0xffff0000, v38
    v_add_f32 v85, v85, v93
    v_add_f32 v86, v86, v94
    v_add_f32 v102, v102, v110
    v_cvt_pk_bf16_f32 v86, v86, v102
    v_lshlrev_b32 v94, 16, v86
    v_and_b32 v102, 0xffff0000, v86
    v_sub_f32 v86, v94, v102
    v_cvt_pk_bf16_f32 v86, v86, v86
    v_lshlrev_b32 v86, 16, v86
    v_lshlrev_b32 v94, 16, v39
    v_add_f32 v86, v86, v94
    v_add_f32 v87, v87, v95
    v_add_f32 v103, v103, v111
    v_cvt_pk_bf16_f32 v87, v87, v103
    v_lshlrev_b32 v95, 16, v87
    v_and_b32 v103, 0xffff0000, v87
    v_sub_f32 v87, v95, v103
    v_cvt_pk_bf16_f32 v87, v87, v87
    v_lshlrev_b32 v87, 16, v87
    v_and_b32 v95, 0xffff0000, v39
    v_add_f32 v87, v87, v95
    v_cvt_pk_bf16_f32 v36, v80, v81
    v_cvt_pk_bf16_f32 v37, v82, v83
    v_cvt_pk_bf16_f32 v38, v84, v85
    v_cvt_pk_bf16_f32 v39, v86, v87
    s_waitcnt vmcnt(0)
    v_add_f32 v112, v112, v120
    v_add_f32 v128, v128, v136
    v_cvt_pk_bf16_f32 v112, v112, v128
    v_lshlrev_b32 v120, 16, v112
    v_and_b32 v128, 0xffff0000, v112
    v_sub_f32 v112, v120, v128
    v_cvt_pk_bf16_f32 v112, v112, v112
    v_lshlrev_b32 v112, 16, v112
    v_lshlrev_b32 v120, 16, v40
    v_add_f32 v112, v112, v120
    v_add_f32 v113, v113, v121
    v_add_f32 v129, v129, v137
    v_cvt_pk_bf16_f32 v113, v113, v129
    v_lshlrev_b32 v121, 16, v113
    v_and_b32 v129, 0xffff0000, v113
    v_sub_f32 v113, v121, v129
    v_cvt_pk_bf16_f32 v113, v113, v113
    v_lshlrev_b32 v113, 16, v113
    v_and_b32 v121, 0xffff0000, v40
    v_add_f32 v113, v113, v121
    v_add_f32 v114, v114, v122
    v_add_f32 v130, v130, v138
    v_cvt_pk_bf16_f32 v114, v114, v130
    v_lshlrev_b32 v122, 16, v114
    v_and_b32 v130, 0xffff0000, v114
    v_sub_f32 v114, v122, v130
    v_cvt_pk_bf16_f32 v114, v114, v114
    v_lshlrev_b32 v114, 16, v114
    v_lshlrev_b32 v122, 16, v41
    v_add_f32 v114, v114, v122
    v_add_f32 v115, v115, v123
    v_add_f32 v131, v131, v139
    v_cvt_pk_bf16_f32 v115, v115, v131
    v_lshlrev_b32 v123, 16, v115
    v_and_b32 v131, 0xffff0000, v115
    v_sub_f32 v115, v123, v131
    v_cvt_pk_bf16_f32 v115, v115, v115
    v_lshlrev_b32 v115, 16, v115
    v_and_b32 v123, 0xffff0000, v41
    v_add_f32 v115, v115, v123
    v_add_f32 v116, v116, v124
    v_add_f32 v132, v132, v140
    v_cvt_pk_bf16_f32 v116, v116, v132
    v_lshlrev_b32 v124, 16, v116
    v_and_b32 v132, 0xffff0000, v116
    v_sub_f32 v116, v124, v132
    v_cvt_pk_bf16_f32 v116, v116, v116
    v_lshlrev_b32 v116, 16, v116
    v_lshlrev_b32 v124, 16, v42
    v_add_f32 v116, v116, v124
    v_add_f32 v117, v117, v125
    v_add_f32 v133, v133, v141
    v_cvt_pk_bf16_f32 v117, v117, v133
    v_lshlrev_b32 v125, 16, v117
    v_and_b32 v133, 0xffff0000, v117
    v_sub_f32 v117, v125, v133
    v_cvt_pk_bf16_f32 v117, v117, v117
    v_lshlrev_b32 v117, 16, v117
    v_and_b32 v125, 0xffff0000, v42
    v_add_f32 v117, v117, v125
    v_add_f32 v118, v118, v126
    v_add_f32 v134, v134, v142
    v_cvt_pk_bf16_f32 v118, v118, v134
    v_lshlrev_b32 v126, 16, v118
    v_and_b32 v134, 0xffff0000, v118
    v_sub_f32 v118, v126, v134
    v_cvt_pk_bf16_f32 v118, v118, v118
    v_lshlrev_b32 v118, 16, v118
    v_lshlrev_b32 v126, 16, v43
    v_add_f32 v118, v118, v126
    v_add_f32 v119, v119, v127
    v_add_f32 v135, v135, v143
    v_cvt_pk_bf16_f32 v119, v119, v135
    v_lshlrev_b32 v127, 16, v119
    v_and_b32 v135, 0xffff0000, v119
    v_sub_f32 v119, v127, v135
    v_cvt_pk_bf16_f32 v119, v119, v119
    v_lshlrev_b32 v119, 16, v119
    v_and_b32 v127, 0xffff0000, v43
    v_add_f32 v119, v119, v127
    v_cvt_pk_bf16_f32 v40, v112, v113
    v_cvt_pk_bf16_f32 v41, v114, v115
    v_cvt_pk_bf16_f32 v42, v116, v117
    v_cvt_pk_bf16_f32 v43, v118, v119
    buffer_store_dwordx4 v[8:11], v5, s[36:39], 0 offen offset:0
    buffer_store_dwordx4 v[12:15], v5, s[36:39], 0 offen offset:128
    buffer_store_dwordx4 v[16:19], v5, s[36:39], 0 offen offset:256
    buffer_store_dwordx4 v[20:23], v5, s[36:39], 0 offen offset:384
    buffer_store_dwordx4 v[24:27], v5, s[36:39], 0 offen offset:512
    buffer_store_dwordx4 v[28:31], v5, s[36:39], 0 offen offset:640
    buffer_store_dwordx4 v[32:35], v5, s[36:39], 0 offen offset:768
    buffer_store_dwordx4 v[36:39], v5, s[36:39], 0 offen offset:896
    buffer_store_dwordx4 v[40:43], v5, s[36:39], 0 offen offset:1024
    s_waitcnt vmcnt(0)
    buffer_load_dwordx4 v[8:11], v5, s[36:39], 0 offen offset:0
    buffer_load_dwordx4 v[12:15], v5, s[36:39], 0 offen offset:128
    buffer_load_dwordx4 v[16:19], v5, s[36:39], 0 offen offset:256
    buffer_load_dwordx4 v[20:23], v5, s[36:39], 0 offen offset:384
    buffer_load_dwordx4 v[24:27], v5, s[36:39], 0 offen offset:512
    buffer_load_dwordx4 v[28:31], v5, s[36:39], 0 offen offset:640
    buffer_load_dwordx4 v[32:35], v5, s[36:39], 0 offen offset:768
    buffer_load_dwordx4 v[36:39], v5, s[36:39], 0 offen offset:896
    buffer_load_dwordx4 v[40:43], v5, s[36:39], 0 offen offset:1024
    s_waitcnt vmcnt(0)
    v_lshlrev_b32 v44, 16, v8
    v_and_b32 v45, 0xffff0000, v8
    v_lshlrev_b32 v46, 16, v9
    v_and_b32 v47, 0xffff0000, v9
    v_lshlrev_b32 v48, 16, v10
    v_and_b32 v49, 0xffff0000, v10
    v_lshlrev_b32 v50, 16, v11
    v_and_b32 v51, 0xffff0000, v11
    v_lshlrev_b32 v52, 16, v12
    v_and_b32 v53, 0xffff0000, v12
    v_lshlrev_b32 v54, 16, v13
    v_and_b32 v55, 0xffff0000, v13
    v_lshlrev_b32 v56, 16, v14
    v_and_b32 v57, 0xffff0000, v14
    v_lshlrev_b32 v58, 16, v15
    v_and_b32 v59, 0xffff0000, v15
    v_lshlrev_b32 v60, 16, v16
    v_and_b32 v61, 0xffff0000, v16
    v_lshlrev_b32 v62, 16, v17
    v_and_b32 v63, 0xffff0000, v17
    v_lshlrev_b32 v64, 16, v18
    v_and_b32 v65, 0xffff0000, v18
    v_lshlrev_b32 v66, 16, v19
    v_and_b32 v67, 0xffff0000, v19
    v_lshlrev_b32 v68, 16, v20
    v_and_b32 v69, 0xffff0000, v20
    v_lshlrev_b32 v70, 16, v21
    v_and_b32 v71, 0xffff0000, v21
    v_lshlrev_b32 v72, 16, v22
    v_and_b32 v73, 0xffff0000, v22
    v_lshlrev_b32 v74, 16, v23
    v_and_b32 v75, 0xffff0000, v23
    v_lshlrev_b32 v76, 16, v24
    v_and_b32 v77, 0xffff0000, v24
    v_lshlrev_b32 v78, 16, v25
    v_and_b32 v79, 0xffff0000, v25
    v_lshlrev_b32 v80, 16, v26
    v_and_b32 v81, 0xffff0000, v26
    v_lshlrev_b32 v82, 16, v27
    v_and_b32 v83, 0xffff0000, v27
    v_lshlrev_b32 v84, 16, v28
    v_and_b32 v85, 0xffff0000, v28
    v_lshlrev_b32 v86, 16, v29
    v_and_b32 v87, 0xffff0000, v29
    v_lshlrev_b32 v88, 16, v30
    v_and_b32 v89, 0xffff0000, v30
    v_lshlrev_b32 v90, 16, v31
    v_and_b32 v91, 0xffff0000, v31
    v_lshlrev_b32 v92, 16, v32
    v_and_b32 v93, 0xffff0000, v32
    v_lshlrev_b32 v94, 16, v33
    v_and_b32 v95, 0xffff0000, v33
    v_lshlrev_b32 v96, 16, v34
    v_and_b32 v97, 0xffff0000, v34
    v_lshlrev_b32 v98, 16, v35
    v_and_b32 v99, 0xffff0000, v35
    v_lshlrev_b32 v100, 16, v36
    v_and_b32 v101, 0xffff0000, v36
    v_lshlrev_b32 v102, 16, v37
    v_and_b32 v103, 0xffff0000, v37
    v_lshlrev_b32 v104, 16, v38
    v_and_b32 v105, 0xffff0000, v38
    v_lshlrev_b32 v106, 16, v39
    v_and_b32 v107, 0xffff0000, v39
    v_lshlrev_b32 v108, 16, v40
    v_and_b32 v109, 0xffff0000, v40
    v_lshlrev_b32 v110, 16, v41
    v_and_b32 v111, 0xffff0000, v41
    v_lshlrev_b32 v112, 16, v42
    v_and_b32 v113, 0xffff0000, v42
    v_lshlrev_b32 v114, 16, v43
    v_and_b32 v115, 0xffff0000, v43
    v_add_f32 v116, v44, v45
    v_add_f32 v116, v116, v46
    v_add_f32 v116, v116, v47
    v_add_f32 v116, v116, v48
    v_add_f32 v116, v116, v49
    v_add_f32 v116, v116, v50
    v_add_f32 v116, v116, v51
    v_add_f32 v116, v116, v52
    v_add_f32 v116, v116, v53
    v_add_f32 v116, v116, v54
    v_add_f32 v116, v116, v55
    v_add_f32 v116, v116, v56
    v_add_f32 v116, v116, v57
    v_add_f32 v116, v116, v58
    v_add_f32 v116, v116, v59
    v_add_f32 v116, v116, v60
    v_add_f32 v116, v116, v61
    v_add_f32 v116, v116, v62
    v_add_f32 v116, v116, v63
    v_add_f32 v116, v116, v64
    v_add_f32 v116, v116, v65
    v_add_f32 v116, v116, v66
    v_add_f32 v116, v116, v67
    v_add_f32 v116, v116, v68
    v_add_f32 v116, v116, v69
    v_add_f32 v116, v116, v70
    v_add_f32 v116, v116, v71
    v_add_f32 v116, v116, v72
    v_add_f32 v116, v116, v73
    v_add_f32 v116, v116, v74
    v_add_f32 v116, v116, v75
    v_add_f32 v116, v116, v76
    v_add_f32 v116, v116, v77
    v_add_f32 v116, v116, v78
    v_add_f32 v116, v116, v79
    v_add_f32 v116, v116, v80
    v_add_f32 v116, v116, v81
    v_add_f32 v116, v116, v82
    v_add_f32 v116, v116, v83
    v_add_f32 v116, v116, v84
    v_add_f32 v116, v116, v85
    v_add_f32 v116, v116, v86
    v_add_f32 v116, v116, v87
    v_add_f32 v116, v116, v88
    v_add_f32 v116, v116, v89
    v_add_f32 v116, v116, v90
    v_add_f32 v116, v116, v91
    v_add_f32 v116, v116, v92
    v_add_f32 v116, v116, v93
    v_add_f32 v116, v116, v94
    v_add_f32 v116, v116, v95
    v_add_f32 v116, v116, v96
    v_add_f32 v116, v116, v97
    v_add_f32 v116, v116, v98
    v_add_f32 v116, v116, v99
    v_add_f32 v116, v116, v100
    v_add_f32 v116, v116, v101
    v_add_f32 v116, v116, v102
    v_add_f32 v116, v116, v103
    v_add_f32 v116, v116, v104
    v_add_f32 v116, v116, v105
    v_add_f32 v116, v116, v106
    v_add_f32 v116, v116, v107
    v_add_f32 v116, v116, v108
    v_add_f32 v116, v116, v109
    v_add_f32 v116, v116, v110
    v_add_f32 v116, v116, v111
    v_add_f32 v116, v116, v112
    v_add_f32 v116, v116, v113
    v_add_f32 v116, v116, v114
    v_add_f32 v116, v116, v115
    s_nop 1
    v_add_f32_dpp v116, v116, v116 quad_perm:[1,0,3,2] row_mask:0xf bank_mask:0xf
    s_nop 1
    v_add_f32_dpp v116, v116, v116 quad_perm:[2,3,0,1] row_mask:0xf bank_mask:0xf
    s_nop 1
    v_add_f32_dpp v116, v116, v116 row_half_mirror row_mask:0xf bank_mask:0xf
    v_mul_f32 v118, 0x3ae38e39, v116
    v_sub_f32 v119, v44, v118
    v_mul_f32 v117, v119, v119
    v_sub_f32 v119, v45, v118
    v_fmac_f32 v117, v119, v119
    v_sub_f32 v119, v46, v118
    v_fmac_f32 v117, v119, v119
    v_sub_f32 v119, v47, v118
    v_fmac_f32 v117, v119, v119
    v_sub_f32 v119, v48, v118
    v_fmac_f32 v117, v119, v119
    v_sub_f32 v119, v49, v118
    v_fmac_f32 v117, v119, v119
    v_sub_f32 v119, v50, v118
    v_fmac_f32 v117, v119, v119
    v_sub_f32 v119, v51, v118
    v_fmac_f32 v117, v119, v119
    v_sub_f32 v119, v52, v118
    v_fmac_f32 v117, v119, v119
    v_sub_f32 v119, v53, v118
    v_fmac_f32 v117, v119, v119
    v_sub_f32 v119, v54, v118
    v_fmac_f32 v117, v119, v119
    v_sub_f32 v119, v55, v118
    v_fmac_f32 v117, v119, v119
    v_sub_f32 v119, v56, v118
    v_fmac_f32 v117, v119, v119
    v_sub_f32 v119, v57, v118
    v_fmac_f32 v117, v119, v119
    v_sub_f32 v119, v58, v118
    v_fmac_f32 v117, v119, v119
    v_sub_f32 v119, v59, v118
    v_fmac_f32 v117, v119, v119
    v_sub_f32 v119, v60, v118
    v_fmac_f32 v117, v119, v119
    v_sub_f32 v119, v61, v118
    v_fmac_f32 v117, v119, v119
    v_sub_f32 v119, v62, v118
    v_fmac_f32 v117, v119, v119
    v_sub_f32 v119, v63, v118
    v_fmac_f32 v117, v119, v119
    v_sub_f32 v119, v64, v118
    v_fmac_f32 v117, v119, v119
    v_sub_f32 v119, v65, v118
    v_fmac_f32 v117, v119, v119
    v_sub_f32 v119, v66, v118
    v_fmac_f32 v117, v119, v119
    v_sub_f32 v119, v67, v118
    v_fmac_f32 v117, v119, v119
    v_sub_f32 v119, v68, v118
    v_fmac_f32 v117, v119, v119
    v_sub_f32 v119, v69, v118
    v_fmac_f32 v117, v119, v119
    v_sub_f32 v119, v70, v118
    v_fmac_f32 v117, v119, v119
    v_sub_f32 v119, v71, v118
    v_fmac_f32 v117, v119, v119
    v_sub_f32 v119, v72, v118
    v_fmac_f32 v117, v119, v119
    v_sub_f32 v119, v73, v118
    v_fmac_f32 v117, v119, v119
    v_sub_f32 v119, v74, v118
    v_fmac_f32 v117, v119, v119
    v_sub_f32 v119, v75, v118
    v_fmac_f32 v117, v119, v119
    v_sub_f32 v119, v76, v118
    v_fmac_f32 v117, v119, v119
    v_sub_f32 v119, v77, v118
    v_fmac_f32 v117, v119, v119
    v_sub_f32 v119, v78, v118
    v_fmac_f32 v117, v119, v119
    v_sub_f32 v119, v79, v118
    v_fmac_f32 v117, v119, v119
    v_sub_f32 v119, v80, v118
    v_fmac_f32 v117, v119, v119
    v_sub_f32 v119, v81, v118
    v_fmac_f32 v117, v119, v119
    v_sub_f32 v119, v82, v118
    v_fmac_f32 v117, v119, v119
    v_sub_f32 v119, v83, v118
    v_fmac_f32 v117, v119, v119
    v_sub_f32 v119, v84, v118
    v_fmac_f32 v117, v119, v119
    v_sub_f32 v119, v85, v118
    v_fmac_f32 v117, v119, v119
    v_sub_f32 v119, v86, v118
    v_fmac_f32 v117, v119, v119
    v_sub_f32 v119, v87, v118
    v_fmac_f32 v117, v119, v119
    v_sub_f32 v119, v88, v118
    v_fmac_f32 v117, v119, v119
    v_sub_f32 v119, v89, v118
    v_fmac_f32 v117, v119, v119
    v_sub_f32 v119, v90, v118
    v_fmac_f32 v117, v119, v119
    v_sub_f32 v119, v91, v118
    v_fmac_f32 v117, v119, v119
    v_sub_f32 v119, v92, v118
    v_fmac_f32 v117, v119, v119
    v_sub_f32 v119, v93, v118
    v_fmac_f32 v117, v119, v119
    v_sub_f32 v119, v94, v118
    v_fmac_f32 v117, v119, v119
    v_sub_f32 v119, v95, v118
    v_fmac_f32 v117, v119, v119
    v_sub_f32 v119, v96, v118
    v_fmac_f32 v117, v119, v119
    v_sub_f32 v119, v97, v118
    v_fmac_f32 v117, v119, v119
    v_sub_f32 v119, v98, v118
    v_fmac_f32 v117, v119, v119
    v_sub_f32 v119, v99, v118
    v_fmac_f32 v117, v119, v119
    v_sub_f32 v119, v100, v118
    v_fmac_f32 v117, v119, v119
    v_sub_f32 v119, v101, v118
    v_fmac_f32 v117, v119, v119
    v_sub_f32 v119, v102, v118
    v_fmac_f32 v117, v119, v119
    v_sub_f32 v119, v103, v118
    v_fmac_f32 v117, v119, v119
    v_sub_f32 v119, v104, v118
    v_fmac_f32 v117, v119, v119
    v_sub_f32 v119, v105, v118
    v_fmac_f32 v117, v119, v119
    v_sub_f32 v119, v106, v118
    v_fmac_f32 v117, v119, v119
    v_sub_f32 v119, v107, v118
    v_fmac_f32 v117, v119, v119
    v_sub_f32 v119, v108, v118
    v_fmac_f32 v117, v119, v119
    v_sub_f32 v119, v109, v118
    v_fmac_f32 v117, v119, v119
    v_sub_f32 v119, v110, v118
    v_fmac_f32 v117, v119, v119
    v_sub_f32 v119, v111, v118
    v_fmac_f32 v117, v119, v119
    v_sub_f32 v119, v112, v118
    v_fmac_f32 v117, v119, v119
    v_sub_f32 v119, v113, v118
    v_fmac_f32 v117, v119, v119
    v_sub_f32 v119, v114, v118
    v_fmac_f32 v117, v119, v119
    v_sub_f32 v119, v115, v118
    v_fmac_f32 v117, v119, v119
    s_nop 1
    v_add_f32_dpp v117, v117, v117 quad_perm:[1,0,3,2] row_mask:0xf bank_mask:0xf
    s_nop 1
    v_add_f32_dpp v117, v117, v117 quad_perm:[2,3,0,1] row_mask:0xf bank_mask:0xf
    s_nop 1
    v_add_f32_dpp v117, v117, v117 row_half_mirror row_mask:0xf bank_mask:0xf
    v_mul_f32 v120, 0x3ae38e39, v117
    v_cvt_pk_bf16_f32 v121, v118, v120
    v_and_b32 v122, 0xffff0000, v121
    v_lshlrev_b32 v121, 16, v121
    v_add_f32 v122, 0x3727c5ac, v122
    v_cvt_pk_bf16_f32 v122, v122, v122
    v_lshlrev_b32 v122, 16, v122
    v_sqrt_f32 v122, v122
    s_nop 0
    v_cvt_pk_bf16_f32 v122, v122, v122
    v_lshlrev_b32 v122, 16, v122
    v_rcp_f32 v123, v122
    v_sub_f32 v44, v44, v121
    v_sub_f32 v45, v45, v121
    v_cvt_pk_bf16_f32 v8, v44, v45
    v_lshlrev_b32 v44, 16, v8
    v_and_b32 v45, 0xffff0000, v8
    v_mul_f32 v125, v44, v123
    v_fma_f32 v127, -v125, v122, v44
    v_fma_f32 v44, v127, v123, v125
    v_mul_f32 v126, v45, v123
    v_fma_f32 v128, -v126, v122, v45
    v_fma_f32 v45, v128, v123, v126
    v_cvt_pk_bf16_f32 v8, v44, v45
    v_sub_f32 v46, v46, v121
    v_sub_f32 v47, v47, v121
    v_cvt_pk_bf16_f32 v9, v46, v47
    v_lshlrev_b32 v46, 16, v9
    v_and_b32 v47, 0xffff0000, v9
    v_mul_f32 v125, v46, v123
    v_fma_f32 v127, -v125, v122, v46
    v_fma_f32 v46, v127, v123, v125
    v_mul_f32 v126, v47, v123
    v_fma_f32 v128, -v126, v122, v47
    v_fma_f32 v47, v128, v123, v126
    v_cvt_pk_bf16_f32 v9, v46, v47
    v_sub_f32 v48, v48, v121
    v_sub_f32 v49, v49, v121
    v_cvt_pk_bf16_f32 v10, v48, v49
    v_lshlrev_b32 v48, 16, v10
    v_and_b32 v49, 0xffff0000, v10
    v_mul_f32 v125, v48, v123
    v_fma_f32 v127, -v125, v122, v48
    v_fma_f32 v48, v127, v123, v125
    v_mul_f32 v126, v49, v123
    v_fma_f32 v128, -v126, v122, v49
    v_fma_f32 v49, v128, v123, v126
    v_cvt_pk_bf16_f32 v10, v48, v49
    v_sub_f32 v50, v50, v121
    v_sub_f32 v51, v51, v121
    v_cvt_pk_bf16_f32 v11, v50, v51
    v_lshlrev_b32 v50, 16, v11
    v_and_b32 v51, 0xffff0000, v11
    v_mul_f32 v125, v50, v123
    v_fma_f32 v127, -v125, v122, v50
    v_fma_f32 v50, v127, v123, v125
    v_mul_f32 v126, v51, v123
    v_fma_f32 v128, -v126, v122, v51
    v_fma_f32 v51, v128, v123, v126
    v_cvt_pk_bf16_f32 v11, v50, v51
    v_sub_f32 v52, v52, v121
    v_sub_f32 v53, v53, v121
    v_cvt_pk_bf16_f32 v12, v52, v53
    v_lshlrev_b32 v52, 16, v12
    v_and_b32 v53, 0xffff0000, v12
    v_mul_f32 v125, v52, v123
    v_fma_f32 v127, -v125, v122, v52
    v_fma_f32 v52, v127, v123, v125
    v_mul_f32 v126, v53, v123
    v_fma_f32 v128, -v126, v122, v53
    v_fma_f32 v53, v128, v123, v126
    v_cvt_pk_bf16_f32 v12, v52, v53
    v_sub_f32 v54, v54, v121
    v_sub_f32 v55, v55, v121
    v_cvt_pk_bf16_f32 v13, v54, v55
    v_lshlrev_b32 v54, 16, v13
    v_and_b32 v55, 0xffff0000, v13
    v_mul_f32 v125, v54, v123
    v_fma_f32 v127, -v125, v122, v54
    v_fma_f32 v54, v127, v123, v125
    v_mul_f32 v126, v55, v123
    v_fma_f32 v128, -v126, v122, v55
    v_fma_f32 v55, v128, v123, v126
    v_cvt_pk_bf16_f32 v13, v54, v55
    v_sub_f32 v56, v56, v121
    v_sub_f32 v57, v57, v121
    v_cvt_pk_bf16_f32 v14, v56, v57
    v_lshlrev_b32 v56, 16, v14
    v_and_b32 v57, 0xffff0000, v14
    v_mul_f32 v125, v56, v123
    v_fma_f32 v127, -v125, v122, v56
    v_fma_f32 v56, v127, v123, v125
    v_mul_f32 v126, v57, v123
    v_fma_f32 v128, -v126, v122, v57
    v_fma_f32 v57, v128, v123, v126
    v_cvt_pk_bf16_f32 v14, v56, v57
    v_sub_f32 v58, v58, v121
    v_sub_f32 v59, v59, v121
    v_cvt_pk_bf16_f32 v15, v58, v59
    v_lshlrev_b32 v58, 16, v15
    v_and_b32 v59, 0xffff0000, v15
    v_mul_f32 v125, v58, v123
    v_fma_f32 v127, -v125, v122, v58
    v_fma_f32 v58, v127, v123, v125
    v_mul_f32 v126, v59, v123
    v_fma_f32 v128, -v126, v122, v59
    v_fma_f32 v59, v128, v123, v126
    v_cvt_pk_bf16_f32 v15, v58, v59
    v_sub_f32 v60, v60, v121
    v_sub_f32 v61, v61, v121
    v_cvt_pk_bf16_f32 v16, v60, v61
    v_lshlrev_b32 v60, 16, v16
    v_and_b32 v61, 0xffff0000, v16
    v_mul_f32 v125, v60, v123
    v_fma_f32 v127, -v125, v122, v60
    v_fma_f32 v60, v127, v123, v125
    v_mul_f32 v126, v61, v123
    v_fma_f32 v128, -v126, v122, v61
    v_fma_f32 v61, v128, v123, v126
    v_cvt_pk_bf16_f32 v16, v60, v61
    v_sub_f32 v62, v62, v121
    v_sub_f32 v63, v63, v121
    v_cvt_pk_bf16_f32 v17, v62, v63
    v_lshlrev_b32 v62, 16, v17
    v_and_b32 v63, 0xffff0000, v17
    v_mul_f32 v125, v62, v123
    v_fma_f32 v127, -v125, v122, v62
    v_fma_f32 v62, v127, v123, v125
    v_mul_f32 v126, v63, v123
    v_fma_f32 v128, -v126, v122, v63
    v_fma_f32 v63, v128, v123, v126
    v_cvt_pk_bf16_f32 v17, v62, v63
    v_sub_f32 v64, v64, v121
    v_sub_f32 v65, v65, v121
    v_cvt_pk_bf16_f32 v18, v64, v65
    v_lshlrev_b32 v64, 16, v18
    v_and_b32 v65, 0xffff0000, v18
    v_mul_f32 v125, v64, v123
    v_fma_f32 v127, -v125, v122, v64
    v_fma_f32 v64, v127, v123, v125
    v_mul_f32 v126, v65, v123
    v_fma_f32 v128, -v126, v122, v65
    v_fma_f32 v65, v128, v123, v126
    v_cvt_pk_bf16_f32 v18, v64, v65
    v_sub_f32 v66, v66, v121
    v_sub_f32 v67, v67, v121
    v_cvt_pk_bf16_f32 v19, v66, v67
    v_lshlrev_b32 v66, 16, v19
    v_and_b32 v67, 0xffff0000, v19
    v_mul_f32 v125, v66, v123
    v_fma_f32 v127, -v125, v122, v66
    v_fma_f32 v66, v127, v123, v125
    v_mul_f32 v126, v67, v123
    v_fma_f32 v128, -v126, v122, v67
    v_fma_f32 v67, v128, v123, v126
    v_cvt_pk_bf16_f32 v19, v66, v67
    v_sub_f32 v68, v68, v121
    v_sub_f32 v69, v69, v121
    v_cvt_pk_bf16_f32 v20, v68, v69
    v_lshlrev_b32 v68, 16, v20
    v_and_b32 v69, 0xffff0000, v20
    v_mul_f32 v125, v68, v123
    v_fma_f32 v127, -v125, v122, v68
    v_fma_f32 v68, v127, v123, v125
    v_mul_f32 v126, v69, v123
    v_fma_f32 v128, -v126, v122, v69
    v_fma_f32 v69, v128, v123, v126
    v_cvt_pk_bf16_f32 v20, v68, v69
    v_sub_f32 v70, v70, v121
    v_sub_f32 v71, v71, v121
    v_cvt_pk_bf16_f32 v21, v70, v71
    v_lshlrev_b32 v70, 16, v21
    v_and_b32 v71, 0xffff0000, v21
    v_mul_f32 v125, v70, v123
    v_fma_f32 v127, -v125, v122, v70
    v_fma_f32 v70, v127, v123, v125
    v_mul_f32 v126, v71, v123
    v_fma_f32 v128, -v126, v122, v71
    v_fma_f32 v71, v128, v123, v126
    v_cvt_pk_bf16_f32 v21, v70, v71
    v_sub_f32 v72, v72, v121
    v_sub_f32 v73, v73, v121
    v_cvt_pk_bf16_f32 v22, v72, v73
    v_lshlrev_b32 v72, 16, v22
    v_and_b32 v73, 0xffff0000, v22
    v_mul_f32 v125, v72, v123
    v_fma_f32 v127, -v125, v122, v72
    v_fma_f32 v72, v127, v123, v125
    v_mul_f32 v126, v73, v123
    v_fma_f32 v128, -v126, v122, v73
    v_fma_f32 v73, v128, v123, v126
    v_cvt_pk_bf16_f32 v22, v72, v73
    v_sub_f32 v74, v74, v121
    v_sub_f32 v75, v75, v121
    v_cvt_pk_bf16_f32 v23, v74, v75
    v_lshlrev_b32 v74, 16, v23
    v_and_b32 v75, 0xffff0000, v23
    v_mul_f32 v125, v74, v123
    v_fma_f32 v127, -v125, v122, v74
    v_fma_f32 v74, v127, v123, v125
    v_mul_f32 v126, v75, v123
    v_fma_f32 v128, -v126, v122, v75
    v_fma_f32 v75, v128, v123, v126
    v_cvt_pk_bf16_f32 v23, v74, v75
    v_sub_f32 v76, v76, v121
    v_sub_f32 v77, v77, v121
    v_cvt_pk_bf16_f32 v24, v76, v77
    v_lshlrev_b32 v76, 16, v24
    v_and_b32 v77, 0xffff0000, v24
    v_mul_f32 v125, v76, v123
    v_fma_f32 v127, -v125, v122, v76
    v_fma_f32 v76, v127, v123, v125
    v_mul_f32 v126, v77, v123
    v_fma_f32 v128, -v126, v122, v77
    v_fma_f32 v77, v128, v123, v126
    v_cvt_pk_bf16_f32 v24, v76, v77
    v_sub_f32 v78, v78, v121
    v_sub_f32 v79, v79, v121
    v_cvt_pk_bf16_f32 v25, v78, v79
    v_lshlrev_b32 v78, 16, v25
    v_and_b32 v79, 0xffff0000, v25
    v_mul_f32 v125, v78, v123
    v_fma_f32 v127, -v125, v122, v78
    v_fma_f32 v78, v127, v123, v125
    v_mul_f32 v126, v79, v123
    v_fma_f32 v128, -v126, v122, v79
    v_fma_f32 v79, v128, v123, v126
    v_cvt_pk_bf16_f32 v25, v78, v79
    v_sub_f32 v80, v80, v121
    v_sub_f32 v81, v81, v121
    v_cvt_pk_bf16_f32 v26, v80, v81
    v_lshlrev_b32 v80, 16, v26
    v_and_b32 v81, 0xffff0000, v26
    v_mul_f32 v125, v80, v123
    v_fma_f32 v127, -v125, v122, v80
    v_fma_f32 v80, v127, v123, v125
    v_mul_f32 v126, v81, v123
    v_fma_f32 v128, -v126, v122, v81
    v_fma_f32 v81, v128, v123, v126
    v_cvt_pk_bf16_f32 v26, v80, v81
    v_sub_f32 v82, v82, v121
    v_sub_f32 v83, v83, v121
    v_cvt_pk_bf16_f32 v27, v82, v83
    v_lshlrev_b32 v82, 16, v27
    v_and_b32 v83, 0xffff0000, v27
    v_mul_f32 v125, v82, v123
    v_fma_f32 v127, -v125, v122, v82
    v_fma_f32 v82, v127, v123, v125
    v_mul_f32 v126, v83, v123
    v_fma_f32 v128, -v126, v122, v83
    v_fma_f32 v83, v128, v123, v126
    v_cvt_pk_bf16_f32 v27, v82, v83
    v_sub_f32 v84, v84, v121
    v_sub_f32 v85, v85, v121
    v_cvt_pk_bf16_f32 v28, v84, v85
    v_lshlrev_b32 v84, 16, v28
    v_and_b32 v85, 0xffff0000, v28
    v_mul_f32 v125, v84, v123
    v_fma_f32 v127, -v125, v122, v84
    v_fma_f32 v84, v127, v123, v125
    v_mul_f32 v126, v85, v123
    v_fma_f32 v128, -v126, v122, v85
    v_fma_f32 v85, v128, v123, v126
    v_cvt_pk_bf16_f32 v28, v84, v85
    v_sub_f32 v86, v86, v121
    v_sub_f32 v87, v87, v121
    v_cvt_pk_bf16_f32 v29, v86, v87
    v_lshlrev_b32 v86, 16, v29
    v_and_b32 v87, 0xffff0000, v29
    v_mul_f32 v125, v86, v123
    v_fma_f32 v127, -v125, v122, v86
    v_fma_f32 v86, v127, v123, v125
    v_mul_f32 v126, v87, v123
    v_fma_f32 v128, -v126, v122, v87
    v_fma_f32 v87, v128, v123, v126
    v_cvt_pk_bf16_f32 v29, v86, v87
    v_sub_f32 v88, v88, v121
    v_sub_f32 v89, v89, v121
    v_cvt_pk_bf16_f32 v30, v88, v89
    v_lshlrev_b32 v88, 16, v30
    v_and_b32 v89, 0xffff0000, v30
    v_mul_f32 v125, v88, v123
    v_fma_f32 v127, -v125, v122, v88
    v_fma_f32 v88, v127, v123, v125
    v_mul_f32 v126, v89, v123
    v_fma_f32 v128, -v126, v122, v89
    v_fma_f32 v89, v128, v123, v126
    v_cvt_pk_bf16_f32 v30, v88, v89
    v_sub_f32 v90, v90, v121
    v_sub_f32 v91, v91, v121
    v_cvt_pk_bf16_f32 v31, v90, v91
    v_lshlrev_b32 v90, 16, v31
    v_and_b32 v91, 0xffff0000, v31
    v_mul_f32 v125, v90, v123
    v_fma_f32 v127, -v125, v122, v90
    v_fma_f32 v90, v127, v123, v125
    v_mul_f32 v126, v91, v123
    v_fma_f32 v128, -v126, v122, v91
    v_fma_f32 v91, v128, v123, v126
    v_cvt_pk_bf16_f32 v31, v90, v91
    v_sub_f32 v92, v92, v121
    v_sub_f32 v93, v93, v121
    v_cvt_pk_bf16_f32 v32, v92, v93
    v_lshlrev_b32 v92, 16, v32
    v_and_b32 v93, 0xffff0000, v32
    v_mul_f32 v125, v92, v123
    v_fma_f32 v127, -v125, v122, v92
    v_fma_f32 v92, v127, v123, v125
    v_mul_f32 v126, v93, v123
    v_fma_f32 v128, -v126, v122, v93
    v_fma_f32 v93, v128, v123, v126
    v_cvt_pk_bf16_f32 v32, v92, v93
    v_sub_f32 v94, v94, v121
    v_sub_f32 v95, v95, v121
    v_cvt_pk_bf16_f32 v33, v94, v95
    v_lshlrev_b32 v94, 16, v33
    v_and_b32 v95, 0xffff0000, v33
    v_mul_f32 v125, v94, v123
    v_fma_f32 v127, -v125, v122, v94
    v_fma_f32 v94, v127, v123, v125
    v_mul_f32 v126, v95, v123
    v_fma_f32 v128, -v126, v122, v95
    v_fma_f32 v95, v128, v123, v126
    v_cvt_pk_bf16_f32 v33, v94, v95
    v_sub_f32 v96, v96, v121
    v_sub_f32 v97, v97, v121
    v_cvt_pk_bf16_f32 v34, v96, v97
    v_lshlrev_b32 v96, 16, v34
    v_and_b32 v97, 0xffff0000, v34
    v_mul_f32 v125, v96, v123
    v_fma_f32 v127, -v125, v122, v96
    v_fma_f32 v96, v127, v123, v125
    v_mul_f32 v126, v97, v123
    v_fma_f32 v128, -v126, v122, v97
    v_fma_f32 v97, v128, v123, v126
    v_cvt_pk_bf16_f32 v34, v96, v97
    v_sub_f32 v98, v98, v121
    v_sub_f32 v99, v99, v121
    v_cvt_pk_bf16_f32 v35, v98, v99
    v_lshlrev_b32 v98, 16, v35
    v_and_b32 v99, 0xffff0000, v35
    v_mul_f32 v125, v98, v123
    v_fma_f32 v127, -v125, v122, v98
    v_fma_f32 v98, v127, v123, v125
    v_mul_f32 v126, v99, v123
    v_fma_f32 v128, -v126, v122, v99
    v_fma_f32 v99, v128, v123, v126
    v_cvt_pk_bf16_f32 v35, v98, v99
    v_sub_f32 v100, v100, v121
    v_sub_f32 v101, v101, v121
    v_cvt_pk_bf16_f32 v36, v100, v101
    v_lshlrev_b32 v100, 16, v36
    v_and_b32 v101, 0xffff0000, v36
    v_mul_f32 v125, v100, v123
    v_fma_f32 v127, -v125, v122, v100
    v_fma_f32 v100, v127, v123, v125
    v_mul_f32 v126, v101, v123
    v_fma_f32 v128, -v126, v122, v101
    v_fma_f32 v101, v128, v123, v126
    v_cvt_pk_bf16_f32 v36, v100, v101
    v_sub_f32 v102, v102, v121
    v_sub_f32 v103, v103, v121
    v_cvt_pk_bf16_f32 v37, v102, v103
    v_lshlrev_b32 v102, 16, v37
    v_and_b32 v103, 0xffff0000, v37
    v_mul_f32 v125, v102, v123
    v_fma_f32 v127, -v125, v122, v102
    v_fma_f32 v102, v127, v123, v125
    v_mul_f32 v126, v103, v123
    v_fma_f32 v128, -v126, v122, v103
    v_fma_f32 v103, v128, v123, v126
    v_cvt_pk_bf16_f32 v37, v102, v103
    v_sub_f32 v104, v104, v121
    v_sub_f32 v105, v105, v121
    v_cvt_pk_bf16_f32 v38, v104, v105
    v_lshlrev_b32 v104, 16, v38
    v_and_b32 v105, 0xffff0000, v38
    v_mul_f32 v125, v104, v123
    v_fma_f32 v127, -v125, v122, v104
    v_fma_f32 v104, v127, v123, v125
    v_mul_f32 v126, v105, v123
    v_fma_f32 v128, -v126, v122, v105
    v_fma_f32 v105, v128, v123, v126
    v_cvt_pk_bf16_f32 v38, v104, v105
    v_sub_f32 v106, v106, v121
    v_sub_f32 v107, v107, v121
    v_cvt_pk_bf16_f32 v39, v106, v107
    v_lshlrev_b32 v106, 16, v39
    v_and_b32 v107, 0xffff0000, v39
    v_mul_f32 v125, v106, v123
    v_fma_f32 v127, -v125, v122, v106
    v_fma_f32 v106, v127, v123, v125
    v_mul_f32 v126, v107, v123
    v_fma_f32 v128, -v126, v122, v107
    v_fma_f32 v107, v128, v123, v126
    v_cvt_pk_bf16_f32 v39, v106, v107
    v_sub_f32 v108, v108, v121
    v_sub_f32 v109, v109, v121
    v_cvt_pk_bf16_f32 v40, v108, v109
    v_lshlrev_b32 v108, 16, v40
    v_and_b32 v109, 0xffff0000, v40
    v_mul_f32 v125, v108, v123
    v_fma_f32 v127, -v125, v122, v108
    v_fma_f32 v108, v127, v123, v125
    v_mul_f32 v126, v109, v123
    v_fma_f32 v128, -v126, v122, v109
    v_fma_f32 v109, v128, v123, v126
    v_cvt_pk_bf16_f32 v40, v108, v109
    v_sub_f32 v110, v110, v121
    v_sub_f32 v111, v111, v121
    v_cvt_pk_bf16_f32 v41, v110, v111
    v_lshlrev_b32 v110, 16, v41
    v_and_b32 v111, 0xffff0000, v41
    v_mul_f32 v125, v110, v123
    v_fma_f32 v127, -v125, v122, v110
    v_fma_f32 v110, v127, v123, v125
    v_mul_f32 v126, v111, v123
    v_fma_f32 v128, -v126, v122, v111
    v_fma_f32 v111, v128, v123, v126
    v_cvt_pk_bf16_f32 v41, v110, v111
    v_sub_f32 v112, v112, v121
    v_sub_f32 v113, v113, v121
    v_cvt_pk_bf16_f32 v42, v112, v113
    v_lshlrev_b32 v112, 16, v42
    v_and_b32 v113, 0xffff0000, v42
    v_mul_f32 v125, v112, v123
    v_fma_f32 v127, -v125, v122, v112
    v_fma_f32 v112, v127, v123, v125
    v_mul_f32 v126, v113, v123
    v_fma_f32 v128, -v126, v122, v113
    v_fma_f32 v113, v128, v123, v126
    v_cvt_pk_bf16_f32 v42, v112, v113
    v_sub_f32 v114, v114, v121
    v_sub_f32 v115, v115, v121
    v_cvt_pk_bf16_f32 v43, v114, v115
    v_lshlrev_b32 v114, 16, v43
    v_and_b32 v115, 0xffff0000, v43
    v_mul_f32 v125, v114, v123
    v_fma_f32 v127, -v125, v122, v114
    v_fma_f32 v114, v127, v123, v125
    v_mul_f32 v126, v115, v123
    v_fma_f32 v128, -v126, v122, v115
    v_fma_f32 v115, v128, v123, v126
    v_cvt_pk_bf16_f32 v43, v114, v115
    buffer_store_dwordx4 v[8:11], v5, s[44:47], 0 offen offset:0
    buffer_store_dwordx4 v[12:15], v5, s[44:47], 0 offen offset:128
    buffer_store_dwordx4 v[16:19], v5, s[44:47], 0 offen offset:256
    buffer_store_dwordx4 v[20:23], v5, s[44:47], 0 offen offset:384
    buffer_store_dwordx4 v[24:27], v5, s[44:47], 0 offen offset:512
    buffer_store_dwordx4 v[28:31], v5, s[44:47], 0 offen offset:640
    buffer_store_dwordx4 v[32:35], v5, s[44:47], 0 offen offset:768
    buffer_store_dwordx4 v[36:39], v5, s[44:47], 0 offen offset:896
    buffer_store_dwordx4 v[40:43], v5, s[44:47], 0 offen offset:1024
L_post1_kernel_end:
    s_endpgm
.globl op2_kernel
.p2align 8
.type op2_kernel,@function
op2_kernel:
    s_cmp_ge_u32 s2, 192
    s_cbranch_scc1 L_op2_kernel_end
    s_load_dwordx16 s[4:19], s[0:1], 0
    s_load_dwordx8 s[20:27], s[0:1], 64
    v_lshrrev_b32 v1, 6, v0
    s_nop 0
    v_readfirstlane_b32 s36, v1
    v_and_b32 v1, 63, v0
    s_lshl_b32 s37, s36, 10
    v_and_b32 v80, 15, v1
    v_lshlrev_b32 v80, 7, v80
    v_lshrrev_b32 v81, 4, v1
    v_and_b32 v82, 7, v1
    v_xor_b32 v81, v81, v82
    v_lshl_add_u32 v83, v81, 4, v80
    v_xor_b32 v84, 64, v83
    s_lshr_b32 s38, s36, 1
    s_and_b32 s39, s36, 1
    s_mul_i32 s40, s38, 4096
    s_mul_i32 s41, s39, 6144
    s_add_u32 s41, s41, 8192
    v_add_u32 v7, s40, v83
    v_add_u32 v8, s40, v84
    v_add_u32 v9, s41, v83
    v_add_u32 v10, s41, v84
    s_mov_b32 s42, s38
    s_mov_b32 s43, s39
    s_and_b32 s50, s2, 7
    s_lshr_b32 s51, s2, 3
    s_and_b32 s59, s51, 3
    s_lshl_b32 s50, s50, 2
    s_add_u32 s50, s50, s59
    s_lshr_b32 s52, s51, 2
    s_mov_b32 s51, s50
    s_lshl_b32 s53, s51, 6
    s_mul_i32 s54, s52, 96
    s_waitcnt lgkmcnt(0)
    s_add_u32 s60, s26, 0x1778000
    s_addc_u32 s61, s27, 0
    s_and_b32 s61, s61, 0xffff
    s_mov_b32 s62, 0x240000
    s_mov_b32 s63, 0x00020000
    s_mul_i32 s56, s42, 32
    s_add_u32 s56, s56, s53
    s_mul_i32 s57, s43, 48
    s_add_u32 s57, s57, s54
    v_lshrrev_b32 v80, 4, v1
    v_lshlrev_b32 v80, 2, v80
    v_add_u32 v80, s56, v80
    s_movk_i32 s58, 576
    v_mul_lo_u32 v80, v80, s58
    v_and_b32 v81, 15, v1
    v_add_u32 v80, v80, v81
    v_add_u32 v80, s57, v80
    v_lshlrev_b32 v84, 1, v80
    s_mov_b32 s58, 0
    buffer_load_ushort v85, v84, s[60:63], s58 offen offset:0
    buffer_load_ushort v89, v84, s[60:63], s58 offen offset:32
    buffer_load_ushort v93, v84, s[60:63], s58 offen offset:64
    s_mov_b32 s58, 1152
    buffer_load_ushort v86, v84, s[60:63], s58 offen offset:0
    buffer_load_ushort v90, v84, s[60:63], s58 offen offset:32
    buffer_load_ushort v94, v84, s[60:63], s58 offen offset:64
    s_mov_b32 s58, 2304
    buffer_load_ushort v87, v84, s[60:63], s58 offen offset:0
    buffer_load_ushort v91, v84, s[60:63], s58 offen offset:32
    buffer_load_ushort v95, v84, s[60:63], s58 offen offset:64
    s_mov_b32 s58, 3456
    buffer_load_ushort v88, v84, s[60:63], s58 offen offset:0
    buffer_load_ushort v92, v84, s[60:63], s58 offen offset:32
    buffer_load_ushort v96, v84, s[60:63], s58 offen offset:64
    s_mov_b32 s58, 18432
    buffer_load_ushort v97, v84, s[60:63], s58 offen offset:0
    buffer_load_ushort v101, v84, s[60:63], s58 offen offset:32
    buffer_load_ushort v105, v84, s[60:63], s58 offen offset:64
    s_mov_b32 s58, 19584
    buffer_load_ushort v98, v84, s[60:63], s58 offen offset:0
    buffer_load_ushort v102, v84, s[60:63], s58 offen offset:32
    buffer_load_ushort v106, v84, s[60:63], s58 offen offset:64
    s_mov_b32 s58, 20736
    buffer_load_ushort v99, v84, s[60:63], s58 offen offset:0
    buffer_load_ushort v103, v84, s[60:63], s58 offen offset:32
    buffer_load_ushort v107, v84, s[60:63], s58 offen offset:64
    s_mov_b32 s58, 21888
    buffer_load_ushort v100, v84, s[60:63], s58 offen offset:0
    buffer_load_ushort v104, v84, s[60:63], s58 offen offset:32
    buffer_load_ushort v108, v84, s[60:63], s58 offen offset:64
    s_add_u32 s28, s26, 0x12f8000
    s_addc_u32 s29, s27, 0
    s_and_b32 s29, s29, 0xffff
    s_mov_b32 s30, 0x240000
    s_mov_b32 s31, 0x00020000
    s_add_u32 s32, s26, 0x1e6000
    s_addc_u32 s33, s27, 0
    s_and_b32 s33, s33, 0xffff
    s_mov_b32 s34, 0xa2000
    s_mov_b32 s35, 0x00020000
    v_lshrrev_b32 v80, 3, v1
    v_and_b32 v81, 7, v1
    v_xor_b32 v81, v81, v80
    v_lshlrev_b32 v81, 4, v81
    s_lshl_b32 s44, s36, 3
    v_add_u32 v80, s44, v80
    s_mov_b32 s45, 1152
    s_mov_b32 s46, 1152
    v_add_u32 v82, 0, v80
    v_add_u32 v82, s53, v82
    v_mul_lo_u32 v82, v82, s45
    v_add_u32 v2, v82, v81
    v_add_u32 v82, 32, v80
    v_add_u32 v82, s53, v82
    v_mul_lo_u32 v82, v82, s45
    v_add_u32 v3, v82, v81
    v_add_u32 v82, 0, v80
    v_add_u32 v82, s54, v82
    v_mul_lo_u32 v82, v82, s46
    v_add_u32 v4, v82, v81
    v_add_u32 v82, 32, v80
    v_add_u32 v82, s54, v82
    v_mul_lo_u32 v82, v82, s46
    v_add_u32 v5, v82, v81
    v_add_u32 v82, 64, v80
    v_add_u32 v82, s54, v82
    v_mul_lo_u32 v82, v82, s46
    v_add_u32 v6, v82, v81
    v_mov_b32 v56, 0
    v_mov_b32 v57, 0
    v_mov_b32 v58, 0
    v_mov_b32 v59, 0
    v_mov_b32 v60, 0
    v_mov_b32 v61, 0
    v_mov_b32 v62, 0
    v_mov_b32 v63, 0
    v_mov_b32 v64, 0
    v_mov_b32 v65, 0
    v_mov_b32 v66, 0
    v_mov_b32 v67, 0
    v_mov_b32 v68, 0
    v_mov_b32 v69, 0
    v_mov_b32 v70, 0
    v_mov_b32 v71, 0
    v_mov_b32 v72, 0
    v_mov_b32 v73, 0
    v_mov_b32 v74, 0
    v_mov_b32 v75, 0
    v_mov_b32 v76, 0
    v_mov_b32 v77, 0
    v_mov_b32 v78, 0
    v_mov_b32 v79, 0
    s_mov_b32 s47, 0
    s_mov_b32 s48, 0
    s_add_u32 m0, s37, 0
    s_nop 0
    buffer_load_dwordx4 v2, s[28:31], s47 offen lds
    s_add_u32 m0, s37, 4096
    s_nop 0
    buffer_load_dwordx4 v3, s[28:31], s47 offen lds
    s_add_u32 m0, s37, 8192
    s_nop 0
    buffer_load_dwordx4 v4, s[32:35], s48 offen lds
    s_add_u32 m0, s37, 12288
    s_nop 0
    buffer_load_dwordx4 v5, s[32:35], s48 offen lds
    s_add_u32 m0, s37, 16384
    s_nop 0
    buffer_load_dwordx4 v6, s[32:35], s48 offen lds
    s_add_u32 s47, s47, 128
    s_add_u32 s48, s48, 128
    s_add_u32 m0, s37, 20480
    s_nop 0
    buffer_load_dwordx4 v2, s[28:31], s47 offen lds
    s_add_u32 m0, s37, 24576
    s_nop 0
    buffer_load_dwordx4 v3, s[28:31], s47 offen lds
    s_add_u32 m0, s37, 28672
    s_nop 0
    buffer_load_dwordx4 v4, s[32:35], s48 offen lds
    s_add_u32 m0, s37, 32768
    s_nop 0
    buffer_load_dwordx4 v5, s[32:35], s48 offen lds
    s_add_u32 m0, s37, 36864
    s_nop 0
    buffer_load_dwordx4 v6, s[32:35], s48 offen lds
    s_add_u32 s47, s47, 128
    s_add_u32 s48, s48, 128
    s_mov_b32 s49, 2
L_op2_kernel_loop:
    s_waitcnt vmcnt(5)
    s_barrier
    s_add_u32 m0, s37, 40960
    s_nop 0
    buffer_load_dwordx4 v2, s[28:31], s47 offen lds
    s_add_u32 m0, s37, 45056
    s_nop 0
    buffer_load_dwordx4 v3, s[28:31], s47 offen lds
    s_add_u32 m0, s37, 49152
    s_nop 0
    buffer_load_dwordx4 v4, s[32:35], s48 offen lds
    s_add_u32 m0, s37, 53248
    s_nop 0
    buffer_load_dwordx4 v5, s[32:35], s48 offen lds
    s_add_u32 m0, s37, 57344
    s_nop 0
    buffer_load_dwordx4 v6, s[32:35], s48 offen lds
    s_add_u32 s47, s47, 128
    s_add_u32 s48, s48, 128
    ds_read_b128 v[16:19], v7 offset:0
    ds_read_b128 v[24:27], v7 offset:2048
    ds_read_b128 v[32:35], v9 offset:0
    ds_read_b128 v[40:43], v9 offset:2048
    ds_read_b128 v[48:51], v9 offset:4096
    ds_read_b128 v[20:23], v8 offset:0
    ds_read_b128 v[28:31], v8 offset:2048
    ds_read_b128 v[36:39], v10 offset:0
    ds_read_b128 v[44:47], v10 offset:2048
    ds_read_b128 v[52:55], v10 offset:4096
    s_waitcnt lgkmcnt(5)
    v_mfma_f32_16x16x32_bf16 v[56:59], v[16:19], v[32:35], v[56:59]
    v_mfma_f32_16x16x32_bf16 v[60:63], v[16:19], v[40:43], v[60:63]
    v_mfma_f32_16x16x32_bf16 v[64:67], v[16:19], v[48:51], v[64:67]
    v_mfma_f32_16x16x32_bf16 v[68:71], v[24:27], v[32:35], v[68:71]
    v_mfma_f32_16x16x32_bf16 v[72:75], v[24:27], v[40:43], v[72:75]
    v_mfma_f32_16x16x32_bf16 v[76:79], v[24:27], v[48:51], v[76:79]
    s_waitcnt lgkmcnt(0)
    v_mfma_f32_16x16x32_bf16 v[56:59], v[20:23], v[36:39], v[56:59]
    v_mfma_f32_16x16x32_bf16 v[60:63], v[20:23], v[44:47], v[60:63]
    v_mfma_f32_16x16x32_bf16 v[64:67], v[20:23], v[52:55], v[64:67]
    v_mfma_f32_16x16x32_bf16 v[68:71], v[28:31], v[36:39], v[68:71]
    v_mfma_f32_16x16x32_bf16 v[72:75], v[28:31], v[44:47], v[72:75]
    v_mfma_f32_16x16x32_bf16 v[76:79], v[28:31], v[52:55], v[76:79]
    s_waitcnt vmcnt(5)
    s_barrier
    s_add_u32 m0, s37, 0
    s_nop 0
    buffer_load_dwordx4 v2, s[28:31], s47 offen lds
    s_add_u32 m0, s37, 4096
    s_nop 0
    buffer_load_dwordx4 v3, s[28:31], s47 offen lds
    s_add_u32 m0, s37, 8192
    s_nop 0
    buffer_load_dwordx4 v4, s[32:35], s48 offen lds
    s_add_u32 m0, s37, 12288
    s_nop 0
    buffer_load_dwordx4 v5, s[32:35], s48 offen lds
    s_add_u32 m0, s37, 16384
    s_nop 0
    buffer_load_dwordx4 v6, s[32:35], s48 offen lds
    s_add_u32 s47, s47, 128
    s_add_u32 s48, s48, 128
    v_add_u32 v11, 20480, v7
    v_add_u32 v12, 20480, v8
    v_add_u32 v13, 20480, v9
    v_add_u32 v14, 20480, v10
    ds_read_b128 v[16:19], v11 offset:0
    ds_read_b128 v[24:27], v11 offset:2048
    ds_read_b128 v[32:35], v13 offset:0
    ds_read_b128 v[40:43], v13 offset:2048
    ds_read_b128 v[48:51], v13 offset:4096
    ds_read_b128 v[20:23], v12 offset:0
    ds_read_b128 v[28:31], v12 offset:2048
    ds_read_b128 v[36:39], v14 offset:0
    ds_read_b128 v[44:47], v14 offset:2048
    ds_read_b128 v[52:55], v14 offset:4096
    s_waitcnt lgkmcnt(5)
    v_mfma_f32_16x16x32_bf16 v[56:59], v[16:19], v[32:35], v[56:59]
    v_mfma_f32_16x16x32_bf16 v[60:63], v[16:19], v[40:43], v[60:63]
    v_mfma_f32_16x16x32_bf16 v[64:67], v[16:19], v[48:51], v[64:67]
    v_mfma_f32_16x16x32_bf16 v[68:71], v[24:27], v[32:35], v[68:71]
    v_mfma_f32_16x16x32_bf16 v[72:75], v[24:27], v[40:43], v[72:75]
    v_mfma_f32_16x16x32_bf16 v[76:79], v[24:27], v[48:51], v[76:79]
    s_waitcnt lgkmcnt(0)
    v_mfma_f32_16x16x32_bf16 v[56:59], v[20:23], v[36:39], v[56:59]
    v_mfma_f32_16x16x32_bf16 v[60:63], v[20:23], v[44:47], v[60:63]
    v_mfma_f32_16x16x32_bf16 v[64:67], v[20:23], v[52:55], v[64:67]
    v_mfma_f32_16x16x32_bf16 v[68:71], v[28:31], v[36:39], v[68:71]
    v_mfma_f32_16x16x32_bf16 v[72:75], v[28:31], v[44:47], v[72:75]
    v_mfma_f32_16x16x32_bf16 v[76:79], v[28:31], v[52:55], v[76:79]
    s_waitcnt vmcnt(5)
    s_barrier
    s_add_u32 m0, s37, 20480
    s_nop 0
    buffer_load_dwordx4 v2, s[28:31], s47 offen lds
    s_add_u32 m0, s37, 24576
    s_nop 0
    buffer_load_dwordx4 v3, s[28:31], s47 offen lds
    s_add_u32 m0, s37, 28672
    s_nop 0
    buffer_load_dwordx4 v4, s[32:35], s48 offen lds
    s_add_u32 m0, s37, 32768
    s_nop 0
    buffer_load_dwordx4 v5, s[32:35], s48 offen lds
    s_add_u32 m0, s37, 36864
    s_nop 0
    buffer_load_dwordx4 v6, s[32:35], s48 offen lds
    s_add_u32 s47, s47, 128
    s_add_u32 s48, s48, 128
    v_add_u32 v11, 40960, v7
    v_add_u32 v12, 40960, v8
    v_add_u32 v13, 40960, v9
    v_add_u32 v14, 40960, v10
    ds_read_b128 v[16:19], v11 offset:0
    ds_read_b128 v[24:27], v11 offset:2048
    ds_read_b128 v[32:35], v13 offset:0
    ds_read_b128 v[40:43], v13 offset:2048
    ds_read_b128 v[48:51], v13 offset:4096
    ds_read_b128 v[20:23], v12 offset:0
    ds_read_b128 v[28:31], v12 offset:2048
    ds_read_b128 v[36:39], v14 offset:0
    ds_read_b128 v[44:47], v14 offset:2048
    ds_read_b128 v[52:55], v14 offset:4096
    s_waitcnt lgkmcnt(5)
    v_mfma_f32_16x16x32_bf16 v[56:59], v[16:19], v[32:35], v[56:59]
    v_mfma_f32_16x16x32_bf16 v[60:63], v[16:19], v[40:43], v[60:63]
    v_mfma_f32_16x16x32_bf16 v[64:67], v[16:19], v[48:51], v[64:67]
    v_mfma_f32_16x16x32_bf16 v[68:71], v[24:27], v[32:35], v[68:71]
    v_mfma_f32_16x16x32_bf16 v[72:75], v[24:27], v[40:43], v[72:75]
    v_mfma_f32_16x16x32_bf16 v[76:79], v[24:27], v[48:51], v[76:79]
    s_waitcnt lgkmcnt(0)
    v_mfma_f32_16x16x32_bf16 v[56:59], v[20:23], v[36:39], v[56:59]
    v_mfma_f32_16x16x32_bf16 v[60:63], v[20:23], v[44:47], v[60:63]
    v_mfma_f32_16x16x32_bf16 v[64:67], v[20:23], v[52:55], v[64:67]
    v_mfma_f32_16x16x32_bf16 v[68:71], v[28:31], v[36:39], v[68:71]
    v_mfma_f32_16x16x32_bf16 v[72:75], v[28:31], v[44:47], v[72:75]
    v_mfma_f32_16x16x32_bf16 v[76:79], v[28:31], v[52:55], v[76:79]
    s_sub_u32 s49, s49, 1
    s_cmp_lg_u32 s49, 0
    s_cbranch_scc1 L_op2_kernel_loop
    s_waitcnt vmcnt(5)
    s_barrier
    s_add_u32 m0, s37, 40960
    s_nop 0
    buffer_load_dwordx4 v2, s[28:31], s47 offen lds
    s_add_u32 m0, s37, 45056
    s_nop 0
    buffer_load_dwordx4 v3, s[28:31], s47 offen lds
    s_add_u32 m0, s37, 49152
    s_nop 0
    buffer_load_dwordx4 v4, s[32:35], s48 offen lds
    s_add_u32 m0, s37, 53248
    s_nop 0
    buffer_load_dwordx4 v5, s[32:35], s48 offen lds
    s_add_u32 m0, s37, 57344
    s_nop 0
    buffer_load_dwordx4 v6, s[32:35], s48 offen lds
    s_add_u32 s47, s47, 128
    s_add_u32 s48, s48, 128
    ds_read_b128 v[16:19], v7 offset:0
    ds_read_b128 v[24:27], v7 offset:2048
    ds_read_b128 v[32:35], v9 offset:0
    ds_read_b128 v[40:43], v9 offset:2048
    ds_read_b128 v[48:51], v9 offset:4096
    ds_read_b128 v[20:23], v8 offset:0
    ds_read_b128 v[28:31], v8 offset:2048
    ds_read_b128 v[36:39], v10 offset:0
    ds_read_b128 v[44:47], v10 offset:2048
    ds_read_b128 v[52:55], v10 offset:4096
    s_waitcnt lgkmcnt(5)
    v_mfma_f32_16x16x32_bf16 v[56:59], v[16:19], v[32:35], v[56:59]
    v_mfma_f32_16x16x32_bf16 v[60:63], v[16:19], v[40:43], v[60:63]
    v_mfma_f32_16x16x32_bf16 v[64:67], v[16:19], v[48:51], v[64:67]
    v_mfma_f32_16x16x32_bf16 v[68:71], v[24:27], v[32:35], v[68:71]
    v_mfma_f32_16x16x32_bf16 v[72:75], v[24:27], v[40:43], v[72:75]
    v_mfma_f32_16x16x32_bf16 v[76:79], v[24:27], v[48:51], v[76:79]
    s_waitcnt lgkmcnt(0)
    v_mfma_f32_16x16x32_bf16 v[56:59], v[20:23], v[36:39], v[56:59]
    v_mfma_f32_16x16x32_bf16 v[60:63], v[20:23], v[44:47], v[60:63]
    v_mfma_f32_16x16x32_bf16 v[64:67], v[20:23], v[52:55], v[64:67]
    v_mfma_f32_16x16x32_bf16 v[68:71], v[28:31], v[36:39], v[68:71]
    v_mfma_f32_16x16x32_bf16 v[72:75], v[28:31], v[44:47], v[72:75]
    v_mfma_f32_16x16x32_bf16 v[76:79], v[28:31], v[52:55], v[76:79]
    s_waitcnt vmcnt(5)
    s_barrier
    v_add_u32 v11, 20480, v7
    v_add_u32 v12, 20480, v8
    v_add_u32 v13, 20480, v9
    v_add_u32 v14, 20480, v10
    ds_read_b128 v[16:19], v11 offset:0
    ds_read_b128 v[24:27], v11 offset:2048
    ds_read_b128 v[32:35], v13 offset:0
    ds_read_b128 v[40:43], v13 offset:2048
    ds_read_b128 v[48:51], v13 offset:4096
    ds_read_b128 v[20:23], v12 offset:0
    ds_read_b128 v[28:31], v12 offset:2048
    ds_read_b128 v[36:39], v14 offset:0
    ds_read_b128 v[44:47], v14 offset:2048
    ds_read_b128 v[52:55], v14 offset:4096
    s_waitcnt lgkmcnt(5)
    v_mfma_f32_16x16x32_bf16 v[56:59], v[16:19], v[32:35], v[56:59]
    v_mfma_f32_16x16x32_bf16 v[60:63], v[16:19], v[40:43], v[60:63]
    v_mfma_f32_16x16x32_bf16 v[64:67], v[16:19], v[48:51], v[64:67]
    v_mfma_f32_16x16x32_bf16 v[68:71], v[24:27], v[32:35], v[68:71]
    v_mfma_f32_16x16x32_bf16 v[72:75], v[24:27], v[40:43], v[72:75]
    v_mfma_f32_16x16x32_bf16 v[76:79], v[24:27], v[48:51], v[76:79]
    s_waitcnt lgkmcnt(0)
    v_mfma_f32_16x16x32_bf16 v[56:59], v[20:23], v[36:39], v[56:59]
    v_mfma_f32_16x16x32_bf16 v[60:63], v[20:23], v[44:47], v[60:63]
    v_mfma_f32_16x16x32_bf16 v[64:67], v[20:23], v[52:55], v[64:67]
    v_mfma_f32_16x16x32_bf16 v[68:71], v[28:31], v[36:39], v[68:71]
    v_mfma_f32_16x16x32_bf16 v[72:75], v[28:31], v[44:47], v[72:75]
    v_mfma_f32_16x16x32_bf16 v[76:79], v[28:31], v[52:55], v[76:79]
    s_waitcnt vmcnt(0)
    s_barrier
    v_add_u32 v11, 40960, v7
    v_add_u32 v12, 40960, v8
    v_add_u32 v13, 40960, v9
    v_add_u32 v14, 40960, v10
    ds_read_b128 v[16:19], v11 offset:0
    ds_read_b128 v[24:27], v11 offset:2048
    ds_read_b128 v[32:35], v13 offset:0
    ds_read_b128 v[40:43], v13 offset:2048
    ds_read_b128 v[48:51], v13 offset:4096
    ds_read_b128 v[20:23], v12 offset:0
    ds_read_b128 v[28:31], v12 offset:2048
    ds_read_b128 v[36:39], v14 offset:0
    ds_read_b128 v[44:47], v14 offset:2048
    ds_read_b128 v[52:55], v14 offset:4096
    s_waitcnt lgkmcnt(5)
    v_mfma_f32_16x16x32_bf16 v[56:59], v[16:19], v[32:35], v[56:59]
    v_mfma_f32_16x16x32_bf16 v[60:63], v[16:19], v[40:43], v[60:63]
    v_mfma_f32_16x16x32_bf16 v[64:67], v[16:19], v[48:51], v[64:67]
    v_mfma_f32_16x16x32_bf16 v[68:71], v[24:27], v[32:35], v[68:71]
    v_mfma_f32_16x16x32_bf16 v[72:75], v[24:27], v[40:43], v[72:75]
    v_mfma_f32_16x16x32_bf16 v[76:79], v[24:27], v[48:51], v[76:79]
    s_waitcnt lgkmcnt(0)
    v_mfma_f32_16x16x32_bf16 v[56:59], v[20:23], v[36:39], v[56:59]
    v_mfma_f32_16x16x32_bf16 v[60:63], v[20:23], v[44:47], v[60:63]
    v_mfma_f32_16x16x32_bf16 v[64:67], v[20:23], v[52:55], v[64:67]
    v_mfma_f32_16x16x32_bf16 v[68:71], v[28:31], v[36:39], v[68:71]
    v_mfma_f32_16x16x32_bf16 v[72:75], v[28:31], v[44:47], v[72:75]
    v_mfma_f32_16x16x32_bf16 v[76:79], v[28:31], v[52:55], v[76:79]
    s_add_u32 s60, s26, 0x19b8000
    s_addc_u32 s61, s27, 0
    s_and_b32 s61, s61, 0xffff
    s_mov_b32 s62, 0x240000
    s_mov_b32 s63, 0x00020000
    v_cvt_pk_bf16_f32 v80, v56, v56
    v_lshlrev_b32 v80, 16, v80
    v_lshlrev_b32 v85, 16, v85
    v_add_f32 v80, v80, v85
    v_cvt_pk_bf16_f32 v80, v80, v80
    v_cvt_pk_bf16_f32 v81, v57, v57
    v_lshlrev_b32 v81, 16, v81
    v_lshlrev_b32 v86, 16, v86
    v_add_f32 v81, v81, v86
    v_cvt_pk_bf16_f32 v81, v81, v81
    v_cvt_pk_bf16_f32 v82, v58, v58
    v_lshlrev_b32 v82, 16, v82
    v_lshlrev_b32 v87, 16, v87
    v_add_f32 v82, v82, v87
    v_cvt_pk_bf16_f32 v82, v82, v82
    v_cvt_pk_bf16_f32 v83, v59, v59
    v_lshlrev_b32 v83, 16, v83
    v_lshlrev_b32 v88, 16, v88
    v_add_f32 v83, v83, v88
    v_cvt_pk_bf16_f32 v83, v83, v83
    s_mov_b32 s58, 0
    buffer_store_short v80, v84, s[60:63], s58 offen offset:0
    s_mov_b32 s58, 1152
    buffer_store_short v81, v84, s[60:63], s58 offen offset:0
    s_mov_b32 s58, 2304
    buffer_store_short v82, v84, s[60:63], s58 offen offset:0
    s_mov_b32 s58, 3456
    buffer_store_short v83, v84, s[60:63], s58 offen offset:0
    v_cvt_pk_bf16_f32 v80, v60, v60
    v_lshlrev_b32 v80, 16, v80
    v_lshlrev_b32 v89, 16, v89
    v_add_f32 v80, v80, v89
    v_cvt_pk_bf16_f32 v80, v80, v80
    v_cvt_pk_bf16_f32 v81, v61, v61
    v_lshlrev_b32 v81, 16, v81
    v_lshlrev_b32 v90, 16, v90
    v_add_f32 v81, v81, v90
    v_cvt_pk_bf16_f32 v81, v81, v81
    v_cvt_pk_bf16_f32 v82, v62, v62
    v_lshlrev_b32 v82, 16, v82
    v_lshlrev_b32 v91, 16, v91
    v_add_f32 v82, v82, v91
    v_cvt_pk_bf16_f32 v82, v82, v82
    v_cvt_pk_bf16_f32 v83, v63, v63
    v_lshlrev_b32 v83, 16, v83
    v_lshlrev_b32 v92, 16, v92
    v_add_f32 v83, v83, v92
    v_cvt_pk_bf16_f32 v83, v83, v83
    s_mov_b32 s58, 0
    buffer_store_short v80, v84, s[60:63], s58 offen offset:32
    s_mov_b32 s58, 1152
    buffer_store_short v81, v84, s[60:63], s58 offen offset:32
    s_mov_b32 s58, 2304
    buffer_store_short v82, v84, s[60:63], s58 offen offset:32
    s_mov_b32 s58, 3456
    buffer_store_short v83, v84, s[60:63], s58 offen offset:32
    v_cvt_pk_bf16_f32 v80, v64, v64
    v_lshlrev_b32 v80, 16, v80
    v_lshlrev_b32 v93, 16, v93
    v_add_f32 v80, v80, v93
    v_cvt_pk_bf16_f32 v80, v80, v80
    v_cvt_pk_bf16_f32 v81, v65, v65
    v_lshlrev_b32 v81, 16, v81
    v_lshlrev_b32 v94, 16, v94
    v_add_f32 v81, v81, v94
    v_cvt_pk_bf16_f32 v81, v81, v81
    v_cvt_pk_bf16_f32 v82, v66, v66
    v_lshlrev_b32 v82, 16, v82
    v_lshlrev_b32 v95, 16, v95
    v_add_f32 v82, v82, v95
    v_cvt_pk_bf16_f32 v82, v82, v82
    v_cvt_pk_bf16_f32 v83, v67, v67
    v_lshlrev_b32 v83, 16, v83
    v_lshlrev_b32 v96, 16, v96
    v_add_f32 v83, v83, v96
    v_cvt_pk_bf16_f32 v83, v83, v83
    s_mov_b32 s58, 0
    buffer_store_short v80, v84, s[60:63], s58 offen offset:64
    s_mov_b32 s58, 1152
    buffer_store_short v81, v84, s[60:63], s58 offen offset:64
    s_mov_b32 s58, 2304
    buffer_store_short v82, v84, s[60:63], s58 offen offset:64
    s_mov_b32 s58, 3456
    buffer_store_short v83, v84, s[60:63], s58 offen offset:64
    v_cvt_pk_bf16_f32 v80, v68, v68
    v_lshlrev_b32 v80, 16, v80
    v_lshlrev_b32 v97, 16, v97
    v_add_f32 v80, v80, v97
    v_cvt_pk_bf16_f32 v80, v80, v80
    v_cvt_pk_bf16_f32 v81, v69, v69
    v_lshlrev_b32 v81, 16, v81
    v_lshlrev_b32 v98, 16, v98
    v_add_f32 v81, v81, v98
    v_cvt_pk_bf16_f32 v81, v81, v81
    v_cvt_pk_bf16_f32 v82, v70, v70
    v_lshlrev_b32 v82, 16, v82
    v_lshlrev_b32 v99, 16, v99
    v_add_f32 v82, v82, v99
    v_cvt_pk_bf16_f32 v82, v82, v82
    v_cvt_pk_bf16_f32 v83, v71, v71
    v_lshlrev_b32 v83, 16, v83
    v_lshlrev_b32 v100, 16, v100
    v_add_f32 v83, v83, v100
    v_cvt_pk_bf16_f32 v83, v83, v83
    s_mov_b32 s58, 18432
    buffer_store_short v80, v84, s[60:63], s58 offen offset:0
    s_mov_b32 s58, 19584
    buffer_store_short v81, v84, s[60:63], s58 offen offset:0
    s_mov_b32 s58, 20736
    buffer_store_short v82, v84, s[60:63], s58 offen offset:0
    s_mov_b32 s58, 21888
    buffer_store_short v83, v84, s[60:63], s58 offen offset:0
    v_cvt_pk_bf16_f32 v80, v72, v72
    v_lshlrev_b32 v80, 16, v80
    v_lshlrev_b32 v101, 16, v101
    v_add_f32 v80, v80, v101
    v_cvt_pk_bf16_f32 v80, v80, v80
    v_cvt_pk_bf16_f32 v81, v73, v73
    v_lshlrev_b32 v81, 16, v81
    v_lshlrev_b32 v102, 16, v102
    v_add_f32 v81, v81, v102
    v_cvt_pk_bf16_f32 v81, v81, v81
    v_cvt_pk_bf16_f32 v82, v74, v74
    v_lshlrev_b32 v82, 16, v82
    v_lshlrev_b32 v103, 16, v103
    v_add_f32 v82, v82, v103
    v_cvt_pk_bf16_f32 v82, v82, v82
    v_cvt_pk_bf16_f32 v83, v75, v75
    v_lshlrev_b32 v83, 16, v83
    v_lshlrev_b32 v104, 16, v104
    v_add_f32 v83, v83, v104
    v_cvt_pk_bf16_f32 v83, v83, v83
    s_mov_b32 s58, 18432
    buffer_store_short v80, v84, s[60:63], s58 offen offset:32
    s_mov_b32 s58, 19584
    buffer_store_short v81, v84, s[60:63], s58 offen offset:32
    s_mov_b32 s58, 20736
    buffer_store_short v82, v84, s[60:63], s58 offen offset:32
    s_mov_b32 s58, 21888
    buffer_store_short v83, v84, s[60:63], s58 offen offset:32
    v_cvt_pk_bf16_f32 v80, v76, v76
    v_lshlrev_b32 v80, 16, v80
    v_lshlrev_b32 v105, 16, v105
    v_add_f32 v80, v80, v105
    v_cvt_pk_bf16_f32 v80, v80, v80
    v_cvt_pk_bf16_f32 v81, v77, v77
    v_lshlrev_b32 v81, 16, v81
    v_lshlrev_b32 v106, 16, v106
    v_add_f32 v81, v81, v106
    v_cvt_pk_bf16_f32 v81, v81, v81
    v_cvt_pk_bf16_f32 v82, v78, v78
    v_lshlrev_b32 v82, 16, v82
    v_lshlrev_b32 v107, 16, v107
    v_add_f32 v82, v82, v107
    v_cvt_pk_bf16_f32 v82, v82, v82
    v_cvt_pk_bf16_f32 v83, v79, v79
    v_lshlrev_b32 v83, 16, v83
    v_lshlrev_b32 v108, 16, v108
    v_add_f32 v83, v83, v108
    v_cvt_pk_bf16_f32 v83, v83, v83
    s_mov_b32 s58, 18432
    buffer_store_short v80, v84, s[60:63], s58 offen offset:64
    s_mov_b32 s58, 19584
    buffer_store_short v81, v84, s[60:63], s58 offen offset:64
    s_mov_b32 s58, 20736
    buffer_store_short v82, v84, s[60:63], s58 offen offset:64
    s_mov_b32 s58, 21888
    buffer_store_short v83, v84, s[60:63], s58 offen offset:64
L_op2_kernel_end:
    s_endpgm
.globl ln3_kernel
.p2align 8
.type ln3_kernel,@function
ln3_kernel:
    s_cmp_ge_u32 s2, 256
    s_cbranch_scc1 L_ln3_kernel_end
    s_load_dwordx16 s[4:19], s[0:1], 0
    s_load_dwordx8 s[20:27], s[0:1], 64
    v_lshrrev_b32 v1, 6, v0
    v_and_b32 v2, 63, v0
    s_lshl_b32 s28, s2, 3
    v_lshrrev_b32 v3, 3, v0
    v_add_u32 v3, s28, v3
    s_movk_i32 s29, 1152
    v_mul_lo_u32 v3, v3, s29
    v_and_b32 v4, 7, v0
    v_lshl_add_u32 v3, v4, 4, v3
    s_waitcnt lgkmcnt(0)
    s_add_u32 s32, s26, 0x19b8000
    s_addc_u32 s33, s27, 0
    s_and_b32 s33, s33, 0xffff
    s_mov_b32 s34, 0x240000
    s_mov_b32 s35, 0x00020000
    s_add_u32 s36, s26, 0x298000
    s_addc_u32 s37, s27, 0
    s_and_b32 s37, s37, 0xffff
    s_mov_b32 s38, 0x240000
    s_mov_b32 s39, 0x00020000
    buffer_load_dwordx4 v[8:11], v3, s[32:35], 0 offen offset:0
    buffer_load_dwordx4 v[12:15], v3, s[32:35], 0 offen offset:128
    buffer_load_dwordx4 v[16:19], v3, s[32:35], 0 offen offset:256
    buffer_load_dwordx4 v[20:23], v3, s[32:35], 0 offen offset:384
    buffer_load_dwordx4 v[24:27], v3, s[32:35], 0 offen offset:512
    buffer_load_dwordx4 v[28:31], v3, s[32:35], 0 offen offset:640
    buffer_load_dwordx4 v[32:35], v3, s[32:35], 0 offen offset:768
    buffer_load_dwordx4 v[36:39], v3, s[32:35], 0 offen offset:896
    buffer_load_dwordx4 v[40:43], v3, s[32:35], 0 offen offset:1024
    s_waitcnt vmcnt(0)
    v_lshlrev_b32 v44, 16, v8
    v_and_b32 v45, 0xffff0000, v8
    v_lshlrev_b32 v46, 16, v9
    v_and_b32 v47, 0xffff0000, v9
    v_lshlrev_b32 v48, 16, v10
    v_and_b32 v49, 0xffff0000, v10
    v_lshlrev_b32 v50, 16, v11
    v_and_b32 v51, 0xffff0000, v11
    v_lshlrev_b32 v52, 16, v12
    v_and_b32 v53, 0xffff0000, v12
    v_lshlrev_b32 v54, 16, v13
    v_and_b32 v55, 0xffff0000, v13
    v_lshlrev_b32 v56, 16, v14
    v_and_b32 v57, 0xffff0000, v14
    v_lshlrev_b32 v58, 16, v15
    v_and_b32 v59, 0xffff0000, v15
    v_lshlrev_b32 v60, 16, v16
    v_and_b32 v61, 0xffff0000, v16
    v_lshlrev_b32 v62, 16, v17
    v_and_b32 v63, 0xffff0000, v17
    v_lshlrev_b32 v64, 16, v18
    v_and_b32 v65, 0xffff0000, v18
    v_lshlrev_b32 v66, 16, v19
    v_and_b32 v67, 0xffff0000, v19
    v_lshlrev_b32 v68, 16, v20
    v_and_b32 v69, 0xffff0000, v20
    v_lshlrev_b32 v70, 16, v21
    v_and_b32 v71, 0xffff0000, v21
    v_lshlrev_b32 v72, 16, v22
    v_and_b32 v73, 0xffff0000, v22
    v_lshlrev_b32 v74, 16, v23
    v_and_b32 v75, 0xffff0000, v23
    v_lshlrev_b32 v76, 16, v24
    v_and_b32 v77, 0xffff0000, v24
    v_lshlrev_b32 v78, 16, v25
    v_and_b32 v79, 0xffff0000, v25
    v_lshlrev_b32 v80, 16, v26
    v_and_b32 v81, 0xffff0000, v26
    v_lshlrev_b32 v82, 16, v27
    v_and_b32 v83, 0xffff0000, v27
    v_lshlrev_b32 v84, 16, v28
    v_and_b32 v85, 0xffff0000, v28
    v_lshlrev_b32 v86, 16, v29
    v_and_b32 v87, 0xffff0000, v29
    v_lshlrev_b32 v88, 16, v30
    v_and_b32 v89, 0xffff0000, v30
    v_lshlrev_b32 v90, 16, v31
    v_and_b32 v91, 0xffff0000, v31
    v_lshlrev_b32 v92, 16, v32
    v_and_b32 v93, 0xffff0000, v32
    v_lshlrev_b32 v94, 16, v33
    v_and_b32 v95, 0xffff0000, v33
    v_lshlrev_b32 v96, 16, v34
    v_and_b32 v97, 0xffff0000, v34
    v_lshlrev_b32 v98, 16, v35
    v_and_b32 v99, 0xffff0000, v35
    v_lshlrev_b32 v100, 16, v36
    v_and_b32 v101, 0xffff0000, v36
    v_lshlrev_b32 v102, 16, v37
    v_and_b32 v103, 0xffff0000, v37
    v_lshlrev_b32 v104, 16, v38
    v_and_b32 v105, 0xffff0000, v38
    v_lshlrev_b32 v106, 16, v39
    v_and_b32 v107, 0xffff0000, v39
    v_lshlrev_b32 v108, 16, v40
    v_and_b32 v109, 0xffff0000, v40
    v_lshlrev_b32 v110, 16, v41
    v_and_b32 v111, 0xffff0000, v41
    v_lshlrev_b32 v112, 16, v42
    v_and_b32 v113, 0xffff0000, v42
    v_lshlrev_b32 v114, 16, v43
    v_and_b32 v115, 0xffff0000, v43
    v_add_f32 v116, v44, v45
    v_add_f32 v116, v116, v46
    v_add_f32 v116, v116, v47
    v_add_f32 v116, v116, v48
    v_add_f32 v116, v116, v49
    v_add_f32 v116, v116, v50
    v_add_f32 v116, v116, v51
    v_add_f32 v116, v116, v52
    v_add_f32 v116, v116, v53
    v_add_f32 v116, v116, v54
    v_add_f32 v116, v116, v55
    v_add_f32 v116, v116, v56
    v_add_f32 v116, v116, v57
    v_add_f32 v116, v116, v58
    v_add_f32 v116, v116, v59
    v_add_f32 v116, v116, v60
    v_add_f32 v116, v116, v61
    v_add_f32 v116, v116, v62
    v_add_f32 v116, v116, v63
    v_add_f32 v116, v116, v64
    v_add_f32 v116, v116, v65
    v_add_f32 v116, v116, v66
    v_add_f32 v116, v116, v67
    v_add_f32 v116, v116, v68
    v_add_f32 v116, v116, v69
    v_add_f32 v116, v116, v70
    v_add_f32 v116, v116, v71
    v_add_f32 v116, v116, v72
    v_add_f32 v116, v116, v73
    v_add_f32 v116, v116, v74
    v_add_f32 v116, v116, v75
    v_add_f32 v116, v116, v76
    v_add_f32 v116, v116, v77
    v_add_f32 v116, v116, v78
    v_add_f32 v116, v116, v79
    v_add_f32 v116, v116, v80
    v_add_f32 v116, v116, v81
    v_add_f32 v116, v116, v82
    v_add_f32 v116, v116, v83
    v_add_f32 v116, v116, v84
    v_add_f32 v116, v116, v85
    v_add_f32 v116, v116, v86
    v_add_f32 v116, v116, v87
    v_add_f32 v116, v116, v88
    v_add_f32 v116, v116, v89
    v_add_f32 v116, v116, v90
    v_add_f32 v116, v116, v91
    v_add_f32 v116, v116, v92
    v_add_f32 v116, v116, v93
    v_add_f32 v116, v116, v94
    v_add_f32 v116, v116, v95
    v_add_f32 v116, v116, v96
    v_add_f32 v116, v116, v97
    v_add_f32 v116, v116, v98
    v_add_f32 v116, v116, v99
    v_add_f32 v116, v116, v100
    v_add_f32 v116, v116, v101
    v_add_f32 v116, v116, v102
    v_add_f32 v116, v116, v103
    v_add_f32 v116, v116, v104
    v_add_f32 v116, v116, v105
    v_add_f32 v116, v116, v106
    v_add_f32 v116, v116, v107
    v_add_f32 v116, v116, v108
    v_add_f32 v116, v116, v109
    v_add_f32 v116, v116, v110
    v_add_f32 v116, v116, v111
    v_add_f32 v116, v116, v112
    v_add_f32 v116, v116, v113
    v_add_f32 v116, v116, v114
    v_add_f32 v116, v116, v115
    s_nop 1
    v_add_f32_dpp v116, v116, v116 quad_perm:[1,0,3,2] row_mask:0xf bank_mask:0xf
    s_nop 1
    v_add_f32_dpp v116, v116, v116 quad_perm:[2,3,0,1] row_mask:0xf bank_mask:0xf
    s_nop 1
    v_add_f32_dpp v116, v116, v116 row_half_mirror row_mask:0xf bank_mask:0xf
    v_mul_f32 v118, 0x3ae38e39, v116
    v_sub_f32 v119, v44, v118
    v_mul_f32 v117, v119, v119
    v_sub_f32 v119, v45, v118
    v_fmac_f32 v117, v119, v119
    v_sub_f32 v119, v46, v118
    v_fmac_f32 v117, v119, v119
    v_sub_f32 v119, v47, v118
    v_fmac_f32 v117, v119, v119
    v_sub_f32 v119, v48, v118
    v_fmac_f32 v117, v119, v119
    v_sub_f32 v119, v49, v118
    v_fmac_f32 v117, v119, v119
    v_sub_f32 v119, v50, v118
    v_fmac_f32 v117, v119, v119
    v_sub_f32 v119, v51, v118
    v_fmac_f32 v117, v119, v119
    v_sub_f32 v119, v52, v118
    v_fmac_f32 v117, v119, v119
    v_sub_f32 v119, v53, v118
    v_fmac_f32 v117, v119, v119
    v_sub_f32 v119, v54, v118
    v_fmac_f32 v117, v119, v119
    v_sub_f32 v119, v55, v118
    v_fmac_f32 v117, v119, v119
    v_sub_f32 v119, v56, v118
    v_fmac_f32 v117, v119, v119
    v_sub_f32 v119, v57, v118
    v_fmac_f32 v117, v119, v119
    v_sub_f32 v119, v58, v118
    v_fmac_f32 v117, v119, v119
    v_sub_f32 v119, v59, v118
    v_fmac_f32 v117, v119, v119
    v_sub_f32 v119, v60, v118
    v_fmac_f32 v117, v119, v119
    v_sub_f32 v119, v61, v118
    v_fmac_f32 v117, v119, v119
    v_sub_f32 v119, v62, v118
    v_fmac_f32 v117, v119, v119
    v_sub_f32 v119, v63, v118
    v_fmac_f32 v117, v119, v119
    v_sub_f32 v119, v64, v118
    v_fmac_f32 v117, v119, v119
    v_sub_f32 v119, v65, v118
    v_fmac_f32 v117, v119, v119
    v_sub_f32 v119, v66, v118
    v_fmac_f32 v117, v119, v119
    v_sub_f32 v119, v67, v118
    v_fmac_f32 v117, v119, v119
    v_sub_f32 v119, v68, v118
    v_fmac_f32 v117, v119, v119
    v_sub_f32 v119, v69, v118
    v_fmac_f32 v117, v119, v119
    v_sub_f32 v119, v70, v118
    v_fmac_f32 v117, v119, v119
    v_sub_f32 v119, v71, v118
    v_fmac_f32 v117, v119, v119
    v_sub_f32 v119, v72, v118
    v_fmac_f32 v117, v119, v119
    v_sub_f32 v119, v73, v118
    v_fmac_f32 v117, v119, v119
    v_sub_f32 v119, v74, v118
    v_fmac_f32 v117, v119, v119
    v_sub_f32 v119, v75, v118
    v_fmac_f32 v117, v119, v119
    v_sub_f32 v119, v76, v118
    v_fmac_f32 v117, v119, v119
    v_sub_f32 v119, v77, v118
    v_fmac_f32 v117, v119, v119
    v_sub_f32 v119, v78, v118
    v_fmac_f32 v117, v119, v119
    v_sub_f32 v119, v79, v118
    v_fmac_f32 v117, v119, v119
    v_sub_f32 v119, v80, v118
    v_fmac_f32 v117, v119, v119
    v_sub_f32 v119, v81, v118
    v_fmac_f32 v117, v119, v119
    v_sub_f32 v119, v82, v118
    v_fmac_f32 v117, v119, v119
    v_sub_f32 v119, v83, v118
    v_fmac_f32 v117, v119, v119
    v_sub_f32 v119, v84, v118
    v_fmac_f32 v117, v119, v119
    v_sub_f32 v119, v85, v118
    v_fmac_f32 v117, v119, v119
    v_sub_f32 v119, v86, v118
    v_fmac_f32 v117, v119, v119
    v_sub_f32 v119, v87, v118
    v_fmac_f32 v117, v119, v119
    v_sub_f32 v119, v88, v118
    v_fmac_f32 v117, v119, v119
    v_sub_f32 v119, v89, v118
    v_fmac_f32 v117, v119, v119
    v_sub_f32 v119, v90, v118
    v_fmac_f32 v117, v119, v119
    v_sub_f32 v119, v91, v118
    v_fmac_f32 v117, v119, v119
    v_sub_f32 v119, v92, v118
    v_fmac_f32 v117, v119, v119
    v_sub_f32 v119, v93, v118
    v_fmac_f32 v117, v119, v119
    v_sub_f32 v119, v94, v118
    v_fmac_f32 v117, v119, v119
    v_sub_f32 v119, v95, v118
    v_fmac_f32 v117, v119, v119
    v_sub_f32 v119, v96, v118
    v_fmac_f32 v117, v119, v119
    v_sub_f32 v119, v97, v118
    v_fmac_f32 v117, v119, v119
    v_sub_f32 v119, v98, v118
    v_fmac_f32 v117, v119, v119
    v_sub_f32 v119, v99, v118
    v_fmac_f32 v117, v119, v119
    v_sub_f32 v119, v100, v118
    v_fmac_f32 v117, v119, v119
    v_sub_f32 v119, v101, v118
    v_fmac_f32 v117, v119, v119
    v_sub_f32 v119, v102, v118
    v_fmac_f32 v117, v119, v119
    v_sub_f32 v119, v103, v118
    v_fmac_f32 v117, v119, v119
    v_sub_f32 v119, v104, v118
    v_fmac_f32 v117, v119, v119
    v_sub_f32 v119, v105, v118
    v_fmac_f32 v117, v119, v119
    v_sub_f32 v119, v106, v118
    v_fmac_f32 v117, v119, v119
    v_sub_f32 v119, v107, v118
    v_fmac_f32 v117, v119, v119
    v_sub_f32 v119, v108, v118
    v_fmac_f32 v117, v119, v119
    v_sub_f32 v119, v109, v118
    v_fmac_f32 v117, v119, v119
    v_sub_f32 v119, v110, v118
    v_fmac_f32 v117, v119, v119
    v_sub_f32 v119, v111, v118
    v_fmac_f32 v117, v119, v119
    v_sub_f32 v119, v112, v118
    v_fmac_f32 v117, v119, v119
    v_sub_f32 v119, v113, v118
    v_fmac_f32 v117, v119, v119
    v_sub_f32 v119, v114, v118
    v_fmac_f32 v117, v119, v119
    v_sub_f32 v119, v115, v118
    v_fmac_f32 v117, v119, v119
    s_nop 1
    v_add_f32_dpp v117, v117, v117 quad_perm:[1,0,3,2] row_mask:0xf bank_mask:0xf
    s_nop 1
    v_add_f32_dpp v117, v117, v117 quad_perm:[2,3,0,1] row_mask:0xf bank_mask:0xf
    s_nop 1
    v_add_f32_dpp v117, v117, v117 row_half_mirror row_mask:0xf bank_mask:0xf
    v_mul_f32 v120, 0x3ae38e39, v117
    v_cvt_pk_bf16_f32 v121, v118, v120
    v_and_b32 v122, 0xffff0000, v121
    v_lshlrev_b32 v121, 16, v121
    v_add_f32 v122, 0x3727c5ac, v122
    v_cvt_pk_bf16_f32 v122, v122, v122
    v_lshlrev_b32 v122, 16, v122
    v_sqrt_f32 v122, v122
    s_nop 0
    v_cvt_pk_bf16_f32 v122, v122, v122
    v_lshlrev_b32 v122, 16, v122
    v_rcp_f32 v123, v122
    v_sub_f32 v44, v44, v121
    v_sub_f32 v45, v45, v121
    v_cvt_pk_bf16_f32 v8, v44, v45
    v_lshlrev_b32 v44, 16, v8
    v_and_b32 v45, 0xffff0000, v8
    v_mul_f32 v125, v44, v123
    v_fma_f32 v127, -v125, v122, v44
    v_fma_f32 v44, v127, v123, v125
    v_mul_f32 v126, v45, v123
    v_fma_f32 v128, -v126, v122, v45
    v_fma_f32 v45, v128, v123, v126
    v_cvt_pk_bf16_f32 v8, v44, v45
    v_sub_f32 v46, v46, v121
    v_sub_f32 v47, v47, v121
    v_cvt_pk_bf16_f32 v9, v46, v47
    v_lshlrev_b32 v46, 16, v9
    v_and_b32 v47, 0xffff0000, v9
    v_mul_f32 v125, v46, v123
    v_fma_f32 v127, -v125, v122, v46
    v_fma_f32 v46, v127, v123, v125
    v_mul_f32 v126, v47, v123
    v_fma_f32 v128, -v126, v122, v47
    v_fma_f32 v47, v128, v123, v126
    v_cvt_pk_bf16_f32 v9, v46, v47
    v_sub_f32 v48, v48, v121
    v_sub_f32 v49, v49, v121
    v_cvt_pk_bf16_f32 v10, v48, v49
    v_lshlrev_b32 v48, 16, v10
    v_and_b32 v49, 0xffff0000, v10
    v_mul_f32 v125, v48, v123
    v_fma_f32 v127, -v125, v122, v48
    v_fma_f32 v48, v127, v123, v125
    v_mul_f32 v126, v49, v123
    v_fma_f32 v128, -v126, v122, v49
    v_fma_f32 v49, v128, v123, v126
    v_cvt_pk_bf16_f32 v10, v48, v49
    v_sub_f32 v50, v50, v121
    v_sub_f32 v51, v51, v121
    v_cvt_pk_bf16_f32 v11, v50, v51
    v_lshlrev_b32 v50, 16, v11
    v_and_b32 v51, 0xffff0000, v11
    v_mul_f32 v125, v50, v123
    v_fma_f32 v127, -v125, v122, v50
    v_fma_f32 v50, v127, v123, v125
    v_mul_f32 v126, v51, v123
    v_fma_f32 v128, -v126, v122, v51
    v_fma_f32 v51, v128, v123, v126
    v_cvt_pk_bf16_f32 v11, v50, v51
    v_sub_f32 v52, v52, v121
    v_sub_f32 v53, v53, v121
    v_cvt_pk_bf16_f32 v12, v52, v53
    v_lshlrev_b32 v52, 16, v12
    v_and_b32 v53, 0xffff0000, v12
    v_mul_f32 v125, v52, v123
    v_fma_f32 v127, -v125, v122, v52
    v_fma_f32 v52, v127, v123, v125
    v_mul_f32 v126, v53, v123
    v_fma_f32 v128, -v126, v122, v53
    v_fma_f32 v53, v128, v123, v126
    v_cvt_pk_bf16_f32 v12, v52, v53
    v_sub_f32 v54, v54, v121
    v_sub_f32 v55, v55, v121
    v_cvt_pk_bf16_f32 v13, v54, v55
    v_lshlrev_b32 v54, 16, v13
    v_and_b32 v55, 0xffff0000, v13
    v_mul_f32 v125, v54, v123
    v_fma_f32 v127, -v125, v122, v54
    v_fma_f32 v54, v127, v123, v125
    v_mul_f32 v126, v55, v123
    v_fma_f32 v128, -v126, v122, v55
    v_fma_f32 v55, v128, v123, v126
    v_cvt_pk_bf16_f32 v13, v54, v55
    v_sub_f32 v56, v56, v121
    v_sub_f32 v57, v57, v121
    v_cvt_pk_bf16_f32 v14, v56, v57
    v_lshlrev_b32 v56, 16, v14
    v_and_b32 v57, 0xffff0000, v14
    v_mul_f32 v125, v56, v123
    v_fma_f32 v127, -v125, v122, v56
    v_fma_f32 v56, v127, v123, v125
    v_mul_f32 v126, v57, v123
    v_fma_f32 v128, -v126, v122, v57
    v_fma_f32 v57, v128, v123, v126
    v_cvt_pk_bf16_f32 v14, v56, v57
    v_sub_f32 v58, v58, v121
    v_sub_f32 v59, v59, v121
    v_cvt_pk_bf16_f32 v15, v58, v59
    v_lshlrev_b32 v58, 16, v15
    v_and_b32 v59, 0xffff0000, v15
    v_mul_f32 v125, v58, v123
    v_fma_f32 v127, -v125, v122, v58
    v_fma_f32 v58, v127, v123, v125
    v_mul_f32 v126, v59, v123
    v_fma_f32 v128, -v126, v122, v59
    v_fma_f32 v59, v128, v123, v126
    v_cvt_pk_bf16_f32 v15, v58, v59
    v_sub_f32 v60, v60, v121
    v_sub_f32 v61, v61, v121
    v_cvt_pk_bf16_f32 v16, v60, v61
    v_lshlrev_b32 v60, 16, v16
    v_and_b32 v61, 0xffff0000, v16
    v_mul_f32 v125, v60, v123
    v_fma_f32 v127, -v125, v122, v60
    v_fma_f32 v60, v127, v123, v125
    v_mul_f32 v126, v61, v123
    v_fma_f32 v128, -v126, v122, v61
    v_fma_f32 v61, v128, v123, v126
    v_cvt_pk_bf16_f32 v16, v60, v61
    v_sub_f32 v62, v62, v121
    v_sub_f32 v63, v63, v121
    v_cvt_pk_bf16_f32 v17, v62, v63
    v_lshlrev_b32 v62, 16, v17
    v_and_b32 v63, 0xffff0000, v17
    v_mul_f32 v125, v62, v123
    v_fma_f32 v127, -v125, v122, v62
    v_fma_f32 v62, v127, v123, v125
    v_mul_f32 v126, v63, v123
    v_fma_f32 v128, -v126, v122, v63
    v_fma_f32 v63, v128, v123, v126
    v_cvt_pk_bf16_f32 v17, v62, v63
    v_sub_f32 v64, v64, v121
    v_sub_f32 v65, v65, v121
    v_cvt_pk_bf16_f32 v18, v64, v65
    v_lshlrev_b32 v64, 16, v18
    v_and_b32 v65, 0xffff0000, v18
    v_mul_f32 v125, v64, v123
    v_fma_f32 v127, -v125, v122, v64
    v_fma_f32 v64, v127, v123, v125
    v_mul_f32 v126, v65, v123
    v_fma_f32 v128, -v126, v122, v65
    v_fma_f32 v65, v128, v123, v126
    v_cvt_pk_bf16_f32 v18, v64, v65
    v_sub_f32 v66, v66, v121
    v_sub_f32 v67, v67, v121
    v_cvt_pk_bf16_f32 v19, v66, v67
    v_lshlrev_b32 v66, 16, v19
    v_and_b32 v67, 0xffff0000, v19
    v_mul_f32 v125, v66, v123
    v_fma_f32 v127, -v125, v122, v66
    v_fma_f32 v66, v127, v123, v125
    v_mul_f32 v126, v67, v123
    v_fma_f32 v128, -v126, v122, v67
    v_fma_f32 v67, v128, v123, v126
    v_cvt_pk_bf16_f32 v19, v66, v67
    v_sub_f32 v68, v68, v121
    v_sub_f32 v69, v69, v121
    v_cvt_pk_bf16_f32 v20, v68, v69
    v_lshlrev_b32 v68, 16, v20
    v_and_b32 v69, 0xffff0000, v20
    v_mul_f32 v125, v68, v123
    v_fma_f32 v127, -v125, v122, v68
    v_fma_f32 v68, v127, v123, v125
    v_mul_f32 v126, v69, v123
    v_fma_f32 v128, -v126, v122, v69
    v_fma_f32 v69, v128, v123, v126
    v_cvt_pk_bf16_f32 v20, v68, v69
    v_sub_f32 v70, v70, v121
    v_sub_f32 v71, v71, v121
    v_cvt_pk_bf16_f32 v21, v70, v71
    v_lshlrev_b32 v70, 16, v21
    v_and_b32 v71, 0xffff0000, v21
    v_mul_f32 v125, v70, v123
    v_fma_f32 v127, -v125, v122, v70
    v_fma_f32 v70, v127, v123, v125
    v_mul_f32 v126, v71, v123
    v_fma_f32 v128, -v126, v122, v71
    v_fma_f32 v71, v128, v123, v126
    v_cvt_pk_bf16_f32 v21, v70, v71
    v_sub_f32 v72, v72, v121
    v_sub_f32 v73, v73, v121
    v_cvt_pk_bf16_f32 v22, v72, v73
    v_lshlrev_b32 v72, 16, v22
    v_and_b32 v73, 0xffff0000, v22
    v_mul_f32 v125, v72, v123
    v_fma_f32 v127, -v125, v122, v72
    v_fma_f32 v72, v127, v123, v125
    v_mul_f32 v126, v73, v123
    v_fma_f32 v128, -v126, v122, v73
    v_fma_f32 v73, v128, v123, v126
    v_cvt_pk_bf16_f32 v22, v72, v73
    v_sub_f32 v74, v74, v121
    v_sub_f32 v75, v75, v121
    v_cvt_pk_bf16_f32 v23, v74, v75
    v_lshlrev_b32 v74, 16, v23
    v_and_b32 v75, 0xffff0000, v23
    v_mul_f32 v125, v74, v123
    v_fma_f32 v127, -v125, v122, v74
    v_fma_f32 v74, v127, v123, v125
    v_mul_f32 v126, v75, v123
    v_fma_f32 v128, -v126, v122, v75
    v_fma_f32 v75, v128, v123, v126
    v_cvt_pk_bf16_f32 v23, v74, v75
    v_sub_f32 v76, v76, v121
    v_sub_f32 v77, v77, v121
    v_cvt_pk_bf16_f32 v24, v76, v77
    v_lshlrev_b32 v76, 16, v24
    v_and_b32 v77, 0xffff0000, v24
    v_mul_f32 v125, v76, v123
    v_fma_f32 v127, -v125, v122, v76
    v_fma_f32 v76, v127, v123, v125
    v_mul_f32 v126, v77, v123
    v_fma_f32 v128, -v126, v122, v77
    v_fma_f32 v77, v128, v123, v126
    v_cvt_pk_bf16_f32 v24, v76, v77
    v_sub_f32 v78, v78, v121
    v_sub_f32 v79, v79, v121
    v_cvt_pk_bf16_f32 v25, v78, v79
    v_lshlrev_b32 v78, 16, v25
    v_and_b32 v79, 0xffff0000, v25
    v_mul_f32 v125, v78, v123
    v_fma_f32 v127, -v125, v122, v78
    v_fma_f32 v78, v127, v123, v125
    v_mul_f32 v126, v79, v123
    v_fma_f32 v128, -v126, v122, v79
    v_fma_f32 v79, v128, v123, v126
    v_cvt_pk_bf16_f32 v25, v78, v79
    v_sub_f32 v80, v80, v121
    v_sub_f32 v81, v81, v121
    v_cvt_pk_bf16_f32 v26, v80, v81
    v_lshlrev_b32 v80, 16, v26
    v_and_b32 v81, 0xffff0000, v26
    v_mul_f32 v125, v80, v123
    v_fma_f32 v127, -v125, v122, v80
    v_fma_f32 v80, v127, v123, v125
    v_mul_f32 v126, v81, v123
    v_fma_f32 v128, -v126, v122, v81
    v_fma_f32 v81, v128, v123, v126
    v_cvt_pk_bf16_f32 v26, v80, v81
    v_sub_f32 v82, v82, v121
    v_sub_f32 v83, v83, v121
    v_cvt_pk_bf16_f32 v27, v82, v83
    v_lshlrev_b32 v82, 16, v27
    v_and_b32 v83, 0xffff0000, v27
    v_mul_f32 v125, v82, v123
    v_fma_f32 v127, -v125, v122, v82
    v_fma_f32 v82, v127, v123, v125
    v_mul_f32 v126, v83, v123
    v_fma_f32 v128, -v126, v122, v83
    v_fma_f32 v83, v128, v123, v126
    v_cvt_pk_bf16_f32 v27, v82, v83
    v_sub_f32 v84, v84, v121
    v_sub_f32 v85, v85, v121
    v_cvt_pk_bf16_f32 v28, v84, v85
    v_lshlrev_b32 v84, 16, v28
    v_and_b32 v85, 0xffff0000, v28
    v_mul_f32 v125, v84, v123
    v_fma_f32 v127, -v125, v122, v84
    v_fma_f32 v84, v127, v123, v125
    v_mul_f32 v126, v85, v123
    v_fma_f32 v128, -v126, v122, v85
    v_fma_f32 v85, v128, v123, v126
    v_cvt_pk_bf16_f32 v28, v84, v85
    v_sub_f32 v86, v86, v121
    v_sub_f32 v87, v87, v121
    v_cvt_pk_bf16_f32 v29, v86, v87
    v_lshlrev_b32 v86, 16, v29
    v_and_b32 v87, 0xffff0000, v29
    v_mul_f32 v125, v86, v123
    v_fma_f32 v127, -v125, v122, v86
    v_fma_f32 v86, v127, v123, v125
    v_mul_f32 v126, v87, v123
    v_fma_f32 v128, -v126, v122, v87
    v_fma_f32 v87, v128, v123, v126
    v_cvt_pk_bf16_f32 v29, v86, v87
    v_sub_f32 v88, v88, v121
    v_sub_f32 v89, v89, v121
    v_cvt_pk_bf16_f32 v30, v88, v89
    v_lshlrev_b32 v88, 16, v30
    v_and_b32 v89, 0xffff0000, v30
    v_mul_f32 v125, v88, v123
    v_fma_f32 v127, -v125, v122, v88
    v_fma_f32 v88, v127, v123, v125
    v_mul_f32 v126, v89, v123
    v_fma_f32 v128, -v126, v122, v89
    v_fma_f32 v89, v128, v123, v126
    v_cvt_pk_bf16_f32 v30, v88, v89
    v_sub_f32 v90, v90, v121
    v_sub_f32 v91, v91, v121
    v_cvt_pk_bf16_f32 v31, v90, v91
    v_lshlrev_b32 v90, 16, v31
    v_and_b32 v91, 0xffff0000, v31
    v_mul_f32 v125, v90, v123
    v_fma_f32 v127, -v125, v122, v90
    v_fma_f32 v90, v127, v123, v125
    v_mul_f32 v126, v91, v123
    v_fma_f32 v128, -v126, v122, v91
    v_fma_f32 v91, v128, v123, v126
    v_cvt_pk_bf16_f32 v31, v90, v91
    v_sub_f32 v92, v92, v121
    v_sub_f32 v93, v93, v121
    v_cvt_pk_bf16_f32 v32, v92, v93
    v_lshlrev_b32 v92, 16, v32
    v_and_b32 v93, 0xffff0000, v32
    v_mul_f32 v125, v92, v123
    v_fma_f32 v127, -v125, v122, v92
    v_fma_f32 v92, v127, v123, v125
    v_mul_f32 v126, v93, v123
    v_fma_f32 v128, -v126, v122, v93
    v_fma_f32 v93, v128, v123, v126
    v_cvt_pk_bf16_f32 v32, v92, v93
    v_sub_f32 v94, v94, v121
    v_sub_f32 v95, v95, v121
    v_cvt_pk_bf16_f32 v33, v94, v95
    v_lshlrev_b32 v94, 16, v33
    v_and_b32 v95, 0xffff0000, v33
    v_mul_f32 v125, v94, v123
    v_fma_f32 v127, -v125, v122, v94
    v_fma_f32 v94, v127, v123, v125
    v_mul_f32 v126, v95, v123
    v_fma_f32 v128, -v126, v122, v95
    v_fma_f32 v95, v128, v123, v126
    v_cvt_pk_bf16_f32 v33, v94, v95
    v_sub_f32 v96, v96, v121
    v_sub_f32 v97, v97, v121
    v_cvt_pk_bf16_f32 v34, v96, v97
    v_lshlrev_b32 v96, 16, v34
    v_and_b32 v97, 0xffff0000, v34
    v_mul_f32 v125, v96, v123
    v_fma_f32 v127, -v125, v122, v96
    v_fma_f32 v96, v127, v123, v125
    v_mul_f32 v126, v97, v123
    v_fma_f32 v128, -v126, v122, v97
    v_fma_f32 v97, v128, v123, v126
    v_cvt_pk_bf16_f32 v34, v96, v97
    v_sub_f32 v98, v98, v121
    v_sub_f32 v99, v99, v121
    v_cvt_pk_bf16_f32 v35, v98, v99
    v_lshlrev_b32 v98, 16, v35
    v_and_b32 v99, 0xffff0000, v35
    v_mul_f32 v125, v98, v123
    v_fma_f32 v127, -v125, v122, v98
    v_fma_f32 v98, v127, v123, v125
    v_mul_f32 v126, v99, v123
    v_fma_f32 v128, -v126, v122, v99
    v_fma_f32 v99, v128, v123, v126
    v_cvt_pk_bf16_f32 v35, v98, v99
    v_sub_f32 v100, v100, v121
    v_sub_f32 v101, v101, v121
    v_cvt_pk_bf16_f32 v36, v100, v101
    v_lshlrev_b32 v100, 16, v36
    v_and_b32 v101, 0xffff0000, v36
    v_mul_f32 v125, v100, v123
    v_fma_f32 v127, -v125, v122, v100
    v_fma_f32 v100, v127, v123, v125
    v_mul_f32 v126, v101, v123
    v_fma_f32 v128, -v126, v122, v101
    v_fma_f32 v101, v128, v123, v126
    v_cvt_pk_bf16_f32 v36, v100, v101
    v_sub_f32 v102, v102, v121
    v_sub_f32 v103, v103, v121
    v_cvt_pk_bf16_f32 v37, v102, v103
    v_lshlrev_b32 v102, 16, v37
    v_and_b32 v103, 0xffff0000, v37
    v_mul_f32 v125, v102, v123
    v_fma_f32 v127, -v125, v122, v102
    v_fma_f32 v102, v127, v123, v125
    v_mul_f32 v126, v103, v123
    v_fma_f32 v128, -v126, v122, v103
    v_fma_f32 v103, v128, v123, v126
    v_cvt_pk_bf16_f32 v37, v102, v103
    v_sub_f32 v104, v104, v121
    v_sub_f32 v105, v105, v121
    v_cvt_pk_bf16_f32 v38, v104, v105
    v_lshlrev_b32 v104, 16, v38
    v_and_b32 v105, 0xffff0000, v38
    v_mul_f32 v125, v104, v123
    v_fma_f32 v127, -v125, v122, v104
    v_fma_f32 v104, v127, v123, v125
    v_mul_f32 v126, v105, v123
    v_fma_f32 v128, -v126, v122, v105
    v_fma_f32 v105, v128, v123, v126
    v_cvt_pk_bf16_f32 v38, v104, v105
    v_sub_f32 v106, v106, v121
    v_sub_f32 v107, v107, v121
    v_cvt_pk_bf16_f32 v39, v106, v107
    v_lshlrev_b32 v106, 16, v39
    v_and_b32 v107, 0xffff0000, v39
    v_mul_f32 v125, v106, v123
    v_fma_f32 v127, -v125, v122, v106
    v_fma_f32 v106, v127, v123, v125
    v_mul_f32 v126, v107, v123
    v_fma_f32 v128, -v126, v122, v107
    v_fma_f32 v107, v128, v123, v126
    v_cvt_pk_bf16_f32 v39, v106, v107
    v_sub_f32 v108, v108, v121
    v_sub_f32 v109, v109, v121
    v_cvt_pk_bf16_f32 v40, v108, v109
    v_lshlrev_b32 v108, 16, v40
    v_and_b32 v109, 0xffff0000, v40
    v_mul_f32 v125, v108, v123
    v_fma_f32 v127, -v125, v122, v108
    v_fma_f32 v108, v127, v123, v125
    v_mul_f32 v126, v109, v123
    v_fma_f32 v128, -v126, v122, v109
    v_fma_f32 v109, v128, v123, v126
    v_cvt_pk_bf16_f32 v40, v108, v109
    v_sub_f32 v110, v110, v121
    v_sub_f32 v111, v111, v121
    v_cvt_pk_bf16_f32 v41, v110, v111
    v_lshlrev_b32 v110, 16, v41
    v_and_b32 v111, 0xffff0000, v41
    v_mul_f32 v125, v110, v123
    v_fma_f32 v127, -v125, v122, v110
    v_fma_f32 v110, v127, v123, v125
    v_mul_f32 v126, v111, v123
    v_fma_f32 v128, -v126, v122, v111
    v_fma_f32 v111, v128, v123, v126
    v_cvt_pk_bf16_f32 v41, v110, v111
    v_sub_f32 v112, v112, v121
    v_sub_f32 v113, v113, v121
    v_cvt_pk_bf16_f32 v42, v112, v113
    v_lshlrev_b32 v112, 16, v42
    v_and_b32 v113, 0xffff0000, v42
    v_mul_f32 v125, v112, v123
    v_fma_f32 v127, -v125, v122, v112
    v_fma_f32 v112, v127, v123, v125
    v_mul_f32 v126, v113, v123
    v_fma_f32 v128, -v126, v122, v113
    v_fma_f32 v113, v128, v123, v126
    v_cvt_pk_bf16_f32 v42, v112, v113
    v_sub_f32 v114, v114, v121
    v_sub_f32 v115, v115, v121
    v_cvt_pk_bf16_f32 v43, v114, v115
    v_lshlrev_b32 v114, 16, v43
    v_and_b32 v115, 0xffff0000, v43
    v_mul_f32 v125, v114, v123
    v_fma_f32 v127, -v125, v122, v114
    v_fma_f32 v114, v127, v123, v125
    v_mul_f32 v126, v115, v123
    v_fma_f32 v128, -v126, v122, v115
    v_fma_f32 v115, v128, v123, v126
    v_cvt_pk_bf16_f32 v43, v114, v115
    buffer_store_dwordx4 v[8:11], v3, s[36:39], 0 offen offset:0
    buffer_store_dwordx4 v[12:15], v3, s[36:39], 0 offen offset:128
    buffer_store_dwordx4 v[16:19], v3, s[36:39], 0 offen offset:256
    buffer_store_dwordx4 v[20:23], v3, s[36:39], 0 offen offset:384
    buffer_store_dwordx4 v[24:27], v3, s[36:39], 0 offen offset:512
    buffer_store_dwordx4 v[28:31], v3, s[36:39], 0 offen offset:640
    buffer_store_dwordx4 v[32:35], v3, s[36:39], 0 offen offset:768
    buffer_store_dwordx4 v[36:39], v3, s[36:39], 0 offen offset:896
    buffer_store_dwordx4 v[40:43], v3, s[36:39], 0 offen offset:1024
L_ln3_kernel_end:
    s_endpgm
.globl post2_kernel
.p2align 8
.type post2_kernel,@function
post2_kernel:
    s_cmp_ge_u32 s2, 256
    s_cbranch_scc1 L_post2_kernel_end
    s_load_dwordx16 s[4:19], s[0:1], 0
    s_load_dwordx8 s[20:27], s[0:1], 64
    s_lshl_b32 s28, s2, 3
    v_lshrrev_b32 v3, 3, v0
    v_add_u32 v3, s28, v3
    v_and_b32 v4, 7, v0
    s_movk_i32 s29, 1152
    v_mul_lo_u32 v5, v3, s29
    v_lshl_add_u32 v5, v4, 4, v5
    v_lshlrev_b32 v6, 1, v5
    s_waitcnt lgkmcnt(0)
    s_add_u32 s32, s26, 0x19b8000
    s_addc_u32 s33, s27, 0
    s_and_b32 s33, s33, 0xffff
    s_mov_b32 s34, 0x240000
    s_mov_b32 s35, 0x00020000
    s_mov_b32 s36, s22
    s_mov_b32 s37, s23
    s_and_b32 s37, s37, 0xffff
    s_mov_b32 s38, 0x240000
    s_mov_b32 s39, 0x00020000
    s_add_u32 s40, s26, 0x2078000
    s_addc_u32 s41, s27, 0
    s_and_b32 s41, s41, 0xffff
    s_mov_b32 s42, 0x1200000
    s_mov_b32 s43, 0x00020000
    s_add_u32 s44, s26, 0x298000
    s_addc_u32 s45, s27, 0
    s_and_b32 s45, s45, 0xffff
    s_mov_b32 s46, 0x240000
    s_mov_b32 s47, 0x00020000
    buffer_load_dwordx4 v[8:11], v5, s[32:35], 0 offen offset:0
    buffer_load_dwordx4 v[12:15], v5, s[32:35], 0 offen offset:128
    buffer_load_dwordx4 v[16:19], v5, s[32:35], 0 offen offset:256
    buffer_load_dwordx4 v[20:23], v5, s[32:35], 0 offen offset:384
    buffer_load_dwordx4 v[24:27], v5, s[32:35], 0 offen offset:512
    buffer_load_dwordx4 v[28:31], v5, s[32:35], 0 offen offset:640
    buffer_load_dwordx4 v[32:35], v5, s[32:35], 0 offen offset:768
    buffer_load_dwordx4 v[36:39], v5, s[32:35], 0 offen offset:896
    buffer_load_dwordx4 v[40:43], v5, s[32:35], 0 offen offset:1024
    s_mov_b32 s48, 0
    buffer_load_dwordx4 v[48:51], v6, s[40:43], s48 offen offset:0
    buffer_load_dwordx4 v[52:55], v6, s[40:43], s48 offen offset:16
    s_mov_b32 s48, 4718592
    buffer_load_dwordx4 v[56:59], v6, s[40:43], s48 offen offset:0
    buffer_load_dwordx4 v[60:63], v6, s[40:43], s48 offen offset:16
    s_mov_b32 s48, 9437184
    buffer_load_dwordx4 v[64:67], v6, s[40:43], s48 offen offset:0
    buffer_load_dwordx4 v[68:71], v6, s[40:43], s48 offen offset:16
    s_mov_b32 s48, 14155776
    buffer_load_dwordx4 v[72:75], v6, s[40:43], s48 offen offset:0
    buffer_load_dwordx4 v[76:79], v6, s[40:43], s48 offen offset:16
    s_mov_b32 s48, 0
    buffer_load_dwordx4 v[80:83], v6, s[40:43], s48 offen offset:256
    buffer_load_dwordx4 v[84:87], v6, s[40:43], s48 offen offset:272
    s_mov_b32 s48, 4718592
    buffer_load_dwordx4 v[88:91], v6, s[40:43], s48 offen offset:256
    buffer_load_dwordx4 v[92:95], v6, s[40:43], s48 offen offset:272
    s_mov_b32 s48, 9437184
    buffer_load_dwordx4 v[96:99], v6, s[40:43], s48 offen offset:256
    buffer_load_dwordx4 v[100:103], v6, s[40:43], s48 offen offset:272
    s_mov_b32 s48, 14155776
    buffer_load_dwordx4 v[104:107], v6, s[40:43], s48 offen offset:256
    buffer_load_dwordx4 v[108:111], v6, s[40:43], s48 offen offset:272
    s_mov_b32 s48, 0
    buffer_load_dwordx4 v[112:115], v6, s[40:43], s48 offen offset:512
    buffer_load_dwordx4 v[116:119], v6, s[40:43], s48 offen offset:528
    s_mov_b32 s48, 4718592
    buffer_load_dwordx4 v[120:123], v6, s[40:43], s48 offen offset:512
    buffer_load_dwordx4 v[124:127], v6, s[40:43], s48 offen offset:528
    s_mov_b32 s48, 9437184
    buffer_load_dwordx4 v[128:131], v6, s[40:43], s48 offen offset:512
    buffer_load_dwordx4 v[132:135], v6, s[40:43], s48 offen offset:528
    s_mov_b32 s48, 14155776
    buffer_load_dwordx4 v[136:139], v6, s[40:43], s48 offen offset:512
    buffer_load_dwordx4 v[140:143], v6, s[40:43], s48 offen offset:528
    s_waitcnt vmcnt(16)
    v_add_f32 v48, v48, v56
    v_add_f32 v64, v64, v72
    v_cvt_pk_bf16_f32 v48, v48, v64
    v_lshlrev_b32 v56, 16, v48
    v_and_b32 v64, 0xffff0000, v48
    v_sub_f32 v48, v56, v64
    v_cvt_pk_bf16_f32 v48, v48, v48
    v_lshlrev_b32 v48, 16, v48
    v_lshlrev_b32 v56, 16, v8
    v_add_f32 v48, v48, v56
    v_add_f32 v49, v49, v57
    v_add_f32 v65, v65, v73
    v_cvt_pk_bf16_f32 v49, v49, v65
    v_lshlrev_b32 v57, 16, v49
    v_and_b32 v65, 0xffff0000, v49
    v_sub_f32 v49, v57, v65
    v_cvt_pk_bf16_f32 v49, v49, v49
    v_lshlrev_b32 v49, 16, v49
    v_and_b32 v57, 0xffff0000, v8
    v_add_f32 v49, v49, v57
    v_add_f32 v50, v50, v58
    v_add_f32 v66, v66, v74
    v_cvt_pk_bf16_f32 v50, v50, v66
    v_lshlrev_b32 v58, 16, v50
    v_and_b32 v66, 0xffff0000, v50
    v_sub_f32 v50, v58, v66
    v_cvt_pk_bf16_f32 v50, v50, v50
    v_lshlrev_b32 v50, 16, v50
    v_lshlrev_b32 v58, 16, v9
    v_add_f32 v50, v50, v58
    v_add_f32 v51, v51, v59
    v_add_f32 v67, v67, v75
    v_cvt_pk_bf16_f32 v51, v51, v67
    v_lshlrev_b32 v59, 16, v51
    v_and_b32 v67, 0xffff0000, v51
    v_sub_f32 v51, v59, v67
    v_cvt_pk_bf16_f32 v51, v51, v51
    v_lshlrev_b32 v51, 16, v51
    v_and_b32 v59, 0xffff0000, v9
    v_add_f32 v51, v51, v59
    v_add_f32 v52, v52, v60
    v_add_f32 v68, v68, v76
    v_cvt_pk_bf16_f32 v52, v52, v68
    v_lshlrev_b32 v60, 16, v52
    v_and_b32 v68, 0xffff0000, v52
    v_sub_f32 v52, v60, v68
    v_cvt_pk_bf16_f32 v52, v52, v52
    v_lshlrev_b32 v52, 16, v52
    v_lshlrev_b32 v60, 16, v10
    v_add_f32 v52, v52, v60
    v_add_f32 v53, v53, v61
    v_add_f32 v69, v69, v77
    v_cvt_pk_bf16_f32 v53, v53, v69
    v_lshlrev_b32 v61, 16, v53
    v_and_b32 v69, 0xffff0000, v53
    v_sub_f32 v53, v61, v69
    v_cvt_pk_bf16_f32 v53, v53, v53
    v_lshlrev_b32 v53, 16, v53
    v_and_b32 v61, 0xffff0000, v10
    v_add_f32 v53, v53, v61
    v_add_f32 v54, v54, v62
    v_add_f32 v70, v70, v78
    v_cvt_pk_bf16_f32 v54, v54, v70
    v_lshlrev_b32 v62, 16, v54
    v_and_b32 v70, 0xffff0000, v54
    v_sub_f32 v54, v62, v70
    v_cvt_pk_bf16_f32 v54, v54, v54
    v_lshlrev_b32 v54, 16, v54
    v_lshlrev_b32 v62, 16, v11
    v_add_f32 v54, v54, v62
    v_add_f32 v55, v55, v63
    v_add_f32 v71, v71, v79
    v_cvt_pk_bf16_f32 v55, v55, v71
    v_lshlrev_b32 v63, 16, v55
    v_and_b32 v71, 0xffff0000, v55
    v_sub_f32 v55, v63, v71
    v_cvt_pk_bf16_f32 v55, v55, v55
    v_lshlrev_b32 v55, 16, v55
    v_and_b32 v63, 0xffff0000, v11
    v_add_f32 v55, v55, v63
    v_cvt_pk_bf16_f32 v8, v48, v49
    v_cvt_pk_bf16_f32 v9, v50, v51
    v_cvt_pk_bf16_f32 v10, v52, v53
    v_cvt_pk_bf16_f32 v11, v54, v55
    s_waitcnt vmcnt(8)
    v_add_f32 v80, v80, v88
    v_add_f32 v96, v96, v104
    v_cvt_pk_bf16_f32 v80, v80, v96
    v_lshlrev_b32 v88, 16, v80
    v_and_b32 v96, 0xffff0000, v80
    v_sub_f32 v80, v88, v96
    v_cvt_pk_bf16_f32 v80, v80, v80
    v_lshlrev_b32 v80, 16, v80
    v_lshlrev_b32 v88, 16, v12
    v_add_f32 v80, v80, v88
    v_add_f32 v81, v81, v89
    v_add_f32 v97, v97, v105
    v_cvt_pk_bf16_f32 v81, v81, v97
    v_lshlrev_b32 v89, 16, v81
    v_and_b32 v97, 0xffff0000, v81
    v_sub_f32 v81, v89, v97
    v_cvt_pk_bf16_f32 v81, v81, v81
    v_lshlrev_b32 v81, 16, v81
    v_and_b32 v89, 0xffff0000, v12
    v_add_f32 v81, v81, v89
    v_add_f32 v82, v82, v90
    v_add_f32 v98, v98, v106
    v_cvt_pk_bf16_f32 v82, v82, v98
    v_lshlrev_b32 v90, 16, v82
    v_and_b32 v98, 0xffff0000, v82
    v_sub_f32 v82, v90, v98
    v_cvt_pk_bf16_f32 v82, v82, v82
    v_lshlrev_b32 v82, 16, v82
    v_lshlrev_b32 v90, 16, v13
    v_add_f32 v82, v82, v90
    v_add_f32 v83, v83, v91
    v_add_f32 v99, v99, v107
    v_cvt_pk_bf16_f32 v83, v83, v99
    v_lshlrev_b32 v91, 16, v83
    v_and_b32 v99, 0xffff0000, v83
    v_sub_f32 v83, v91, v99
    v_cvt_pk_bf16_f32 v83, v83, v83
    v_lshlrev_b32 v83, 16, v83
    v_and_b32 v91, 0xffff0000, v13
    v_add_f32 v83, v83, v91
    v_add_f32 v84, v84, v92
    v_add_f32 v100, v100, v108
    v_cvt_pk_bf16_f32 v84, v84, v100
    v_lshlrev_b32 v92, 16, v84
    v_and_b32 v100, 0xffff0000, v84
    v_sub_f32 v84, v92, v100
    v_cvt_pk_bf16_f32 v84, v84, v84
    v_lshlrev_b32 v84, 16, v84
    v_lshlrev_b32 v92, 16, v14
    v_add_f32 v84, v84, v92
    v_add_f32 v85, v85, v93
    v_add_f32 v101, v101, v109
    v_cvt_pk_bf16_f32 v85, v85, v101
    v_lshlrev_b32 v93, 16, v85
    v_and_b32 v101, 0xffff0000, v85
    v_sub_f32 v85, v93, v101
    v_cvt_pk_bf16_f32 v85, v85, v85
    v_lshlrev_b32 v85, 16, v85
    v_and_b32 v93, 0xffff0000, v14
    v_add_f32 v85, v85, v93
    v_add_f32 v86, v86, v94
    v_add_f32 v102, v102, v110
    v_cvt_pk_bf16_f32 v86, v86, v102
    v_lshlrev_b32 v94, 16, v86
    v_and_b32 v102, 0xffff0000, v86
    v_sub_f32 v86, v94, v102
    v_cvt_pk_bf16_f32 v86, v86, v86
    v_lshlrev_b32 v86, 16, v86
    v_lshlrev_b32 v94, 16, v15
    v_add_f32 v86, v86, v94
    v_add_f32 v87, v87, v95
    v_add_f32 v103, v103, v111
    v_cvt_pk_bf16_f32 v87, v87, v103
    v_lshlrev_b32 v95, 16, v87
    v_and_b32 v103, 0xffff0000, v87
    v_sub_f32 v87, v95, v103
    v_cvt_pk_bf16_f32 v87, v87, v87
    v_lshlrev_b32 v87, 16, v87
    v_and_b32 v95, 0xffff0000, v15
    v_add_f32 v87, v87, v95
    v_cvt_pk_bf16_f32 v12, v80, v81
    v_cvt_pk_bf16_f32 v13, v82, v83
    v_cvt_pk_bf16_f32 v14, v84, v85
    v_cvt_pk_bf16_f32 v15, v86, v87
    s_waitcnt vmcnt(0)
    v_add_f32 v112, v112, v120
    v_add_f32 v128, v128, v136
    v_cvt_pk_bf16_f32 v112, v112, v128
    v_lshlrev_b32 v120, 16, v112
    v_and_b32 v128, 0xffff0000, v112
    v_sub_f32 v112, v120, v128
    v_cvt_pk_bf16_f32 v112, v112, v112
    v_lshlrev_b32 v112, 16, v112
    v_lshlrev_b32 v120, 16, v16
    v_add_f32 v112, v112, v120
    v_add_f32 v113, v113, v121
    v_add_f32 v129, v129, v137
    v_cvt_pk_bf16_f32 v113, v113, v129
    v_lshlrev_b32 v121, 16, v113
    v_and_b32 v129, 0xffff0000, v113
    v_sub_f32 v113, v121, v129
    v_cvt_pk_bf16_f32 v113, v113, v113
    v_lshlrev_b32 v113, 16, v113
    v_and_b32 v121, 0xffff0000, v16
    v_add_f32 v113, v113, v121
    v_add_f32 v114, v114, v122
    v_add_f32 v130, v130, v138
    v_cvt_pk_bf16_f32 v114, v114, v130
    v_lshlrev_b32 v122, 16, v114
    v_and_b32 v130, 0xffff0000, v114
    v_sub_f32 v114, v122, v130
    v_cvt_pk_bf16_f32 v114, v114, v114
    v_lshlrev_b32 v114, 16, v114
    v_lshlrev_b32 v122, 16, v17
    v_add_f32 v114, v114, v122
    v_add_f32 v115, v115, v123
    v_add_f32 v131, v131, v139
    v_cvt_pk_bf16_f32 v115, v115, v131
    v_lshlrev_b32 v123, 16, v115
    v_and_b32 v131, 0xffff0000, v115
    v_sub_f32 v115, v123, v131
    v_cvt_pk_bf16_f32 v115, v115, v115
    v_lshlrev_b32 v115, 16, v115
    v_and_b32 v123, 0xffff0000, v17
    v_add_f32 v115, v115, v123
    v_add_f32 v116, v116, v124
    v_add_f32 v132, v132, v140
    v_cvt_pk_bf16_f32 v116, v116, v132
    v_lshlrev_b32 v124, 16, v116
    v_and_b32 v132, 0xffff0000, v116
    v_sub_f32 v116, v124, v132
    v_cvt_pk_bf16_f32 v116, v116, v116
    v_lshlrev_b32 v116, 16, v116
    v_lshlrev_b32 v124, 16, v18
    v_add_f32 v116, v116, v124
    v_add_f32 v117, v117, v125
    v_add_f32 v133, v133, v141
    v_cvt_pk_bf16_f32 v117, v117, v133
    v_lshlrev_b32 v125, 16, v117
    v_and_b32 v133, 0xffff0000, v117
    v_sub_f32 v117, v125, v133
    v_cvt_pk_bf16_f32 v117, v117, v117
    v_lshlrev_b32 v117, 16, v117
    v_and_b32 v125, 0xffff0000, v18
    v_add_f32 v117, v117, v125
    v_add_f32 v118, v118, v126
    v_add_f32 v134, v134, v142
    v_cvt_pk_bf16_f32 v118, v118, v134
    v_lshlrev_b32 v126, 16, v118
    v_and_b32 v134, 0xffff0000, v118
    v_sub_f32 v118, v126, v134
    v_cvt_pk_bf16_f32 v118, v118, v118
    v_lshlrev_b32 v118, 16, v118
    v_lshlrev_b32 v126, 16, v19
    v_add_f32 v118, v118, v126
    v_add_f32 v119, v119, v127
    v_add_f32 v135, v135, v143
    v_cvt_pk_bf16_f32 v119, v119, v135
    v_lshlrev_b32 v127, 16, v119
    v_and_b32 v135, 0xffff0000, v119
    v_sub_f32 v119, v127, v135
    v_cvt_pk_bf16_f32 v119, v119, v119
    v_lshlrev_b32 v119, 16, v119
    v_and_b32 v127, 0xffff0000, v19
    v_add_f32 v119, v119, v127
    v_cvt_pk_bf16_f32 v16, v112, v113
    v_cvt_pk_bf16_f32 v17, v114, v115
    v_cvt_pk_bf16_f32 v18, v116, v117
    v_cvt_pk_bf16_f32 v19, v118, v119
    s_mov_b32 s48, 0
    buffer_load_dwordx4 v[48:51], v6, s[40:43], s48 offen offset:768
    buffer_load_dwordx4 v[52:55], v6, s[40:43], s48 offen offset:784
    s_mov_b32 s48, 4718592
    buffer_load_dwordx4 v[56:59], v6, s[40:43], s48 offen offset:768
    buffer_load_dwordx4 v[60:63], v6, s[40:43], s48 offen offset:784
    s_mov_b32 s48, 9437184
    buffer_load_dwordx4 v[64:67], v6, s[40:43], s48 offen offset:768
    buffer_load_dwordx4 v[68:71], v6, s[40:43], s48 offen offset:784
    s_mov_b32 s48, 14155776
    buffer_load_dwordx4 v[72:75], v6, s[40:43], s48 offen offset:768
    buffer_load_dwordx4 v[76:79], v6, s[40:43], s48 offen offset:784
    s_mov_b32 s48, 0
    buffer_load_dwordx4 v[80:83], v6, s[40:43], s48 offen offset:1024
    buffer_load_dwordx4 v[84:87], v6, s[40:43], s48 offen offset:1040
    s_mov_b32 s48, 4718592
    buffer_load_dwordx4 v[88:91], v6, s[40:43], s48 offen offset:1024
    buffer_load_dwordx4 v[92:95], v6, s[40:43], s48 offen offset:1040
    s_mov_b32 s48, 9437184
    buffer_load_dwordx4 v[96:99], v6, s[40:43], s48 offen offset:1024
    buffer_load_dwordx4 v[100:103], v6, s[40:43], s48 offen offset:1040
    s_mov_b32 s48, 14155776
    buffer_load_dwordx4 v[104:107], v6, s[40:43], s48 offen offset:1024
    buffer_load_dwordx4 v[108:111], v6, s[40:43], s48 offen offset:1040
    s_mov_b32 s48, 0
    buffer_load_dwordx4 v[112:115], v6, s[40:43], s48 offen offset:1280
    buffer_load_dwordx4 v[116:119], v6, s[40:43], s48 offen offset:1296
    s_mov_b32 s48, 4718592
    buffer_load_dwordx4 v[120:123], v6, s[40:43], s48 offen offset:1280
    buffer_load_dwordx4 v[124:127], v6, s[40:43], s48 offen offset:1296
    s_mov_b32 s48, 9437184
    buffer_load_dwordx4 v[128:131], v6, s[40:43], s48 offen offset:1280
    buffer_load_dwordx4 v[132:135], v6, s[40:43], s48 offen offset:1296
    s_mov_b32 s48, 14155776
    buffer_load_dwordx4 v[136:139], v6, s[40:43], s48 offen offset:1280
    buffer_load_dwordx4 v[140:143], v6, s[40:43], s48 offen offset:1296
    s_waitcnt vmcnt(16)
    v_add_f32 v48, v48, v56
    v_add_f32 v64, v64, v72
    v_cvt_pk_bf16_f32 v48, v48, v64
    v_lshlrev_b32 v56, 16, v48
    v_and_b32 v64, 0xffff0000, v48
    v_sub_f32 v48, v56, v64
    v_cvt_pk_bf16_f32 v48, v48, v48
    v_lshlrev_b32 v48, 16, v48
    v_lshlrev_b32 v56, 16, v20
    v_add_f32 v48, v48, v56
    v_add_f32 v49, v49, v57
    v_add_f32 v65, v65, v73
    v_cvt_pk_bf16_f32 v49, v49, v65
    v_lshlrev_b32 v57, 16, v49
    v_and_b32 v65, 0xffff0000, v49
    v_sub_f32 v49, v57, v65
    v_cvt_pk_bf16_f32 v49, v49, v49
    v_lshlrev_b32 v49, 16, v49
    v_and_b32 v57, 0xffff0000, v20
    v_add_f32 v49, v49, v57
    v_add_f32 v50, v50, v58
    v_add_f32 v66, v66, v74
    v_cvt_pk_bf16_f32 v50, v50, v66
    v_lshlrev_b32 v58, 16, v50
    v_and_b32 v66, 0xffff0000, v50
    v_sub_f32 v50, v58, v66
    v_cvt_pk_bf16_f32 v50, v50, v50
    v_lshlrev_b32 v50, 16, v50
    v_lshlrev_b32 v58, 16, v21
    v_add_f32 v50, v50, v58
    v_add_f32 v51, v51, v59
    v_add_f32 v67, v67, v75
    v_cvt_pk_bf16_f32 v51, v51, v67
    v_lshlrev_b32 v59, 16, v51
    v_and_b32 v67, 0xffff0000, v51
    v_sub_f32 v51, v59, v67
    v_cvt_pk_bf16_f32 v51, v51, v51
    v_lshlrev_b32 v51, 16, v51
    v_and_b32 v59, 0xffff0000, v21
    v_add_f32 v51, v51, v59
    v_add_f32 v52, v52, v60
    v_add_f32 v68, v68, v76
    v_cvt_pk_bf16_f32 v52, v52, v68
    v_lshlrev_b32 v60, 16, v52
    v_and_b32 v68, 0xffff0000, v52
    v_sub_f32 v52, v60, v68
    v_cvt_pk_bf16_f32 v52, v52, v52
    v_lshlrev_b32 v52, 16, v52
    v_lshlrev_b32 v60, 16, v22
    v_add_f32 v52, v52, v60
    v_add_f32 v53, v53, v61
    v_add_f32 v69, v69, v77
    v_cvt_pk_bf16_f32 v53, v53, v69
    v_lshlrev_b32 v61, 16, v53
    v_and_b32 v69, 0xffff0000, v53
    v_sub_f32 v53, v61, v69
    v_cvt_pk_bf16_f32 v53, v53, v53
    v_lshlrev_b32 v53, 16, v53
    v_and_b32 v61, 0xffff0000, v22
    v_add_f32 v53, v53, v61
    v_add_f32 v54, v54, v62
    v_add_f32 v70, v70, v78
    v_cvt_pk_bf16_f32 v54, v54, v70
    v_lshlrev_b32 v62, 16, v54
    v_and_b32 v70, 0xffff0000, v54
    v_sub_f32 v54, v62, v70
    v_cvt_pk_bf16_f32 v54, v54, v54
    v_lshlrev_b32 v54, 16, v54
    v_lshlrev_b32 v62, 16, v23
    v_add_f32 v54, v54, v62
    v_add_f32 v55, v55, v63
    v_add_f32 v71, v71, v79
    v_cvt_pk_bf16_f32 v55, v55, v71
    v_lshlrev_b32 v63, 16, v55
    v_and_b32 v71, 0xffff0000, v55
    v_sub_f32 v55, v63, v71
    v_cvt_pk_bf16_f32 v55, v55, v55
    v_lshlrev_b32 v55, 16, v55
    v_and_b32 v63, 0xffff0000, v23
    v_add_f32 v55, v55, v63
    v_cvt_pk_bf16_f32 v20, v48, v49
    v_cvt_pk_bf16_f32 v21, v50, v51
    v_cvt_pk_bf16_f32 v22, v52, v53
    v_cvt_pk_bf16_f32 v23, v54, v55
    s_waitcnt vmcnt(8)
    v_add_f32 v80, v80, v88
    v_add_f32 v96, v96, v104
    v_cvt_pk_bf16_f32 v80, v80, v96
    v_lshlrev_b32 v88, 16, v80
    v_and_b32 v96, 0xffff0000, v80
    v_sub_f32 v80, v88, v96
    v_cvt_pk_bf16_f32 v80, v80, v80
    v_lshlrev_b32 v80, 16, v80
    v_lshlrev_b32 v88, 16, v24
    v_add_f32 v80, v80, v88
    v_add_f32 v81, v81, v89
    v_add_f32 v97, v97, v105
    v_cvt_pk_bf16_f32 v81, v81, v97
    v_lshlrev_b32 v89, 16, v81
    v_and_b32 v97, 0xffff0000, v81
    v_sub_f32 v81, v89, v97
    v_cvt_pk_bf16_f32 v81, v81, v81
    v_lshlrev_b32 v81, 16, v81
    v_and_b32 v89, 0xffff0000, v24
    v_add_f32 v81, v81, v89
    v_add_f32 v82, v82, v90
    v_add_f32 v98, v98, v106
    v_cvt_pk_bf16_f32 v82, v82, v98
    v_lshlrev_b32 v90, 16, v82
    v_and_b32 v98, 0xffff0000, v82
    v_sub_f32 v82, v90, v98
    v_cvt_pk_bf16_f32 v82, v82, v82
    v_lshlrev_b32 v82, 16, v82
    v_lshlrev_b32 v90, 16, v25
    v_add_f32 v82, v82, v90
    v_add_f32 v83, v83, v91
    v_add_f32 v99, v99, v107
    v_cvt_pk_bf16_f32 v83, v83, v99
    v_lshlrev_b32 v91, 16, v83
    v_and_b32 v99, 0xffff0000, v83
    v_sub_f32 v83, v91, v99
    v_cvt_pk_bf16_f32 v83, v83, v83
    v_lshlrev_b32 v83, 16, v83
    v_and_b32 v91, 0xffff0000, v25
    v_add_f32 v83, v83, v91
    v_add_f32 v84, v84, v92
    v_add_f32 v100, v100, v108
    v_cvt_pk_bf16_f32 v84, v84, v100
    v_lshlrev_b32 v92, 16, v84
    v_and_b32 v100, 0xffff0000, v84
    v_sub_f32 v84, v92, v100
    v_cvt_pk_bf16_f32 v84, v84, v84
    v_lshlrev_b32 v84, 16, v84
    v_lshlrev_b32 v92, 16, v26
    v_add_f32 v84, v84, v92
    v_add_f32 v85, v85, v93
    v_add_f32 v101, v101, v109
    v_cvt_pk_bf16_f32 v85, v85, v101
    v_lshlrev_b32 v93, 16, v85
    v_and_b32 v101, 0xffff0000, v85
    v_sub_f32 v85, v93, v101
    v_cvt_pk_bf16_f32 v85, v85, v85
    v_lshlrev_b32 v85, 16, v85
    v_and_b32 v93, 0xffff0000, v26
    v_add_f32 v85, v85, v93
    v_add_f32 v86, v86, v94
    v_add_f32 v102, v102, v110
    v_cvt_pk_bf16_f32 v86, v86, v102
    v_lshlrev_b32 v94, 16, v86
    v_and_b32 v102, 0xffff0000, v86
    v_sub_f32 v86, v94, v102
    v_cvt_pk_bf16_f32 v86, v86, v86
    v_lshlrev_b32 v86, 16, v86
    v_lshlrev_b32 v94, 16, v27
    v_add_f32 v86, v86, v94
    v_add_f32 v87, v87, v95
    v_add_f32 v103, v103, v111
    v_cvt_pk_bf16_f32 v87, v87, v103
    v_lshlrev_b32 v95, 16, v87
    v_and_b32 v103, 0xffff0000, v87
    v_sub_f32 v87, v95, v103
    v_cvt_pk_bf16_f32 v87, v87, v87
    v_lshlrev_b32 v87, 16, v87
    v_and_b32 v95, 0xffff0000, v27
    v_add_f32 v87, v87, v95
    v_cvt_pk_bf16_f32 v24, v80, v81
    v_cvt_pk_bf16_f32 v25, v82, v83
    v_cvt_pk_bf16_f32 v26, v84, v85
    v_cvt_pk_bf16_f32 v27, v86, v87
    s_waitcnt vmcnt(0)
    v_add_f32 v112, v112, v120
    v_add_f32 v128, v128, v136
    v_cvt_pk_bf16_f32 v112, v112, v128
    v_lshlrev_b32 v120, 16, v112
    v_and_b32 v128, 0xffff0000, v112
    v_sub_f32 v112, v120, v128
    v_cvt_pk_bf16_f32 v112, v112, v112
    v_lshlrev_b32 v112, 16, v112
    v_lshlrev_b32 v120, 16, v28
    v_add_f32 v112, v112, v120
    v_add_f32 v113, v113, v121
    v_add_f32 v129, v129, v137
    v_cvt_pk_bf16_f32 v113, v113, v129
    v_lshlrev_b32 v121, 16, v113
    v_and_b32 v129, 0xffff0000, v113
    v_sub_f32 v113, v121, v129
    v_cvt_pk_bf16_f32 v113, v113, v113
    v_lshlrev_b32 v113, 16, v113
    v_and_b32 v121, 0xffff0000, v28
    v_add_f32 v113, v113, v121
    v_add_f32 v114, v114, v122
    v_add_f32 v130, v130, v138
    v_cvt_pk_bf16_f32 v114, v114, v130
    v_lshlrev_b32 v122, 16, v114
    v_and_b32 v130, 0xffff0000, v114
    v_sub_f32 v114, v122, v130
    v_cvt_pk_bf16_f32 v114, v114, v114
    v_lshlrev_b32 v114, 16, v114
    v_lshlrev_b32 v122, 16, v29
    v_add_f32 v114, v114, v122
    v_add_f32 v115, v115, v123
    v_add_f32 v131, v131, v139
    v_cvt_pk_bf16_f32 v115, v115, v131
    v_lshlrev_b32 v123, 16, v115
    v_and_b32 v131, 0xffff0000, v115
    v_sub_f32 v115, v123, v131
    v_cvt_pk_bf16_f32 v115, v115, v115
    v_lshlrev_b32 v115, 16, v115
    v_and_b32 v123, 0xffff0000, v29
    v_add_f32 v115, v115, v123
    v_add_f32 v116, v116, v124
    v_add_f32 v132, v132, v140
    v_cvt_pk_bf16_f32 v116, v116, v132
    v_lshlrev_b32 v124, 16, v116
    v_and_b32 v132, 0xffff0000, v116
    v_sub_f32 v116, v124, v132
    v_cvt_pk_bf16_f32 v116, v116, v116
    v_lshlrev_b32 v116, 16, v116
    v_lshlrev_b32 v124, 16, v30
    v_add_f32 v116, v116, v124
    v_add_f32 v117, v117, v125
    v_add_f32 v133, v133, v141
    v_cvt_pk_bf16_f32 v117, v117, v133
    v_lshlrev_b32 v125, 16, v117
    v_and_b32 v133, 0xffff0000, v117
    v_sub_f32 v117, v125, v133
    v_cvt_pk_bf16_f32 v117, v117, v117
    v_lshlrev_b32 v117, 16, v117
    v_and_b32 v125, 0xffff0000, v30
    v_add_f32 v117, v117, v125
    v_add_f32 v118, v118, v126
    v_add_f32 v134, v134, v142
    v_cvt_pk_bf16_f32 v118, v118, v134
    v_lshlrev_b32 v126, 16, v118
    v_and_b32 v134, 0xffff0000, v118
    v_sub_f32 v118, v126, v134
    v_cvt_pk_bf16_f32 v118, v118, v118
    v_lshlrev_b32 v118, 16, v118
    v_lshlrev_b32 v126, 16, v31
    v_add_f32 v118, v118, v126
    v_add_f32 v119, v119, v127
    v_add_f32 v135, v135, v143
    v_cvt_pk_bf16_f32 v119, v119, v135
    v_lshlrev_b32 v127, 16, v119
    v_and_b32 v135, 0xffff0000, v119
    v_sub_f32 v119, v127, v135
    v_cvt_pk_bf16_f32 v119, v119, v119
    v_lshlrev_b32 v119, 16, v119
    v_and_b32 v127, 0xffff0000, v31
    v_add_f32 v119, v119, v127
    v_cvt_pk_bf16_f32 v28, v112, v113
    v_cvt_pk_bf16_f32 v29, v114, v115
    v_cvt_pk_bf16_f32 v30, v116, v117
    v_cvt_pk_bf16_f32 v31, v118, v119
    s_mov_b32 s48, 0
    buffer_load_dwordx4 v[48:51], v6, s[40:43], s48 offen offset:1536
    buffer_load_dwordx4 v[52:55], v6, s[40:43], s48 offen offset:1552
    s_mov_b32 s48, 4718592
    buffer_load_dwordx4 v[56:59], v6, s[40:43], s48 offen offset:1536
    buffer_load_dwordx4 v[60:63], v6, s[40:43], s48 offen offset:1552
    s_mov_b32 s48, 9437184
    buffer_load_dwordx4 v[64:67], v6, s[40:43], s48 offen offset:1536
    buffer_load_dwordx4 v[68:71], v6, s[40:43], s48 offen offset:1552
    s_mov_b32 s48, 14155776
    buffer_load_dwordx4 v[72:75], v6, s[40:43], s48 offen offset:1536
    buffer_load_dwordx4 v[76:79], v6, s[40:43], s48 offen offset:1552
    s_mov_b32 s48, 0
    buffer_load_dwordx4 v[80:83], v6, s[40:43], s48 offen offset:1792
    buffer_load_dwordx4 v[84:87], v6, s[40:43], s48 offen offset:1808
    s_mov_b32 s48, 4718592
    buffer_load_dwordx4 v[88:91], v6, s[40:43], s48 offen offset:1792
    buffer_load_dwordx4 v[92:95], v6, s[40:43], s48 offen offset:1808
    s_mov_b32 s48, 9437184
    buffer_load_dwordx4 v[96:99], v6, s[40:43], s48 offen offset:1792
    buffer_load_dwordx4 v[100:103], v6, s[40:43], s48 offen offset:1808
    s_mov_b32 s48, 14155776
    buffer_load_dwordx4 v[104:107], v6, s[40:43], s48 offen offset:1792
    buffer_load_dwordx4 v[108:111], v6, s[40:43], s48 offen offset:1808
    s_mov_b32 s48, 0
    buffer_load_dwordx4 v[112:115], v6, s[40:43], s48 offen offset:2048
    buffer_load_dwordx4 v[116:119], v6, s[40:43], s48 offen offset:2064
    s_mov_b32 s48, 4718592
    buffer_load_dwordx4 v[120:123], v6, s[40:43], s48 offen offset:2048
    buffer_load_dwordx4 v[124:127], v6, s[40:43], s48 offen offset:2064
    s_mov_b32 s48, 9437184
    buffer_load_dwordx4 v[128:131], v6, s[40:43], s48 offen offset:2048
    buffer_load_dwordx4 v[132:135], v6, s[40:43], s48 offen offset:2064
    s_mov_b32 s48, 14155776
    buffer_load_dwordx4 v[136:139], v6, s[40:43], s48 offen offset:2048
    buffer_load_dwordx4 v[140:143], v6, s[40:43], s48 offen offset:2064
    s_waitcnt vmcnt(16)
    v_add_f32 v48, v48, v56
    v_add_f32 v64, v64, v72
    v_cvt_pk_bf16_f32 v48, v48, v64
    v_lshlrev_b32 v56, 16, v48
    v_and_b32 v64, 0xffff0000, v48
    v_sub_f32 v48, v56, v64
    v_cvt_pk_bf16_f32 v48, v48, v48
    v_lshlrev_b32 v48, 16, v48
    v_lshlrev_b32 v56, 16, v32
    v_add_f32 v48, v48, v56
    v_add_f32 v49, v49, v57
    v_add_f32 v65, v65, v73
    v_cvt_pk_bf16_f32 v49, v49, v65
    v_lshlrev_b32 v57, 16, v49
    v_and_b32 v65, 0xffff0000, v49
    v_sub_f32 v49, v57, v65
    v_cvt_pk_bf16_f32 v49, v49, v49
    v_lshlrev_b32 v49, 16, v49
    v_and_b32 v57, 0xffff0000, v32
    v_add_f32 v49, v49, v57
    v_add_f32 v50, v50, v58
    v_add_f32 v66, v66, v74
    v_cvt_pk_bf16_f32 v50, v50, v66
    v_lshlrev_b32 v58, 16, v50
    v_and_b32 v66, 0xffff0000, v50
    v_sub_f32 v50, v58, v66
    v_cvt_pk_bf16_f32 v50, v50, v50
    v_lshlrev_b32 v50, 16, v50
    v_lshlrev_b32 v58, 16, v33
    v_add_f32 v50, v50, v58
    v_add_f32 v51, v51, v59
    v_add_f32 v67, v67, v75
    v_cvt_pk_bf16_f32 v51, v51, v67
    v_lshlrev_b32 v59, 16, v51
    v_and_b32 v67, 0xffff0000, v51
    v_sub_f32 v51, v59, v67
    v_cvt_pk_bf16_f32 v51, v51, v51
    v_lshlrev_b32 v51, 16, v51
    v_and_b32 v59, 0xffff0000, v33
    v_add_f32 v51, v51, v59
    v_add_f32 v52, v52, v60
    v_add_f32 v68, v68, v76
    v_cvt_pk_bf16_f32 v52, v52, v68
    v_lshlrev_b32 v60, 16, v52
    v_and_b32 v68, 0xffff0000, v52
    v_sub_f32 v52, v60, v68
    v_cvt_pk_bf16_f32 v52, v52, v52
    v_lshlrev_b32 v52, 16, v52
    v_lshlrev_b32 v60, 16, v34
    v_add_f32 v52, v52, v60
    v_add_f32 v53, v53, v61
    v_add_f32 v69, v69, v77
    v_cvt_pk_bf16_f32 v53, v53, v69
    v_lshlrev_b32 v61, 16, v53
    v_and_b32 v69, 0xffff0000, v53
    v_sub_f32 v53, v61, v69
    v_cvt_pk_bf16_f32 v53, v53, v53
    v_lshlrev_b32 v53, 16, v53
    v_and_b32 v61, 0xffff0000, v34
    v_add_f32 v53, v53, v61
    v_add_f32 v54, v54, v62
    v_add_f32 v70, v70, v78
    v_cvt_pk_bf16_f32 v54, v54, v70
    v_lshlrev_b32 v62, 16, v54
    v_and_b32 v70, 0xffff0000, v54
    v_sub_f32 v54, v62, v70
    v_cvt_pk_bf16_f32 v54, v54, v54
    v_lshlrev_b32 v54, 16, v54
    v_lshlrev_b32 v62, 16, v35
    v_add_f32 v54, v54, v62
    v_add_f32 v55, v55, v63
    v_add_f32 v71, v71, v79
    v_cvt_pk_bf16_f32 v55, v55, v71
    v_lshlrev_b32 v63, 16, v55
    v_and_b32 v71, 0xffff0000, v55
    v_sub_f32 v55, v63, v71
    v_cvt_pk_bf16_f32 v55, v55, v55
    v_lshlrev_b32 v55, 16, v55
    v_and_b32 v63, 0xffff0000, v35
    v_add_f32 v55, v55, v63
    v_cvt_pk_bf16_f32 v32, v48, v49
    v_cvt_pk_bf16_f32 v33, v50, v51
    v_cvt_pk_bf16_f32 v34, v52, v53
    v_cvt_pk_bf16_f32 v35, v54, v55
    s_waitcnt vmcnt(8)
    v_add_f32 v80, v80, v88
    v_add_f32 v96, v96, v104
    v_cvt_pk_bf16_f32 v80, v80, v96
    v_lshlrev_b32 v88, 16, v80
    v_and_b32 v96, 0xffff0000, v80
    v_sub_f32 v80, v88, v96
    v_cvt_pk_bf16_f32 v80, v80, v80
    v_lshlrev_b32 v80, 16, v80
    v_lshlrev_b32 v88, 16, v36
    v_add_f32 v80, v80, v88
    v_add_f32 v81, v81, v89
    v_add_f32 v97, v97, v105
    v_cvt_pk_bf16_f32 v81, v81, v97
    v_lshlrev_b32 v89, 16, v81
    v_and_b32 v97, 0xffff0000, v81
    v_sub_f32 v81, v89, v97
    v_cvt_pk_bf16_f32 v81, v81, v81
    v_lshlrev_b32 v81, 16, v81
    v_and_b32 v89, 0xffff0000, v36
    v_add_f32 v81, v81, v89
    v_add_f32 v82, v82, v90
    v_add_f32 v98, v98, v106
    v_cvt_pk_bf16_f32 v82, v82, v98
    v_lshlrev_b32 v90, 16, v82
    v_and_b32 v98, 0xffff0000, v82
    v_sub_f32 v82, v90, v98
    v_cvt_pk_bf16_f32 v82, v82, v82
    v_lshlrev_b32 v82, 16, v82
    v_lshlrev_b32 v90, 16, v37
    v_add_f32 v82, v82, v90
    v_add_f32 v83, v83, v91
    v_add_f32 v99, v99, v107
    v_cvt_pk_bf16_f32 v83, v83, v99
    v_lshlrev_b32 v91, 16, v83
    v_and_b32 v99, 0xffff0000, v83
    v_sub_f32 v83, v91, v99
    v_cvt_pk_bf16_f32 v83, v83, v83
    v_lshlrev_b32 v83, 16, v83
    v_and_b32 v91, 0xffff0000, v37
    v_add_f32 v83, v83, v91
    v_add_f32 v84, v84, v92
    v_add_f32 v100, v100, v108
    v_cvt_pk_bf16_f32 v84, v84, v100
    v_lshlrev_b32 v92, 16, v84
    v_and_b32 v100, 0xffff0000, v84
    v_sub_f32 v84, v92, v100
    v_cvt_pk_bf16_f32 v84, v84, v84
    v_lshlrev_b32 v84, 16, v84
    v_lshlrev_b32 v92, 16, v38
    v_add_f32 v84, v84, v92
    v_add_f32 v85, v85, v93
    v_add_f32 v101, v101, v109
    v_cvt_pk_bf16_f32 v85, v85, v101
    v_lshlrev_b32 v93, 16, v85
    v_and_b32 v101, 0xffff0000, v85
    v_sub_f32 v85, v93, v101
    v_cvt_pk_bf16_f32 v85, v85, v85
    v_lshlrev_b32 v85, 16, v85
    v_and_b32 v93, 0xffff0000, v38
    v_add_f32 v85, v85, v93
    v_add_f32 v86, v86, v94
    v_add_f32 v102, v102, v110
    v_cvt_pk_bf16_f32 v86, v86, v102
    v_lshlrev_b32 v94, 16, v86
    v_and_b32 v102, 0xffff0000, v86
    v_sub_f32 v86, v94, v102
    v_cvt_pk_bf16_f32 v86, v86, v86
    v_lshlrev_b32 v86, 16, v86
    v_lshlrev_b32 v94, 16, v39
    v_add_f32 v86, v86, v94
    v_add_f32 v87, v87, v95
    v_add_f32 v103, v103, v111
    v_cvt_pk_bf16_f32 v87, v87, v103
    v_lshlrev_b32 v95, 16, v87
    v_and_b32 v103, 0xffff0000, v87
    v_sub_f32 v87, v95, v103
    v_cvt_pk_bf16_f32 v87, v87, v87
    v_lshlrev_b32 v87, 16, v87
    v_and_b32 v95, 0xffff0000, v39
    v_add_f32 v87, v87, v95
    v_cvt_pk_bf16_f32 v36, v80, v81
    v_cvt_pk_bf16_f32 v37, v82, v83
    v_cvt_pk_bf16_f32 v38, v84, v85
    v_cvt_pk_bf16_f32 v39, v86, v87
    s_waitcnt vmcnt(0)
    v_add_f32 v112, v112, v120
    v_add_f32 v128, v128, v136
    v_cvt_pk_bf16_f32 v112, v112, v128
    v_lshlrev_b32 v120, 16, v112
    v_and_b32 v128, 0xffff0000, v112
    v_sub_f32 v112, v120, v128
    v_cvt_pk_bf16_f32 v112, v112, v112
    v_lshlrev_b32 v112, 16, v112
    v_lshlrev_b32 v120, 16, v40
    v_add_f32 v112, v112, v120
    v_add_f32 v113, v113, v121
    v_add_f32 v129, v129, v137
    v_cvt_pk_bf16_f32 v113, v113, v129
    v_lshlrev_b32 v121, 16, v113
    v_and_b32 v129, 0xffff0000, v113
    v_sub_f32 v113, v121, v129
    v_cvt_pk_bf16_f32 v113, v113, v113
    v_lshlrev_b32 v113, 16, v113
    v_and_b32 v121, 0xffff0000, v40
    v_add_f32 v113, v113, v121
    v_add_f32 v114, v114, v122
    v_add_f32 v130, v130, v138
    v_cvt_pk_bf16_f32 v114, v114, v130
    v_lshlrev_b32 v122, 16, v114
    v_and_b32 v130, 0xffff0000, v114
    v_sub_f32 v114, v122, v130
    v_cvt_pk_bf16_f32 v114, v114, v114
    v_lshlrev_b32 v114, 16, v114
    v_lshlrev_b32 v122, 16, v41
    v_add_f32 v114, v114, v122
    v_add_f32 v115, v115, v123
    v_add_f32 v131, v131, v139
    v_cvt_pk_bf16_f32 v115, v115, v131
    v_lshlrev_b32 v123, 16, v115
    v_and_b32 v131, 0xffff0000, v115
    v_sub_f32 v115, v123, v131
    v_cvt_pk_bf16_f32 v115, v115, v115
    v_lshlrev_b32 v115, 16, v115
    v_and_b32 v123, 0xffff0000, v41
    v_add_f32 v115, v115, v123
    v_add_f32 v116, v116, v124
    v_add_f32 v132, v132, v140
    v_cvt_pk_bf16_f32 v116, v116, v132
    v_lshlrev_b32 v124, 16, v116
    v_and_b32 v132, 0xffff0000, v116
    v_sub_f32 v116, v124, v132
    v_cvt_pk_bf16_f32 v116, v116, v116
    v_lshlrev_b32 v116, 16, v116
    v_lshlrev_b32 v124, 16, v42
    v_add_f32 v116, v116, v124
    v_add_f32 v117, v117, v125
    v_add_f32 v133, v133, v141
    v_cvt_pk_bf16_f32 v117, v117, v133
    v_lshlrev_b32 v125, 16, v117
    v_and_b32 v133, 0xffff0000, v117
    v_sub_f32 v117, v125, v133
    v_cvt_pk_bf16_f32 v117, v117, v117
    v_lshlrev_b32 v117, 16, v117
    v_and_b32 v125, 0xffff0000, v42
    v_add_f32 v117, v117, v125
    v_add_f32 v118, v118, v126
    v_add_f32 v134, v134, v142
    v_cvt_pk_bf16_f32 v118, v118, v134
    v_lshlrev_b32 v126, 16, v118
    v_and_b32 v134, 0xffff0000, v118
    v_sub_f32 v118, v126, v134
    v_cvt_pk_bf16_f32 v118, v118, v118
    v_lshlrev_b32 v118, 16, v118
    v_lshlrev_b32 v126, 16, v43
    v_add_f32 v118, v118, v126
    v_add_f32 v119, v119, v127
    v_add_f32 v135, v135, v143
    v_cvt_pk_bf16_f32 v119, v119, v135
    v_lshlrev_b32 v127, 16, v119
    v_and_b32 v135, 0xffff0000, v119
    v_sub_f32 v119, v127, v135
    v_cvt_pk_bf16_f32 v119, v119, v119
    v_lshlrev_b32 v119, 16, v119
    v_and_b32 v127, 0xffff0000, v43
    v_add_f32 v119, v119, v127
    v_cvt_pk_bf16_f32 v40, v112, v113
    v_cvt_pk_bf16_f32 v41, v114, v115
    v_cvt_pk_bf16_f32 v42, v116, v117
    v_cvt_pk_bf16_f32 v43, v118, v119
    buffer_store_dwordx4 v[8:11], v5, s[36:39], 0 offen offset:0
    buffer_store_dwordx4 v[12:15], v5, s[36:39], 0 offen offset:128
    buffer_store_dwordx4 v[16:19], v5, s[36:39], 0 offen offset:256
    buffer_store_dwordx4 v[20:23], v5, s[36:39], 0 offen offset:384
    buffer_store_dwordx4 v[24:27], v5, s[36:39], 0 offen offset:512
    buffer_store_dwordx4 v[28:31], v5, s[36:39], 0 offen offset:640
    buffer_store_dwordx4 v[32:35], v5, s[36:39], 0 offen offset:768
    buffer_store_dwordx4 v[36:39], v5, s[36:39], 0 offen offset:896
    buffer_store_dwordx4 v[40:43], v5, s[36:39], 0 offen offset:1024
L_post2_kernel_end:
    s_endpgm
.section .rodata,"a"
.p2align 6
.amdhsa_kernel prep_kernel
  .amdhsa_next_free_vgpr 64
  .amdhsa_next_free_sgpr 64
  .amdhsa_accum_offset 64
  .amdhsa_group_segment_fixed_size 0
  .amdhsa_kernarg_size 96
  .amdhsa_user_sgpr_count 2
  .amdhsa_user_sgpr_kernarg_segment_ptr 1
  .amdhsa_system_sgpr_workgroup_id_x 1
.end_amdhsa_kernel
.p2align 6
.amdhsa_kernel ln0_kernel
  .amdhsa_next_free_vgpr 144
  .amdhsa_next_free_sgpr 64
  .amdhsa_accum_offset 144
  .amdhsa_group_segment_fixed_size 0
  .amdhsa_kernarg_size 96
  .amdhsa_user_sgpr_count 2
  .amdhsa_user_sgpr_kernarg_segment_ptr 1
  .amdhsa_system_sgpr_workgroup_id_x 1
.end_amdhsa_kernel
.p2align 6
.amdhsa_kernel qkv_kernel
  .amdhsa_next_free_vgpr 162
  .amdhsa_next_free_sgpr 64
  .amdhsa_accum_offset 164
  .amdhsa_group_segment_fixed_size 0
  .amdhsa_kernarg_size 96
  .amdhsa_user_sgpr_count 2
  .amdhsa_user_sgpr_kernarg_segment_ptr 1
  .amdhsa_system_sgpr_workgroup_id_x 1
.end_amdhsa_kernel
.p2align 6
.amdhsa_kernel kv_kernel
  .amdhsa_next_free_vgpr 132
  .amdhsa_next_free_sgpr 64
  .amdhsa_accum_offset 132
  .amdhsa_group_segment_fixed_size 0
  .amdhsa_kernarg_size 96
  .amdhsa_user_sgpr_count 2
  .amdhsa_user_sgpr_kernarg_segment_ptr 1
  .amdhsa_system_sgpr_workgroup_id_x 1
.end_amdhsa_kernel
.p2align 6
.amdhsa_kernel o_kernel
  .amdhsa_next_free_vgpr 80
  .amdhsa_next_free_sgpr 64
  .amdhsa_accum_offset 80
  .amdhsa_group_segment_fixed_size 0
  .amdhsa_kernarg_size 96
  .amdhsa_user_sgpr_count 2
  .amdhsa_user_sgpr_kernarg_segment_ptr 1
  .amdhsa_system_sgpr_workgroup_id_x 1
.end_amdhsa_kernel
.p2align 6
.amdhsa_kernel op1_kernel
  .amdhsa_next_free_vgpr 110
  .amdhsa_next_free_sgpr 72
  .amdhsa_accum_offset 112
  .amdhsa_group_segment_fixed_size 0
  .amdhsa_kernarg_size 96
  .amdhsa_user_sgpr_count 2
  .amdhsa_user_sgpr_kernarg_segment_ptr 1
  .amdhsa_system_sgpr_workgroup_id_x 1
.end_amdhsa_kernel
.p2align 6
.amdhsa_kernel ln1_kernel
  .amdhsa_next_free_vgpr 144
  .amdhsa_next_free_sgpr 64
  .amdhsa_accum_offset 144
  .amdhsa_group_segment_fixed_size 0
  .amdhsa_kernarg_size 96
  .amdhsa_user_sgpr_count 2
  .amdhsa_user_sgpr_kernarg_segment_ptr 1
  .amdhsa_system_sgpr_workgroup_id_x 1
.end_amdhsa_kernel
.p2align 6
.amdhsa_kernel hid_kernel
  .amdhsa_next_free_vgpr 132
  .amdhsa_next_free_sgpr 64
  .amdhsa_accum_offset 132
  .amdhsa_group_segment_fixed_size 0
  .amdhsa_kernarg_size 96
  .amdhsa_user_sgpr_count 2
  .amdhsa_user_sgpr_kernarg_segment_ptr 1
  .amdhsa_system_sgpr_workgroup_id_x 1
.end_amdhsa_kernel
.p2align 6
.amdhsa_kernel seq_kernel
  .amdhsa_next_free_vgpr 188
  .amdhsa_next_free_sgpr 64
  .amdhsa_accum_offset 188
  .amdhsa_group_segment_fixed_size 0
  .amdhsa_kernarg_size 96
  .amdhsa_user_sgpr_count 2
  .amdhsa_user_sgpr_kernarg_segment_ptr 1
  .amdhsa_system_sgpr_workgroup_id_x 1
.end_amdhsa_kernel
.p2align 6
.amdhsa_kernel post1_kernel
  .amdhsa_next_free_vgpr 144
  .amdhsa_next_free_sgpr 64
  .amdhsa_accum_offset 144
  .amdhsa_group_segment_fixed_size 0
  .amdhsa_kernarg_size 96
  .amdhsa_user_sgpr_count 2
  .amdhsa_user_sgpr_kernarg_segment_ptr 1
  .amdhsa_system_sgpr_workgroup_id_x 1
.end_amdhsa_kernel
.p2align 6
.amdhsa_kernel op2_kernel
  .amdhsa_next_free_vgpr 110
  .amdhsa_next_free_sgpr 72
  .amdhsa_accum_offset 112
  .amdhsa_group_segment_fixed_size 0
  .amdhsa_kernarg_size 96
  .amdhsa_user_sgpr_count 2
  .amdhsa_user_sgpr_kernarg_segment_ptr 1
  .amdhsa_system_sgpr_workgroup_id_x 1
.end_amdhsa_kernel
.p2align 6
.amdhsa_kernel ln3_kernel
  .amdhsa_next_free_vgpr 144
  .amdhsa_next_free_sgpr 64
  .amdhsa_accum_offset 144
  .amdhsa_group_segment_fixed_size 0
  .amdhsa_kernarg_size 96
  .amdhsa_user_sgpr_count 2
  .amdhsa_user_sgpr_kernarg_segment_ptr 1
  .amdhsa_system_sgpr_workgroup_id_x 1
.end_amdhsa_kernel
.p2align 6
.amdhsa_kernel post2_kernel
  .amdhsa_next_free_vgpr 144
  .amdhsa_next_free_sgpr 64
  .amdhsa_accum_offset 144
  .amdhsa_group_segment_fixed_size 0
  .amdhsa_kernarg_size 96
  .amdhsa_user_sgpr_count 2
  .amdhsa_user_sgpr_kernarg_segment_ptr 1
  .amdhsa_system_sgpr_workgroup_id_x 1
.end_amdhsa_kernel
```
